```python
import torch

def _softmax(x, axis=-1):
    return torch.softmax(x, dim=axis)
def _gelu(x):
    return torch.nn.functional.gelu(x, approximate="tanh")
def _silu(x):
    return torch.nn.functional.silu(x)
def _sigmoid(x):
    return torch.sigmoid(x)
def _layernorm(x, axis=-1, eps=1e-5):
    m = x.mean(dim=axis, keepdim=True)
    v = x.var(dim=axis, keepdim=True, unbiased=False)
    return (x - m) / torch.sqrt(v + eps)
def _scatter_add(tgt, idx, src, axis=0):
    return tgt.clone().index_add_(axis, idx, src)
def _segment_sum(src, seg, n):
    out = torch.zeros((n,) + src.shape[1:], dtype=src.dtype)
    return out.index_add_(0, seg, src)
def _pad(x, pw):
    flat = tuple(v for pair in reversed(pw) for v in pair)
    return torch.nn.functional.pad(x, flat)

kernel_name = 'concat_heads__mha_block_cached__mha_block_cached__near_ridge'

def setup_inputs():

    _w = (lambda a: (lambda t: t.to(torch.bfloat16) if t.is_floating_point() else t)(torch.as_tensor(a)))
    def _A_setup():
        B, Sq, D = 8, 192, 576
        H, Sk, Dh = 32, 512, 128
        return {
            "x": _w((lambda *s: torch.randn(*s, dtype=torch.bfloat16) * 0.8)(B, Sq, D)),
            "k_cache": _w((lambda *s: torch.randn(*s, dtype=torch.bfloat16) * 0.8)(B, H, Sk, Dh)),
            "v_cache": _w((lambda *s: torch.randn(*s, dtype=torch.bfloat16) * 0.05)(B, H, Sk, Dh)),
            "wq": _w((lambda *s: torch.randn(*s, dtype=torch.bfloat16) * 0.8)(D, H * Dh) * (D ** -0.5)),
            "wo": _w((lambda *s: torch.randn(*s, dtype=torch.bfloat16) * 0.05)(H * Dh, D) * ((H * Dh) ** -0.5)),
        }
    _A_in = _A_setup()

    def _B_setup():
        B, Sq, D = 8, 192, 576
        H, Sk, Dh = 32, 512, 128
        return {
            "x": _w((lambda *s: torch.randn(*s, dtype=torch.bfloat16) * 0.8)(B, Sq, D)),
            "k_cache": _w((lambda *s: torch.randn(*s, dtype=torch.bfloat16) * 0.8)(B, H, Sk, Dh)),
            "v_cache": _w((lambda *s: torch.randn(*s, dtype=torch.bfloat16) * 0.05)(B, H, Sk, Dh)),
            "wq": _w((lambda *s: torch.randn(*s, dtype=torch.bfloat16) * 0.8)(D, H * Dh) * (D ** -0.5)),
            "wo": _w((lambda *s: torch.randn(*s, dtype=torch.bfloat16) * 0.05)(H * Dh, D) * ((H * Dh) ** -0.5)),
        }
    _B_in = _B_setup()

    return {
        "A_x": _A_in["x"],
        "A_k_cache": _A_in["k_cache"],
        "A_v_cache": _A_in["v_cache"],
        "A_wq": _A_in["wq"],
        "A_wo": _A_in["wo"],
        "B_x": _B_in["x"],
        "B_k_cache": _B_in["k_cache"],
        "B_v_cache": _B_in["v_cache"],
        "B_wq": _B_in["wq"],
        "B_wo": _B_in["wo"],
    }

def reference(A_x, A_k_cache, A_v_cache, A_wq, A_wo, B_x, B_k_cache, B_v_cache, B_wq, B_wo):
    def _A_ref(x, k_cache, v_cache, wq, wo):
        B, Sq, D = x.shape
        H, Dh = 32, 128
        q = (lambda x, *d: x.permute(*d))((x @ wq).reshape(B, Sq, H, Dh), 0, 2, 1, 3)
        scores = torch.einsum("bhqd,bhkd->bhqk", q, k_cache) * (Dh ** -0.5)
        p = _softmax(scores, axis=-1)
        o = torch.einsum("bhqk,bhkd->bhqd", p, v_cache)
        return (lambda x, *d: x.permute(*d))(o, 0, 2, 1, 3).reshape(B, Sq, H * Dh) @ wo

    def _B_ref(x, k_cache, v_cache, wq, wo):
        B, Sq, D = x.shape
        H, Dh = 32, 128
        q = (lambda x, *d: x.permute(*d))((x @ wq).reshape(B, Sq, H, Dh), 0, 2, 1, 3)
        scores = torch.einsum("bhqd,bhkd->bhqk", q, k_cache) * (Dh ** -0.5)
        p = _softmax(scores, axis=-1)
        o = torch.einsum("bhqk,bhkd->bhqd", p, v_cache)
        return (lambda x, *d: x.permute(*d))(o, 0, 2, 1, 3).reshape(B, Sq, H * Dh) @ wo

    a = _A_ref(A_x, A_k_cache, A_v_cache, A_wq, A_wo)
    b = _B_ref(B_x, B_k_cache, B_v_cache, B_wq, B_wo)
    return torch.concatenate([a, b], axis=-1)
```

```asm
; @launch grid=(256,1,1) block=(256,1,1) lds=163840
.amdgcn_target "amdgcn-amd-amdhsa--gfx950"
.text
.globl concat_heads__mha_block_cached__mha_block_cached__near_ridge_kernel
.p2align 8
.type concat_heads__mha_block_cached__mha_block_cached__near_ridge_kernel,@function
concat_heads__mha_block_cached__mha_block_cached__near_ridge_kernel:
s_cmp_ge_u32 s2, 256
s_cbranch_scc1 L_end
s_load_dwordx8 s[48:55], s[0:1], 0
s_load_dwordx8 s[56:63], s[0:1], 40
s_load_dwordx8 s[64:71], s[0:1], 72
s_load_dwordx2 s[72:73], s[0:1], 32
s_getpc_b64 s[6:7]
L_pf_base:
s_lshr_b32 s3, s2, 3
s_lshl_b32 s3, s3, 2
v_lshrrev_b32 v47, 6, v0
v_add_u32 v47, s3, v47
v_mul_u32_u24 v48, 7282, v47
v_lshrrev_b32 v48, 16, v48
v_mul_u32_u24 v48, 9, v48
v_sub_u32 v47, v47, v48
v_lshlrev_b32 v47, 13, v47
v_and_b32 v48, 63, v0
v_lshlrev_b32 v48, 7, v48
v_add_u32 v47, v47, v48
v_min_u32 v47, L_code_end-L_pf_base, v47
global_load_dword v63, v47, s[6:7]
v_lshrrev_b32 v47, 6, v0
v_and_b32 v0, 63, v0
v_readfirstlane_b32 s35, v47
s_and_b32 s3, s2, 7
s_lshr_b32 s38, s3, 2
s_and_b32 s85, s3, 3
s_lshr_b32 s6, s2, 3
s_and_b32 s39, s6, 7
s_lshr_b32 s84, s6, 3
s_lshl_b32 s3, s85, 2
s_add_u32 s3, s3, s84
s_lshr_b32 s36, s35, 1
s_and_b32 s37, s35, 1
s_lshl_b32 s3, s3, 1
s_add_u32 s40, s3, s36
s_lshl_b32 s6, s36, 16
s_lshl_b32 s7, s37, 12
s_add_u32 s28, s6, s7
s_mul_i32 s32, s39, 221184
s_lshl_b32 s33, s40, 8
s_lshl_b32 s34, s35, 11
v_and_b32 v49, 15, v0
v_lshrrev_b32 v50, 4, v0
v_lshrrev_b32 v51, 3, v0
s_lshl_b32 s7, s35, 4
v_add_u32 v51, s7, v51
v_mul_u32_u24 v51, 1152, v51
v_and_b32 v52, 7, v0
v_add_u32 v53, 0, v50
v_xor_b32 v53, v52, v53
v_lshlrev_b32 v53, 4, v53
v_add_u32 v53, v51, v53
v_add_u32 v29, 0, v53
v_add_u32 v53, 4, v50
v_xor_b32 v53, v52, v53
v_lshlrev_b32 v53, 4, v53
v_add_u32 v53, v51, v53
v_add_u32 v30, 8192, v53
s_lshl_b32 s7, s37, 4
v_add_u32 v51, s7, v50
v_lshlrev_b32 v52, 2, v50
v_xor_b32 v52, v49, v52
v_lshlrev_b32 v52, 4, v52
v_lshlrev_b32 v53, 13, v51
v_add_u32 v53, v53, v52
v_add_u32 v25, 0, v53
v_add_u32 v26, 31744, v53
v_add_u32 v27, 63488, v53
v_add_u32 v28, 95232, v53
s_mov_b32 s74, 0
s_waitcnt lgkmcnt(0)
s_cmp_eq_u32 s38, 0
s_cselect_b32 s16, s48, s56
s_cselect_b32 s17, s49, s57
s_mov_b32 s18, 1769472
s_mov_b32 s19, 0x20000
s_cselect_b32 s20, s54, s62
s_cselect_b32 s21, s55, s63
s_mov_b32 s22, 4718592
s_mov_b32 s23, 0x20000
s_cselect_b32 s8, s50, s58
s_cselect_b32 s9, s51, s59
s_mov_b32 s10, 33554432
s_mov_b32 s11, 0x20000
s_cselect_b32 s12, s52, s60
s_cselect_b32 s13, s53, s61
s_mov_b32 s14, 33554432
s_mov_b32 s15, 0x20000
s_cselect_b32 s56, s72, s64
s_cselect_b32 s57, s73, s65
s_mov_b32 s58, 4718592
s_mov_b32 s59, 0x20000
s_mov_b32 s50, s32
s_add_u32 s49, s32, 1152
s_lshl_b32 s3, s74, 7
s_add_u32 s48, s32, s3
s_mov_b32 s53, s33
s_add_u32 s52, s33, 4718592
s_lshl_b32 s3, s74, 19
s_add_u32 s51, s33, s3
s_add_u32 m0, s34, 139264
s_add_u32 s44, s48, 0
buffer_load_dwordx4 v29, s[16:19], s44 offen offset:0  lds
buffer_load_dwordx4 v30, s[16:19], s44 offen offset:1024  lds
s_add_u32 m0, s34, 147456
s_add_u32 s44, s48, 73728
buffer_load_dwordx4 v29, s[16:19], s44 offen offset:0  lds
buffer_load_dwordx4 v30, s[16:19], s44 offen offset:1024  lds
s_add_u32 m0, s34, 155648
s_add_u32 s44, s48, 147456
buffer_load_dwordx4 v29, s[16:19], s44 offen offset:0  lds
buffer_load_dwordx4 v30, s[16:19], s44 offen offset:1024  lds
s_add_u32 s48, s48, 128
s_cmp_eq_u32 s48, s49
s_cselect_b32 s48, s50, s48
s_add_u32 m0, s28, 49152
s_mov_b32 s45, s51
buffer_load_dwordx4 v25, s[20:23], s45 offen offset:0 nt lds
buffer_load_dwordx4 v26, s[20:23], s45 offen offset:1024 nt lds
buffer_load_dwordx4 v27, s[20:23], s45 offen offset:2048 nt lds
buffer_load_dwordx4 v28, s[20:23], s45 offen offset:3072 nt lds
s_add_u32 s51, s51, 262144
s_cmp_eq_u32 s51, s52
s_cselect_b32 s51, s53, s51
s_add_u32 m0, s28, 24576
s_mov_b32 s45, s51
buffer_load_dwordx4 v25, s[20:23], s45 offen offset:0 nt lds
buffer_load_dwordx4 v26, s[20:23], s45 offen offset:1024 nt lds
buffer_load_dwordx4 v27, s[20:23], s45 offen offset:2048 nt lds
buffer_load_dwordx4 v28, s[20:23], s45 offen offset:3072 nt lds
s_add_u32 s51, s51, 262144
s_cmp_eq_u32 s51, s52
s_cselect_b32 s51, s53, s51
s_mov_b32 s24, s70
s_mov_b32 s25, s71
s_mov_b32 s26, 47710208
s_mov_b32 s27, 0x20000
s_mov_b32 s80, s66
s_mov_b32 s81, s67
s_mov_b32 s82, 3538944
s_mov_b32 s83, 0x20000
s_mov_b32 s76, s68
s_mov_b32 s77, s69
s_mov_b32 s78, 256
s_mov_b32 s79, 0x20000
s_lshl_b32 s29, s39, 5
s_add_u32 s29, s29, s40
s_lshl_b32 s29, s29, 17
s_lshl_b32 s30, s38, 3
s_add_u32 s30, s30, s39
s_mul_i32 s30, s30, 6
s_mul_i32 s3, s37, 3
s_add_u32 s30, s30, s3
s_lshl_b32 s30, s30, 18
s_lshl_b32 s3, s40, 13
s_add_u32 s30, s30, s3
s_mov_b32 s42, 0x3e0293ee
s_mov_b32 s43, 0x3e0293ee
s_mov_b32 s31, 0
s_lshr_b32 s6, s2, 3
s_mul_i32 s3, s6, 1
s_mul_i32 s7, s36, 0
s_add_u32 s3, s3, s7
s_and_b32 s3, s3, 15
s_lshl_b32 s41, s3, 13
s_mov_b32 s54, s41
s_mov_b32 s55, s41
s_lshl_b32 s3, s85, 10
s_lshl_b32 s6, s6, 5
s_add_u32 s3, s3, s6
s_mul_i32 s86, s3, 1152
s_mul_i32 s3, s35, 9216
s_add_u32 s86, s86, s3
v_and_b32 v47, 31, v0
v_lshrrev_b32 v48, 5, v0
s_lshl_b32 s6, s36, 16
v_lshrrev_b32 v52, 2, v49
v_and_b32 v53, 3, v0
v_and_b32 v54, 1, v53
v_lshlrev_b32 v54, 4, v54
v_lshrrev_b32 v53, 1, v53
v_lshlrev_b32 v53, 3, v53
v_or_b32 v54, v54, v53
v_and_b32 v53, 1, v50
v_lshlrev_b32 v53, 5, v53
v_or_b32 v54, v54, v53
v_lshlrev_b32 v53, 6, v52
v_or_b32 v54, v54, v53
v_add_u32 v54, s6, v54
v_lshlrev_b32 v53, 3, v48
v_add_u32 v53, v53, v52
v_lshlrev_b32 v53, 8, v53
v_add_u32 v53, v53, v54
v_xor_b32 v21, 0, v53
v_xor_b32 v22, 64, v53
v_xor_b32 v23, 128, v53
v_xor_b32 v24, 192, v53
v_lshlrev_b32 v53, 2, v48
v_add_u32 v53, v53, v52
v_lshlrev_b32 v53, 8, v53
v_add_u32 v53, v53, v54
v_add_u32 v53, 32768, v53
v_xor_b32 v9, 0, v53
v_xor_b32 v10, 64, v53
v_xor_b32 v11, 128, v53
v_xor_b32 v12, 192, v53
v_lshrrev_b32 v51, 1, v47
v_and_b32 v51, 7, v51
v_xor_b32 v51, v48, v51
v_lshlrev_b32 v51, 4, v51
v_lshlrev_b32 v52, 7, v47
v_add_u32 v51, v51, v52
s_mul_i32 s3, s37, 12288
s_add_u32 s3, s3, 139264
v_add_u32 v52, s3, v51
v_xor_b32 v31, 0, v52
v_xor_b32 v32, 32, v52
v_xor_b32 v33, 64, v52
v_xor_b32 v34, 96, v52
s_add_u32 m0, s28, 40960
s_mov_b32 s45, s51
buffer_load_dwordx4 v25, s[20:23], s45 offen offset:0 nt lds
buffer_load_dwordx4 v26, s[20:23], s45 offen offset:1024 nt lds
buffer_load_dwordx4 v27, s[20:23], s45 offen offset:2048 nt lds
buffer_load_dwordx4 v28, s[20:23], s45 offen offset:3072 nt lds
s_add_u32 s51, s51, 262144
s_cmp_eq_u32 s51, s52
s_cselect_b32 s51, s53, s51
s_cmp_eq_u32 s37, 0
s_mov_b32 s6, 57344
s_mov_b32 s7, 126976
s_cselect_b32 s3, s6, s7
v_add_u32 v52, s3, v51
v_xor_b32 v35, 0, v52
v_xor_b32 v36, 32, v52
v_xor_b32 v37, 64, v52
v_xor_b32 v38, 96, v52
s_mov_b32 s6, 61440
s_mov_b32 s7, 131072
s_cselect_b32 s3, s6, s7
v_add_u32 v52, s3, v51
v_xor_b32 v39, 0, v52
v_xor_b32 v40, 32, v52
v_xor_b32 v41, 64, v52
v_xor_b32 v42, 96, v52
s_mov_b32 s6, 122880
s_mov_b32 s7, 135168
s_cselect_b32 s3, s6, s7
v_add_u32 v52, s3, v51
v_xor_b32 v43, 0, v52
v_xor_b32 v44, 32, v52
v_xor_b32 v45, 64, v52
v_xor_b32 v46, 96, v52
s_lshl_b32 s7, s37, 4
v_add_u32 v51, s7, v50
v_lshlrev_b32 v53, 8, v51
v_lshlrev_b32 v52, 2, v50
v_xor_b32 v52, v49, v52
v_lshlrev_b32 v52, 4, v52
v_add_u32 v17, v53, v52
v_add_u32 v54, 0, v50
v_xor_b32 v54, v49, v54
v_lshlrev_b32 v54, 4, v54
v_add_u32 v13, v53, v54
v_add_u32 v54, 4, v50
v_xor_b32 v54, v49, v54
v_lshlrev_b32 v54, 4, v54
v_add_u32 v14, v53, v54
v_add_u32 v54, 8, v50
v_xor_b32 v54, v49, v54
v_lshlrev_b32 v54, 4, v54
v_add_u32 v15, v53, v54
v_add_u32 v54, 12, v50
v_xor_b32 v54, v49, v54
v_lshlrev_b32 v54, 4, v54
v_add_u32 v16, v53, v54
s_lshl_b32 s6, s36, 16
v_xor_b32 v51, v48, v49
v_lshlrev_b32 v51, 4, v51
v_lshlrev_b32 v52, 8, v47
v_add3_u32 v51, v51, v52, s6
v_xor_b32 v1, 0, v51
v_xor_b32 v2, 32, v51
v_xor_b32 v3, 64, v51
v_xor_b32 v4, 96, v51
v_xor_b32 v5, 128, v51
v_xor_b32 v6, 160, v51
v_xor_b32 v7, 192, v51
v_xor_b32 v8, 224, v51
v_mov_b32 v18, 0
v_mov_b32 v19, 0
v_mov_b32 v20, 0
s_waitcnt vmcnt(8)
s_barrier
ds_read_b128 a[224:227], v31 offset:0
ds_read_b128 a[228:231], v31 offset:4096
ds_read_b128 a[232:235], v31 offset:8192
ds_read_b64_tr_b16 a[192:193], v21 offset:49152
ds_read_b64_tr_b16 a[194:195], v21 offset:50176
ds_read_b64_tr_b16 a[196:197], v22 offset:49152
ds_read_b64_tr_b16 a[198:199], v22 offset:50176
ds_read_b64_tr_b16 a[200:201], v23 offset:49152
ds_read_b64_tr_b16 a[202:203], v23 offset:50176
ds_read_b64_tr_b16 a[204:205], v24 offset:49152
ds_read_b64_tr_b16 a[206:207], v24 offset:50176
s_waitcnt lgkmcnt(0)
v_mfma_f32_32x32x16_bf16 v[64:79], a[192:195], a[224:227], 0
v_mfma_f32_32x32x16_bf16 v[128:143], a[192:195], a[228:231], 0
ds_read_b128 a[236:239], v32 offset:0
ds_read_b128 a[240:243], v32 offset:4096
s_add_u32 m0, s34, 57344
s_add_u32 s44, s48, 0
buffer_load_dwordx4 v29, s[16:19], s44 offen offset:0  lds
v_mfma_f32_32x32x16_bf16 v[192:207], a[192:195], a[232:235], 0
ds_read_b128 a[244:247], v32 offset:8192
ds_read_b64_tr_b16 a[208:209], v21 offset:53248
buffer_load_dwordx4 v30, s[16:19], s44 offen offset:1024  lds
v_mfma_f32_32x32x16_bf16 v[80:95], a[196:199], a[224:227], 0
ds_read_b64_tr_b16 a[210:211], v21 offset:54272
s_add_u32 m0, s34, 122880
s_add_u32 s44, s48, 73728
buffer_load_dwordx4 v29, s[16:19], s44 offen offset:0  lds
v_mfma_f32_32x32x16_bf16 v[144:159], a[196:199], a[228:231], 0
ds_read_b64_tr_b16 a[212:213], v22 offset:53248
ds_read_b64_tr_b16 a[214:215], v22 offset:54272
buffer_load_dwordx4 v30, s[16:19], s44 offen offset:1024  lds
v_mfma_f32_32x32x16_bf16 v[208:223], a[196:199], a[232:235], 0
ds_read_b64_tr_b16 a[216:217], v23 offset:53248
s_add_u32 m0, s34, 131072
s_add_u32 s44, s48, 147456
buffer_load_dwordx4 v29, s[16:19], s44 offen offset:0  lds
v_mfma_f32_32x32x16_bf16 v[96:111], a[200:203], a[224:227], 0
ds_read_b64_tr_b16 a[218:219], v23 offset:54272
ds_read_b64_tr_b16 a[220:221], v24 offset:53248
buffer_load_dwordx4 v30, s[16:19], s44 offen offset:1024  lds
v_mfma_f32_32x32x16_bf16 v[160:175], a[200:203], a[228:231], 0
ds_read_b64_tr_b16 a[222:223], v24 offset:54272
s_add_u32 s48, s48, 128
s_cmp_eq_u32 s48, s49
s_cselect_b32 s48, s50, s48
s_add_u32 m0, s28, 16384
s_mov_b32 s45, s51
v_mfma_f32_32x32x16_bf16 v[224:239], a[200:203], a[232:235], 0
buffer_load_dwordx4 v25, s[20:23], s45 offen offset:0 nt lds
v_mfma_f32_32x32x16_bf16 v[112:127], a[204:207], a[224:227], 0
buffer_load_dwordx4 v26, s[20:23], s45 offen offset:1024 nt lds
buffer_load_dwordx4 v27, s[20:23], s45 offen offset:2048 nt lds
v_mfma_f32_32x32x16_bf16 v[176:191], a[204:207], a[228:231], 0
buffer_load_dwordx4 v28, s[20:23], s45 offen offset:3072 nt lds
v_mfma_f32_32x32x16_bf16 v[240:255], a[204:207], a[232:235], 0
s_add_u32 s51, s51, 262144
s_cmp_eq_u32 s51, s52
s_cselect_b32 s51, s53, s51
s_waitcnt lgkmcnt(0)
v_mfma_f32_32x32x16_bf16 v[64:79], a[208:211], a[236:239], v[64:79]
s_waitcnt vmcnt(14)
s_barrier
v_mfma_f32_32x32x16_bf16 v[128:143], a[208:211], a[240:243], v[128:143]
ds_read_b128 a[224:227], v33 offset:0
ds_read_b128 a[228:231], v33 offset:4096
s_add_u32 m0, s28, 49152
s_mov_b32 s45, s51
v_mfma_f32_32x32x16_bf16 v[192:207], a[208:211], a[244:247], v[192:207]
ds_read_b128 a[232:235], v33 offset:8192
ds_read_b64_tr_b16 a[192:193], v21 offset:24576
buffer_load_dwordx4 v25, s[20:23], s45 offen offset:0 nt lds
v_mfma_f32_32x32x16_bf16 v[80:95], a[212:215], a[236:239], v[80:95]
ds_read_b64_tr_b16 a[194:195], v21 offset:25600
v_mfma_f32_32x32x16_bf16 v[144:159], a[212:215], a[240:243], v[144:159]
ds_read_b64_tr_b16 a[196:197], v22 offset:24576
ds_read_b64_tr_b16 a[198:199], v22 offset:25600
buffer_load_dwordx4 v26, s[20:23], s45 offen offset:1024 nt lds
v_mfma_f32_32x32x16_bf16 v[208:223], a[212:215], a[244:247], v[208:223]
ds_read_b64_tr_b16 a[200:201], v23 offset:24576
v_mfma_f32_32x32x16_bf16 v[96:111], a[216:219], a[236:239], v[96:111]
ds_read_b64_tr_b16 a[202:203], v23 offset:25600
ds_read_b64_tr_b16 a[204:205], v24 offset:24576
buffer_load_dwordx4 v27, s[20:23], s45 offen offset:2048 nt lds
v_mfma_f32_32x32x16_bf16 v[160:175], a[216:219], a[240:243], v[160:175]
ds_read_b64_tr_b16 a[206:207], v24 offset:25600
v_mfma_f32_32x32x16_bf16 v[224:239], a[216:219], a[244:247], v[224:239]
buffer_load_dwordx4 v28, s[20:23], s45 offen offset:3072 nt lds
v_mfma_f32_32x32x16_bf16 v[112:127], a[220:223], a[236:239], v[112:127]
v_mfma_f32_32x32x16_bf16 v[176:191], a[220:223], a[240:243], v[176:191]
s_add_u32 s51, s51, 262144
s_cmp_eq_u32 s51, s52
s_cselect_b32 s51, s53, s51
v_mfma_f32_32x32x16_bf16 v[240:255], a[220:223], a[244:247], v[240:255]
s_waitcnt lgkmcnt(0)
v_mfma_f32_32x32x16_bf16 v[64:79], a[192:195], a[224:227], v[64:79]
v_mfma_f32_32x32x16_bf16 v[128:143], a[192:195], a[228:231], v[128:143]
ds_read_b128 a[236:239], v34 offset:0
ds_read_b128 a[240:243], v34 offset:4096
v_mfma_f32_32x32x16_bf16 v[192:207], a[192:195], a[232:235], v[192:207]
ds_read_b128 a[244:247], v34 offset:8192
ds_read_b64_tr_b16 a[208:209], v21 offset:28672
v_mfma_f32_32x32x16_bf16 v[80:95], a[196:199], a[224:227], v[80:95]
ds_read_b64_tr_b16 a[210:211], v21 offset:29696
v_mfma_f32_32x32x16_bf16 v[144:159], a[196:199], a[228:231], v[144:159]
ds_read_b64_tr_b16 a[212:213], v22 offset:28672
ds_read_b64_tr_b16 a[214:215], v22 offset:29696
v_mfma_f32_32x32x16_bf16 v[208:223], a[196:199], a[232:235], v[208:223]
ds_read_b64_tr_b16 a[216:217], v23 offset:28672
v_mfma_f32_32x32x16_bf16 v[96:111], a[200:203], a[224:227], v[96:111]
ds_read_b64_tr_b16 a[218:219], v23 offset:29696
ds_read_b64_tr_b16 a[220:221], v24 offset:28672
v_accvgpr_write_b32 a0, 0
v_mfma_f32_32x32x16_bf16 v[160:175], a[200:203], a[228:231], v[160:175]
ds_read_b64_tr_b16 a[222:223], v24 offset:29696
v_accvgpr_write_b32 a1, 0
v_mfma_f32_32x32x16_bf16 v[224:239], a[200:203], a[232:235], v[224:239]
s_add_u32 m0, s28, 0
s_add_u32 s46, s29, s54
v_accvgpr_write_b32 a2, 0
v_mfma_f32_32x32x16_bf16 v[112:127], a[204:207], a[224:227], v[112:127]
buffer_load_dwordx4 v13, s[8:11], s46 offen offset:0 nt lds
v_accvgpr_write_b32 a3, 0
v_mfma_f32_32x32x16_bf16 v[176:191], a[204:207], a[228:231], v[176:191]
v_accvgpr_write_b32 a4, 0
v_mfma_f32_32x32x16_bf16 v[240:255], a[204:207], a[232:235], v[240:255]
v_accvgpr_write_b32 a5, 0
s_waitcnt lgkmcnt(0)
v_mfma_f32_32x32x16_bf16 v[64:79], a[208:211], a[236:239], v[64:79]
s_waitcnt vmcnt(9)
s_barrier
v_mfma_f32_32x32x16_bf16 v[128:143], a[208:211], a[240:243], v[128:143]
ds_read_b128 a[224:227], v35
ds_read_b128 a[228:231], v39
s_add_u32 m0, s34, 139264
s_add_u32 s44, s48, 0
buffer_load_dwordx4 v29, s[16:19], s44 offen offset:0  lds
v_mfma_f32_32x32x16_bf16 v[192:207], a[208:211], a[244:247], v[192:207]
ds_read_b128 a[232:235], v43
ds_read_b64_tr_b16 a[192:193], v21 offset:40960
buffer_load_dwordx4 v30, s[16:19], s44 offen offset:1024  lds
v_mfma_f32_32x32x16_bf16 v[80:95], a[212:215], a[236:239], v[80:95]
ds_read_b64_tr_b16 a[194:195], v21 offset:41984
s_add_u32 m0, s34, 147456
s_add_u32 s44, s48, 73728
buffer_load_dwordx4 v29, s[16:19], s44 offen offset:0  lds
v_mfma_f32_32x32x16_bf16 v[144:159], a[212:215], a[240:243], v[144:159]
ds_read_b64_tr_b16 a[196:197], v22 offset:40960
ds_read_b64_tr_b16 a[198:199], v22 offset:41984
buffer_load_dwordx4 v30, s[16:19], s44 offen offset:1024  lds
v_mfma_f32_32x32x16_bf16 v[208:223], a[212:215], a[244:247], v[208:223]
ds_read_b64_tr_b16 a[200:201], v23 offset:40960
s_add_u32 m0, s34, 155648
s_add_u32 s44, s48, 147456
buffer_load_dwordx4 v29, s[16:19], s44 offen offset:0  lds
v_mfma_f32_32x32x16_bf16 v[96:111], a[216:219], a[236:239], v[96:111]
ds_read_b64_tr_b16 a[202:203], v23 offset:41984
ds_read_b64_tr_b16 a[204:205], v24 offset:40960
buffer_load_dwordx4 v30, s[16:19], s44 offen offset:1024  lds
v_accvgpr_write_b32 a6, 0
v_mfma_f32_32x32x16_bf16 v[160:175], a[216:219], a[240:243], v[160:175]
ds_read_b64_tr_b16 a[206:207], v24 offset:41984
s_add_u32 s48, s48, 128
s_cmp_eq_u32 s48, s49
s_cselect_b32 s48, s50, s48
s_add_u32 m0, s28, 24576
s_mov_b32 s45, s51
v_accvgpr_write_b32 a7, 0
v_mfma_f32_32x32x16_bf16 v[224:239], a[216:219], a[244:247], v[224:239]
buffer_load_dwordx4 v25, s[20:23], s45 offen offset:0 nt lds
v_accvgpr_write_b32 a8, 0
v_mfma_f32_32x32x16_bf16 v[112:127], a[220:223], a[236:239], v[112:127]
buffer_load_dwordx4 v26, s[20:23], s45 offen offset:1024 nt lds
buffer_load_dwordx4 v27, s[20:23], s45 offen offset:2048 nt lds
v_accvgpr_write_b32 a9, 0
v_mfma_f32_32x32x16_bf16 v[176:191], a[220:223], a[240:243], v[176:191]
buffer_load_dwordx4 v28, s[20:23], s45 offen offset:3072 nt lds
v_accvgpr_write_b32 a10, 0
v_mfma_f32_32x32x16_bf16 v[240:255], a[220:223], a[244:247], v[240:255]
s_add_u32 s51, s51, 262144
s_cmp_eq_u32 s51, s52
s_cselect_b32 s51, s53, s51
v_accvgpr_write_b32 a11, 0
s_waitcnt lgkmcnt(0)
v_mfma_f32_32x32x16_bf16 v[64:79], a[192:195], a[224:227], v[64:79]
v_mfma_f32_32x32x16_bf16 v[128:143], a[192:195], a[228:231], v[128:143]
ds_read_b128 a[236:239], v36
ds_read_b128 a[240:243], v40
v_mfma_f32_32x32x16_bf16 v[192:207], a[192:195], a[232:235], v[192:207]
ds_read_b128 a[244:247], v44
ds_read_b64_tr_b16 a[208:209], v21 offset:45056
v_mfma_f32_32x32x16_bf16 v[80:95], a[196:199], a[224:227], v[80:95]
ds_read_b64_tr_b16 a[210:211], v21 offset:46080
v_mfma_f32_32x32x16_bf16 v[144:159], a[196:199], a[228:231], v[144:159]
ds_read_b64_tr_b16 a[212:213], v22 offset:45056
ds_read_b64_tr_b16 a[214:215], v22 offset:46080
v_mfma_f32_32x32x16_bf16 v[208:223], a[196:199], a[232:235], v[208:223]
ds_read_b64_tr_b16 a[216:217], v23 offset:45056
v_mfma_f32_32x32x16_bf16 v[96:111], a[200:203], a[224:227], v[96:111]
ds_read_b64_tr_b16 a[218:219], v23 offset:46080
ds_read_b64_tr_b16 a[220:221], v24 offset:45056
v_accvgpr_write_b32 a12, 0
v_mfma_f32_32x32x16_bf16 v[160:175], a[200:203], a[228:231], v[160:175]
ds_read_b64_tr_b16 a[222:223], v24 offset:46080
v_accvgpr_write_b32 a13, 0
v_mfma_f32_32x32x16_bf16 v[224:239], a[200:203], a[232:235], v[224:239]
s_add_u32 m0, s28, 0
v_accvgpr_write_b32 a14, 0
v_mfma_f32_32x32x16_bf16 v[112:127], a[204:207], a[224:227], v[112:127]
buffer_load_dwordx4 v14, s[8:11], s46 offen offset:1024 nt lds
v_accvgpr_write_b32 a15, 0
v_mfma_f32_32x32x16_bf16 v[176:191], a[204:207], a[228:231], v[176:191]
v_accvgpr_write_b32 a16, 0
v_mfma_f32_32x32x16_bf16 v[240:255], a[204:207], a[232:235], v[240:255]
v_accvgpr_write_b32 a17, 0
s_waitcnt lgkmcnt(0)
v_mfma_f32_32x32x16_bf16 v[64:79], a[208:211], a[236:239], v[64:79]
s_waitcnt vmcnt(16)
s_barrier
v_mfma_f32_32x32x16_bf16 v[128:143], a[208:211], a[240:243], v[128:143]
ds_read_b128 a[224:227], v37
ds_read_b128 a[228:231], v41
s_add_u32 m0, s28, 40960
s_mov_b32 s45, s51
v_mfma_f32_32x32x16_bf16 v[192:207], a[208:211], a[244:247], v[192:207]
ds_read_b128 a[232:235], v45
ds_read_b64_tr_b16 a[192:193], v21 offset:16384
buffer_load_dwordx4 v25, s[20:23], s45 offen offset:0 nt lds
v_mfma_f32_32x32x16_bf16 v[80:95], a[212:215], a[236:239], v[80:95]
ds_read_b64_tr_b16 a[194:195], v21 offset:17408
v_mfma_f32_32x32x16_bf16 v[144:159], a[212:215], a[240:243], v[144:159]
ds_read_b64_tr_b16 a[196:197], v22 offset:16384
ds_read_b64_tr_b16 a[198:199], v22 offset:17408
buffer_load_dwordx4 v26, s[20:23], s45 offen offset:1024 nt lds
v_mfma_f32_32x32x16_bf16 v[208:223], a[212:215], a[244:247], v[208:223]
ds_read_b64_tr_b16 a[200:201], v23 offset:16384
v_mfma_f32_32x32x16_bf16 v[96:111], a[216:219], a[236:239], v[96:111]
ds_read_b64_tr_b16 a[202:203], v23 offset:17408
ds_read_b64_tr_b16 a[204:205], v24 offset:16384
buffer_load_dwordx4 v27, s[20:23], s45 offen offset:2048 nt lds
v_accvgpr_write_b32 a18, 0
v_mfma_f32_32x32x16_bf16 v[160:175], a[216:219], a[240:243], v[160:175]
ds_read_b64_tr_b16 a[206:207], v24 offset:17408
v_accvgpr_write_b32 a19, 0
v_mfma_f32_32x32x16_bf16 v[224:239], a[216:219], a[244:247], v[224:239]
buffer_load_dwordx4 v28, s[20:23], s45 offen offset:3072 nt lds
v_accvgpr_write_b32 a20, 0
v_mfma_f32_32x32x16_bf16 v[112:127], a[220:223], a[236:239], v[112:127]
v_accvgpr_write_b32 a21, 0
v_mfma_f32_32x32x16_bf16 v[176:191], a[220:223], a[240:243], v[176:191]
s_add_u32 s51, s51, 262144
s_cmp_eq_u32 s51, s52
s_cselect_b32 s51, s53, s51
v_accvgpr_write_b32 a22, 0
v_mfma_f32_32x32x16_bf16 v[240:255], a[220:223], a[244:247], v[240:255]
v_accvgpr_write_b32 a23, 0
s_waitcnt lgkmcnt(0)
v_mfma_f32_32x32x16_bf16 v[64:79], a[192:195], a[224:227], v[64:79]
v_mfma_f32_32x32x16_bf16 v[128:143], a[192:195], a[228:231], v[128:143]
ds_read_b128 a[236:239], v38
ds_read_b128 a[240:243], v42
v_mfma_f32_32x32x16_bf16 v[192:207], a[192:195], a[232:235], v[192:207]
ds_read_b128 a[244:247], v46
ds_read_b64_tr_b16 a[208:209], v21 offset:20480
v_mfma_f32_32x32x16_bf16 v[80:95], a[196:199], a[224:227], v[80:95]
ds_read_b64_tr_b16 a[210:211], v21 offset:21504
v_mfma_f32_32x32x16_bf16 v[144:159], a[196:199], a[228:231], v[144:159]
ds_read_b64_tr_b16 a[212:213], v22 offset:20480
ds_read_b64_tr_b16 a[214:215], v22 offset:21504
v_mfma_f32_32x32x16_bf16 v[208:223], a[196:199], a[232:235], v[208:223]
ds_read_b64_tr_b16 a[216:217], v23 offset:20480
v_mfma_f32_32x32x16_bf16 v[96:111], a[200:203], a[224:227], v[96:111]
ds_read_b64_tr_b16 a[218:219], v23 offset:21504
ds_read_b64_tr_b16 a[220:221], v24 offset:20480
v_accvgpr_write_b32 a24, 0
v_mfma_f32_32x32x16_bf16 v[160:175], a[200:203], a[228:231], v[160:175]
ds_read_b64_tr_b16 a[222:223], v24 offset:21504
v_accvgpr_write_b32 a25, 0
v_mfma_f32_32x32x16_bf16 v[224:239], a[200:203], a[232:235], v[224:239]
s_add_u32 m0, s28, 0
v_accvgpr_write_b32 a26, 0
v_mfma_f32_32x32x16_bf16 v[112:127], a[204:207], a[224:227], v[112:127]
buffer_load_dwordx4 v15, s[8:11], s46 offen offset:2048 nt lds
v_accvgpr_write_b32 a27, 0
v_mfma_f32_32x32x16_bf16 v[176:191], a[204:207], a[228:231], v[176:191]
v_accvgpr_write_b32 a28, 0
v_mfma_f32_32x32x16_bf16 v[240:255], a[204:207], a[232:235], v[240:255]
v_accvgpr_write_b32 a29, 0
s_waitcnt lgkmcnt(0)
v_mfma_f32_32x32x16_bf16 v[64:79], a[208:211], a[236:239], v[64:79]
s_waitcnt vmcnt(10)
s_barrier
v_mfma_f32_32x32x16_bf16 v[128:143], a[208:211], a[240:243], v[128:143]
ds_read_b128 a[224:227], v31 offset:0
ds_read_b128 a[228:231], v31 offset:4096
s_add_u32 m0, s34, 57344
s_add_u32 s44, s48, 0
buffer_load_dwordx4 v29, s[16:19], s44 offen offset:0  lds
v_mfma_f32_32x32x16_bf16 v[192:207], a[208:211], a[244:247], v[192:207]
ds_read_b128 a[232:235], v31 offset:8192
ds_read_b64_tr_b16 a[192:193], v21 offset:49152
buffer_load_dwordx4 v30, s[16:19], s44 offen offset:1024  lds
v_mfma_f32_32x32x16_bf16 v[80:95], a[212:215], a[236:239], v[80:95]
ds_read_b64_tr_b16 a[194:195], v21 offset:50176
s_add_u32 m0, s34, 122880
s_add_u32 s44, s48, 73728
buffer_load_dwordx4 v29, s[16:19], s44 offen offset:0  lds
v_mfma_f32_32x32x16_bf16 v[144:159], a[212:215], a[240:243], v[144:159]
ds_read_b64_tr_b16 a[196:197], v22 offset:49152
ds_read_b64_tr_b16 a[198:199], v22 offset:50176
buffer_load_dwordx4 v30, s[16:19], s44 offen offset:1024  lds
v_mfma_f32_32x32x16_bf16 v[208:223], a[212:215], a[244:247], v[208:223]
ds_read_b64_tr_b16 a[200:201], v23 offset:49152
s_add_u32 m0, s34, 131072
s_add_u32 s44, s48, 147456
buffer_load_dwordx4 v29, s[16:19], s44 offen offset:0  lds
v_mfma_f32_32x32x16_bf16 v[96:111], a[216:219], a[236:239], v[96:111]
ds_read_b64_tr_b16 a[202:203], v23 offset:50176
ds_read_b64_tr_b16 a[204:205], v24 offset:49152
buffer_load_dwordx4 v30, s[16:19], s44 offen offset:1024  lds
v_accvgpr_write_b32 a30, 0
v_mfma_f32_32x32x16_bf16 v[160:175], a[216:219], a[240:243], v[160:175]
ds_read_b64_tr_b16 a[206:207], v24 offset:50176
s_add_u32 s48, s48, 128
s_cmp_eq_u32 s48, s49
s_cselect_b32 s48, s50, s48
s_add_u32 m0, s28, 16384
s_mov_b32 s45, s51
v_accvgpr_write_b32 a31, 0
v_mfma_f32_32x32x16_bf16 v[224:239], a[216:219], a[244:247], v[224:239]
buffer_load_dwordx4 v25, s[20:23], s45 offen offset:0 nt lds
v_accvgpr_write_b32 a32, 0
v_mfma_f32_32x32x16_bf16 v[112:127], a[220:223], a[236:239], v[112:127]
buffer_load_dwordx4 v26, s[20:23], s45 offen offset:1024 nt lds
buffer_load_dwordx4 v27, s[20:23], s45 offen offset:2048 nt lds
v_accvgpr_write_b32 a33, 0
v_mfma_f32_32x32x16_bf16 v[176:191], a[220:223], a[240:243], v[176:191]
buffer_load_dwordx4 v28, s[20:23], s45 offen offset:3072 nt lds
v_accvgpr_write_b32 a34, 0
v_mfma_f32_32x32x16_bf16 v[240:255], a[220:223], a[244:247], v[240:255]
s_add_u32 s51, s51, 262144
s_cmp_eq_u32 s51, s52
s_cselect_b32 s51, s53, s51
v_accvgpr_write_b32 a35, 0
s_waitcnt lgkmcnt(0)
v_mfma_f32_32x32x16_bf16 v[64:79], a[192:195], a[224:227], v[64:79]
v_mfma_f32_32x32x16_bf16 v[128:143], a[192:195], a[228:231], v[128:143]
ds_read_b128 a[236:239], v32 offset:0
ds_read_b128 a[240:243], v32 offset:4096
v_mfma_f32_32x32x16_bf16 v[192:207], a[192:195], a[232:235], v[192:207]
ds_read_b128 a[244:247], v32 offset:8192
ds_read_b64_tr_b16 a[208:209], v21 offset:53248
v_mfma_f32_32x32x16_bf16 v[80:95], a[196:199], a[224:227], v[80:95]
ds_read_b64_tr_b16 a[210:211], v21 offset:54272
v_mfma_f32_32x32x16_bf16 v[144:159], a[196:199], a[228:231], v[144:159]
ds_read_b64_tr_b16 a[212:213], v22 offset:53248
ds_read_b64_tr_b16 a[214:215], v22 offset:54272
v_mfma_f32_32x32x16_bf16 v[208:223], a[196:199], a[232:235], v[208:223]
ds_read_b64_tr_b16 a[216:217], v23 offset:53248
v_mfma_f32_32x32x16_bf16 v[96:111], a[200:203], a[224:227], v[96:111]
ds_read_b64_tr_b16 a[218:219], v23 offset:54272
ds_read_b64_tr_b16 a[220:221], v24 offset:53248
v_accvgpr_write_b32 a36, 0
v_mfma_f32_32x32x16_bf16 v[160:175], a[200:203], a[228:231], v[160:175]
ds_read_b64_tr_b16 a[222:223], v24 offset:54272
v_accvgpr_write_b32 a37, 0
v_mfma_f32_32x32x16_bf16 v[224:239], a[200:203], a[232:235], v[224:239]
s_add_u32 m0, s28, 0
v_accvgpr_write_b32 a38, 0
v_mfma_f32_32x32x16_bf16 v[112:127], a[204:207], a[224:227], v[112:127]
buffer_load_dwordx4 v16, s[8:11], s46 offen offset:3072 nt lds
s_add_u32 s54, s54, 8192
s_and_b32 s54, s54, 0x1ffff
v_accvgpr_write_b32 a39, 0
v_mfma_f32_32x32x16_bf16 v[176:191], a[204:207], a[228:231], v[176:191]
v_accvgpr_write_b32 a40, 0
v_mfma_f32_32x32x16_bf16 v[240:255], a[204:207], a[232:235], v[240:255]
v_accvgpr_write_b32 a41, 0
s_waitcnt lgkmcnt(0)
v_mfma_f32_32x32x16_bf16 v[64:79], a[208:211], a[236:239], v[64:79]
s_waitcnt vmcnt(17)
s_barrier
v_mfma_f32_32x32x16_bf16 v[128:143], a[208:211], a[240:243], v[128:143]
ds_read_b128 a[224:227], v33 offset:0
ds_read_b128 a[228:231], v33 offset:4096
s_add_u32 m0, s28, 49152
s_mov_b32 s45, s51
v_mfma_f32_32x32x16_bf16 v[192:207], a[208:211], a[244:247], v[192:207]
ds_read_b128 a[232:235], v33 offset:8192
ds_read_b64_tr_b16 a[192:193], v21 offset:24576
buffer_load_dwordx4 v25, s[20:23], s45 offen offset:0 nt lds
v_mfma_f32_32x32x16_bf16 v[80:95], a[212:215], a[236:239], v[80:95]
ds_read_b64_tr_b16 a[194:195], v21 offset:25600
v_mfma_f32_32x32x16_bf16 v[144:159], a[212:215], a[240:243], v[144:159]
ds_read_b64_tr_b16 a[196:197], v22 offset:24576
ds_read_b64_tr_b16 a[198:199], v22 offset:25600
buffer_load_dwordx4 v26, s[20:23], s45 offen offset:1024 nt lds
v_mfma_f32_32x32x16_bf16 v[208:223], a[212:215], a[244:247], v[208:223]
ds_read_b64_tr_b16 a[200:201], v23 offset:24576
v_mfma_f32_32x32x16_bf16 v[96:111], a[216:219], a[236:239], v[96:111]
ds_read_b64_tr_b16 a[202:203], v23 offset:25600
ds_read_b64_tr_b16 a[204:205], v24 offset:24576
buffer_load_dwordx4 v27, s[20:23], s45 offen offset:2048 nt lds
v_accvgpr_write_b32 a42, 0
v_mfma_f32_32x32x16_bf16 v[160:175], a[216:219], a[240:243], v[160:175]
ds_read_b64_tr_b16 a[206:207], v24 offset:25600
v_accvgpr_write_b32 a43, 0
v_mfma_f32_32x32x16_bf16 v[224:239], a[216:219], a[244:247], v[224:239]
buffer_load_dwordx4 v28, s[20:23], s45 offen offset:3072 nt lds
v_accvgpr_write_b32 a44, 0
v_mfma_f32_32x32x16_bf16 v[112:127], a[220:223], a[236:239], v[112:127]
v_accvgpr_write_b32 a45, 0
v_mfma_f32_32x32x16_bf16 v[176:191], a[220:223], a[240:243], v[176:191]
s_add_u32 s51, s51, 262144
s_cmp_eq_u32 s51, s52
s_cselect_b32 s51, s53, s51
v_accvgpr_write_b32 a46, 0
v_mfma_f32_32x32x16_bf16 v[240:255], a[220:223], a[244:247], v[240:255]
v_accvgpr_write_b32 a47, 0
s_waitcnt lgkmcnt(0)
v_mfma_f32_32x32x16_bf16 v[64:79], a[192:195], a[224:227], v[64:79]
v_mfma_f32_32x32x16_bf16 v[128:143], a[192:195], a[228:231], v[128:143]
ds_read_b128 a[236:239], v34 offset:0
ds_read_b128 a[240:243], v34 offset:4096
v_mfma_f32_32x32x16_bf16 v[192:207], a[192:195], a[232:235], v[192:207]
ds_read_b128 a[244:247], v34 offset:8192
ds_read_b64_tr_b16 a[208:209], v21 offset:28672
v_mfma_f32_32x32x16_bf16 v[80:95], a[196:199], a[224:227], v[80:95]
ds_read_b64_tr_b16 a[210:211], v21 offset:29696
v_mfma_f32_32x32x16_bf16 v[144:159], a[196:199], a[228:231], v[144:159]
ds_read_b64_tr_b16 a[212:213], v22 offset:28672
ds_read_b64_tr_b16 a[214:215], v22 offset:29696
v_mfma_f32_32x32x16_bf16 v[208:223], a[196:199], a[232:235], v[208:223]
ds_read_b64_tr_b16 a[216:217], v23 offset:28672
v_mfma_f32_32x32x16_bf16 v[96:111], a[200:203], a[224:227], v[96:111]
ds_read_b64_tr_b16 a[218:219], v23 offset:29696
ds_read_b64_tr_b16 a[220:221], v24 offset:28672
v_accvgpr_write_b32 a48, 0
v_mfma_f32_32x32x16_bf16 v[160:175], a[200:203], a[228:231], v[160:175]
ds_read_b64_tr_b16 a[222:223], v24 offset:29696
v_accvgpr_write_b32 a49, 0
v_mfma_f32_32x32x16_bf16 v[224:239], a[200:203], a[232:235], v[224:239]
s_add_u32 m0, s28, 32768
s_add_u32 s47, s29, s55
v_accvgpr_write_b32 a50, 0
v_mfma_f32_32x32x16_bf16 v[112:127], a[204:207], a[224:227], v[112:127]
buffer_load_dwordx4 v17, s[12:15], s47 offen offset:0 nt lds
v_accvgpr_write_b32 a51, 0
v_mfma_f32_32x32x16_bf16 v[176:191], a[204:207], a[228:231], v[176:191]
v_accvgpr_write_b32 a52, 0
v_mfma_f32_32x32x16_bf16 v[240:255], a[204:207], a[232:235], v[240:255]
v_accvgpr_write_b32 a53, 0
s_waitcnt lgkmcnt(0)
v_mfma_f32_32x32x16_bf16 v[64:79], a[208:211], a[236:239], v[64:79]
s_waitcnt vmcnt(10)
s_barrier
v_mfma_f32_32x32x16_bf16 v[128:143], a[208:211], a[240:243], v[128:143]
ds_read_b128 a[224:227], v35
ds_read_b128 a[228:231], v39
s_add_u32 m0, s34, 139264
s_add_u32 s44, s48, 0
buffer_load_dwordx4 v29, s[16:19], s44 offen offset:0  lds
v_mfma_f32_32x32x16_bf16 v[192:207], a[208:211], a[244:247], v[192:207]
ds_read_b128 a[232:235], v43
ds_read_b64_tr_b16 a[192:193], v21 offset:40960
buffer_load_dwordx4 v30, s[16:19], s44 offen offset:1024  lds
v_mfma_f32_32x32x16_bf16 v[80:95], a[212:215], a[236:239], v[80:95]
ds_read_b64_tr_b16 a[194:195], v21 offset:41984
s_add_u32 m0, s34, 147456
s_add_u32 s44, s48, 73728
buffer_load_dwordx4 v29, s[16:19], s44 offen offset:0  lds
v_mfma_f32_32x32x16_bf16 v[144:159], a[212:215], a[240:243], v[144:159]
ds_read_b64_tr_b16 a[196:197], v22 offset:40960
ds_read_b64_tr_b16 a[198:199], v22 offset:41984
buffer_load_dwordx4 v30, s[16:19], s44 offen offset:1024  lds
v_mfma_f32_32x32x16_bf16 v[208:223], a[212:215], a[244:247], v[208:223]
ds_read_b64_tr_b16 a[200:201], v23 offset:40960
s_add_u32 m0, s34, 155648
s_add_u32 s44, s48, 147456
buffer_load_dwordx4 v29, s[16:19], s44 offen offset:0  lds
v_mfma_f32_32x32x16_bf16 v[96:111], a[216:219], a[236:239], v[96:111]
ds_read_b64_tr_b16 a[202:203], v23 offset:41984
ds_read_b64_tr_b16 a[204:205], v24 offset:40960
buffer_load_dwordx4 v30, s[16:19], s44 offen offset:1024  lds
v_accvgpr_write_b32 a54, 0
v_mfma_f32_32x32x16_bf16 v[160:175], a[216:219], a[240:243], v[160:175]
ds_read_b64_tr_b16 a[206:207], v24 offset:41984
s_add_u32 s48, s48, 128
s_cmp_eq_u32 s48, s49
s_cselect_b32 s48, s50, s48
s_add_u32 m0, s28, 24576
s_mov_b32 s45, s51
v_accvgpr_write_b32 a55, 0
v_mfma_f32_32x32x16_bf16 v[224:239], a[216:219], a[244:247], v[224:239]
buffer_load_dwordx4 v25, s[20:23], s45 offen offset:0 nt lds
v_accvgpr_write_b32 a56, 0
v_mfma_f32_32x32x16_bf16 v[112:127], a[220:223], a[236:239], v[112:127]
buffer_load_dwordx4 v26, s[20:23], s45 offen offset:1024 nt lds
buffer_load_dwordx4 v27, s[20:23], s45 offen offset:2048 nt lds
v_accvgpr_write_b32 a57, 0
v_mfma_f32_32x32x16_bf16 v[176:191], a[220:223], a[240:243], v[176:191]
buffer_load_dwordx4 v28, s[20:23], s45 offen offset:3072 nt lds
v_accvgpr_write_b32 a58, 0
v_mfma_f32_32x32x16_bf16 v[240:255], a[220:223], a[244:247], v[240:255]
s_add_u32 s51, s51, 262144
s_cmp_eq_u32 s51, s52
s_cselect_b32 s51, s53, s51
v_accvgpr_write_b32 a59, 0
s_waitcnt lgkmcnt(0)
v_mfma_f32_32x32x16_bf16 v[64:79], a[192:195], a[224:227], v[64:79]
v_mfma_f32_32x32x16_bf16 v[128:143], a[192:195], a[228:231], v[128:143]
ds_read_b128 a[236:239], v36
ds_read_b128 a[240:243], v40
v_mfma_f32_32x32x16_bf16 v[192:207], a[192:195], a[232:235], v[192:207]
ds_read_b128 a[244:247], v44
ds_read_b64_tr_b16 a[208:209], v21 offset:45056
v_mfma_f32_32x32x16_bf16 v[80:95], a[196:199], a[224:227], v[80:95]
ds_read_b64_tr_b16 a[210:211], v21 offset:46080
v_mfma_f32_32x32x16_bf16 v[144:159], a[196:199], a[228:231], v[144:159]
ds_read_b64_tr_b16 a[212:213], v22 offset:45056
ds_read_b64_tr_b16 a[214:215], v22 offset:46080
v_mfma_f32_32x32x16_bf16 v[208:223], a[196:199], a[232:235], v[208:223]
ds_read_b64_tr_b16 a[216:217], v23 offset:45056
v_mfma_f32_32x32x16_bf16 v[96:111], a[200:203], a[224:227], v[96:111]
ds_read_b64_tr_b16 a[218:219], v23 offset:46080
ds_read_b64_tr_b16 a[220:221], v24 offset:45056
v_accvgpr_write_b32 a60, 0
v_mfma_f32_32x32x16_bf16 v[160:175], a[200:203], a[228:231], v[160:175]
ds_read_b64_tr_b16 a[222:223], v24 offset:46080
v_accvgpr_write_b32 a61, 0
v_mfma_f32_32x32x16_bf16 v[224:239], a[200:203], a[232:235], v[224:239]
s_add_u32 m0, s28, 32768
v_accvgpr_write_b32 a62, 0
v_mfma_f32_32x32x16_bf16 v[112:127], a[204:207], a[224:227], v[112:127]
buffer_load_dwordx4 v17, s[12:15], s47 offen offset:1024 nt lds
v_accvgpr_write_b32 a63, 0
v_mfma_f32_32x32x16_bf16 v[176:191], a[204:207], a[228:231], v[176:191]
v_accvgpr_write_b32 a64, 0
v_mfma_f32_32x32x16_bf16 v[240:255], a[204:207], a[232:235], v[240:255]
v_accvgpr_write_b32 a65, 0
s_waitcnt lgkmcnt(0)
v_mfma_f32_32x32x16_bf16 v[64:79], a[208:211], a[236:239], v[64:79]
s_waitcnt vmcnt(17)
s_barrier
v_mfma_f32_32x32x16_bf16 v[128:143], a[208:211], a[240:243], v[128:143]
ds_read_b128 a[224:227], v37
ds_read_b128 a[228:231], v41
s_add_u32 m0, s28, 40960
s_mov_b32 s45, s51
v_mfma_f32_32x32x16_bf16 v[192:207], a[208:211], a[244:247], v[192:207]
ds_read_b128 a[232:235], v45
ds_read_b64_tr_b16 a[192:193], v21 offset:16384
buffer_load_dwordx4 v25, s[20:23], s45 offen offset:0 nt lds
v_mfma_f32_32x32x16_bf16 v[80:95], a[212:215], a[236:239], v[80:95]
ds_read_b64_tr_b16 a[194:195], v21 offset:17408
v_mfma_f32_32x32x16_bf16 v[144:159], a[212:215], a[240:243], v[144:159]
ds_read_b64_tr_b16 a[196:197], v22 offset:16384
ds_read_b64_tr_b16 a[198:199], v22 offset:17408
buffer_load_dwordx4 v26, s[20:23], s45 offen offset:1024 nt lds
v_mfma_f32_32x32x16_bf16 v[208:223], a[212:215], a[244:247], v[208:223]
ds_read_b64_tr_b16 a[200:201], v23 offset:16384
v_mfma_f32_32x32x16_bf16 v[96:111], a[216:219], a[236:239], v[96:111]
ds_read_b64_tr_b16 a[202:203], v23 offset:17408
ds_read_b64_tr_b16 a[204:205], v24 offset:16384
buffer_load_dwordx4 v27, s[20:23], s45 offen offset:2048 nt lds
v_accvgpr_write_b32 a66, 0
v_mfma_f32_32x32x16_bf16 v[160:175], a[216:219], a[240:243], v[160:175]
ds_read_b64_tr_b16 a[206:207], v24 offset:17408
v_accvgpr_write_b32 a67, 0
v_mfma_f32_32x32x16_bf16 v[224:239], a[216:219], a[244:247], v[224:239]
buffer_load_dwordx4 v28, s[20:23], s45 offen offset:3072 nt lds
v_accvgpr_write_b32 a68, 0
v_mfma_f32_32x32x16_bf16 v[112:127], a[220:223], a[236:239], v[112:127]
v_accvgpr_write_b32 a69, 0
v_mfma_f32_32x32x16_bf16 v[176:191], a[220:223], a[240:243], v[176:191]
s_add_u32 s51, s51, 262144
s_cmp_eq_u32 s51, s52
s_cselect_b32 s51, s53, s51
v_accvgpr_write_b32 a70, 0
v_mfma_f32_32x32x16_bf16 v[240:255], a[220:223], a[244:247], v[240:255]
v_accvgpr_write_b32 a71, 0
s_waitcnt lgkmcnt(0)
v_mfma_f32_32x32x16_bf16 v[64:79], a[192:195], a[224:227], v[64:79]
v_mfma_f32_32x32x16_bf16 v[128:143], a[192:195], a[228:231], v[128:143]
ds_read_b128 a[236:239], v38
ds_read_b128 a[240:243], v42
v_mfma_f32_32x32x16_bf16 v[192:207], a[192:195], a[232:235], v[192:207]
ds_read_b128 a[244:247], v46
ds_read_b64_tr_b16 a[208:209], v21 offset:20480
v_mfma_f32_32x32x16_bf16 v[80:95], a[196:199], a[224:227], v[80:95]
ds_read_b64_tr_b16 a[210:211], v21 offset:21504
v_mfma_f32_32x32x16_bf16 v[144:159], a[196:199], a[228:231], v[144:159]
ds_read_b64_tr_b16 a[212:213], v22 offset:20480
ds_read_b64_tr_b16 a[214:215], v22 offset:21504
v_mfma_f32_32x32x16_bf16 v[208:223], a[196:199], a[232:235], v[208:223]
ds_read_b64_tr_b16 a[216:217], v23 offset:20480
v_mfma_f32_32x32x16_bf16 v[96:111], a[200:203], a[224:227], v[96:111]
ds_read_b64_tr_b16 a[218:219], v23 offset:21504
ds_read_b64_tr_b16 a[220:221], v24 offset:20480
v_accvgpr_write_b32 a72, 0
v_mfma_f32_32x32x16_bf16 v[160:175], a[200:203], a[228:231], v[160:175]
ds_read_b64_tr_b16 a[222:223], v24 offset:21504
v_accvgpr_write_b32 a73, 0
v_mfma_f32_32x32x16_bf16 v[224:239], a[200:203], a[232:235], v[224:239]
s_add_u32 m0, s28, 32768
v_accvgpr_write_b32 a74, 0
v_mfma_f32_32x32x16_bf16 v[112:127], a[204:207], a[224:227], v[112:127]
buffer_load_dwordx4 v17, s[12:15], s47 offen offset:2048 nt lds
v_accvgpr_write_b32 a75, 0
v_mfma_f32_32x32x16_bf16 v[176:191], a[204:207], a[228:231], v[176:191]
v_accvgpr_write_b32 a76, 0
v_mfma_f32_32x32x16_bf16 v[240:255], a[204:207], a[232:235], v[240:255]
v_accvgpr_write_b32 a77, 0
s_waitcnt lgkmcnt(0)
v_mfma_f32_32x32x16_bf16 v[64:79], a[208:211], a[236:239], v[64:79]
s_waitcnt vmcnt(10)
s_barrier
v_mfma_f32_32x32x16_bf16 v[128:143], a[208:211], a[240:243], v[128:143]
ds_read_b128 a[224:227], v31 offset:0
ds_read_b128 a[228:231], v31 offset:4096
s_add_u32 m0, s34, 57344
s_add_u32 s44, s48, 0
buffer_load_dwordx4 v29, s[16:19], s44 offen offset:0  lds
v_mfma_f32_32x32x16_bf16 v[192:207], a[208:211], a[244:247], v[192:207]
ds_read_b128 a[232:235], v31 offset:8192
ds_read_b64_tr_b16 a[192:193], v21 offset:49152
buffer_load_dwordx4 v30, s[16:19], s44 offen offset:1024  lds
v_mfma_f32_32x32x16_bf16 v[80:95], a[212:215], a[236:239], v[80:95]
ds_read_b64_tr_b16 a[194:195], v21 offset:50176
s_add_u32 m0, s34, 122880
s_add_u32 s44, s48, 73728
buffer_load_dwordx4 v29, s[16:19], s44 offen offset:0  lds
v_mfma_f32_32x32x16_bf16 v[144:159], a[212:215], a[240:243], v[144:159]
ds_read_b64_tr_b16 a[196:197], v22 offset:49152
ds_read_b64_tr_b16 a[198:199], v22 offset:50176
buffer_load_dwordx4 v30, s[16:19], s44 offen offset:1024  lds
v_mfma_f32_32x32x16_bf16 v[208:223], a[212:215], a[244:247], v[208:223]
ds_read_b64_tr_b16 a[200:201], v23 offset:49152
s_add_u32 m0, s34, 131072
s_add_u32 s44, s48, 147456
buffer_load_dwordx4 v29, s[16:19], s44 offen offset:0  lds
v_mfma_f32_32x32x16_bf16 v[96:111], a[216:219], a[236:239], v[96:111]
ds_read_b64_tr_b16 a[202:203], v23 offset:50176
ds_read_b64_tr_b16 a[204:205], v24 offset:49152
buffer_load_dwordx4 v30, s[16:19], s44 offen offset:1024  lds
v_accvgpr_write_b32 a78, 0
v_mfma_f32_32x32x16_bf16 v[160:175], a[216:219], a[240:243], v[160:175]
ds_read_b64_tr_b16 a[206:207], v24 offset:50176
s_add_u32 s48, s48, 128
s_cmp_eq_u32 s48, s49
s_cselect_b32 s48, s50, s48
s_add_u32 m0, s28, 16384
s_mov_b32 s45, s51
v_accvgpr_write_b32 a79, 0
v_mfma_f32_32x32x16_bf16 v[224:239], a[216:219], a[244:247], v[224:239]
buffer_load_dwordx4 v25, s[20:23], s45 offen offset:0 nt lds
v_accvgpr_write_b32 a80, 0
v_mfma_f32_32x32x16_bf16 v[112:127], a[220:223], a[236:239], v[112:127]
buffer_load_dwordx4 v26, s[20:23], s45 offen offset:1024 nt lds
buffer_load_dwordx4 v27, s[20:23], s45 offen offset:2048 nt lds
v_accvgpr_write_b32 a81, 0
v_mfma_f32_32x32x16_bf16 v[176:191], a[220:223], a[240:243], v[176:191]
buffer_load_dwordx4 v28, s[20:23], s45 offen offset:3072 nt lds
v_accvgpr_write_b32 a82, 0
v_mfma_f32_32x32x16_bf16 v[240:255], a[220:223], a[244:247], v[240:255]
s_add_u32 s51, s51, 262144
s_cmp_eq_u32 s51, s52
s_cselect_b32 s51, s53, s51
v_accvgpr_write_b32 a83, 0
s_waitcnt lgkmcnt(0)
v_mfma_f32_32x32x16_bf16 v[64:79], a[192:195], a[224:227], v[64:79]
v_mfma_f32_32x32x16_bf16 v[128:143], a[192:195], a[228:231], v[128:143]
ds_read_b128 a[236:239], v32 offset:0
ds_read_b128 a[240:243], v32 offset:4096
v_mfma_f32_32x32x16_bf16 v[192:207], a[192:195], a[232:235], v[192:207]
ds_read_b128 a[244:247], v32 offset:8192
ds_read_b64_tr_b16 a[208:209], v21 offset:53248
v_mfma_f32_32x32x16_bf16 v[80:95], a[196:199], a[224:227], v[80:95]
ds_read_b64_tr_b16 a[210:211], v21 offset:54272
v_mfma_f32_32x32x16_bf16 v[144:159], a[196:199], a[228:231], v[144:159]
ds_read_b64_tr_b16 a[212:213], v22 offset:53248
ds_read_b64_tr_b16 a[214:215], v22 offset:54272
v_mfma_f32_32x32x16_bf16 v[208:223], a[196:199], a[232:235], v[208:223]
ds_read_b64_tr_b16 a[216:217], v23 offset:53248
v_mfma_f32_32x32x16_bf16 v[96:111], a[200:203], a[224:227], v[96:111]
ds_read_b64_tr_b16 a[218:219], v23 offset:54272
ds_read_b64_tr_b16 a[220:221], v24 offset:53248
v_accvgpr_write_b32 a84, 0
v_mfma_f32_32x32x16_bf16 v[160:175], a[200:203], a[228:231], v[160:175]
ds_read_b64_tr_b16 a[222:223], v24 offset:54272
v_accvgpr_write_b32 a85, 0
v_mfma_f32_32x32x16_bf16 v[224:239], a[200:203], a[232:235], v[224:239]
s_add_u32 m0, s28, 32768
v_accvgpr_write_b32 a86, 0
v_mfma_f32_32x32x16_bf16 v[112:127], a[204:207], a[224:227], v[112:127]
buffer_load_dwordx4 v17, s[12:15], s47 offen offset:3072 nt lds
s_add_u32 s55, s55, 8192
s_and_b32 s55, s55, 0x1ffff
v_accvgpr_write_b32 a87, 0
v_mfma_f32_32x32x16_bf16 v[176:191], a[204:207], a[228:231], v[176:191]
v_accvgpr_write_b32 a88, 0
v_mfma_f32_32x32x16_bf16 v[240:255], a[204:207], a[232:235], v[240:255]
v_accvgpr_write_b32 a89, 0
s_waitcnt lgkmcnt(0)
v_mfma_f32_32x32x16_bf16 v[64:79], a[208:211], a[236:239], v[64:79]
s_waitcnt vmcnt(17)
s_barrier
v_mfma_f32_32x32x16_bf16 v[128:143], a[208:211], a[240:243], v[128:143]
ds_read_b128 a[224:227], v33 offset:0
ds_read_b128 a[228:231], v33 offset:4096
s_add_u32 m0, s28, 49152
s_mov_b32 s45, s51
v_mfma_f32_32x32x16_bf16 v[192:207], a[208:211], a[244:247], v[192:207]
ds_read_b128 a[232:235], v33 offset:8192
ds_read_b64_tr_b16 a[192:193], v21 offset:24576
buffer_load_dwordx4 v25, s[20:23], s45 offen offset:0 nt lds
v_mfma_f32_32x32x16_bf16 v[80:95], a[212:215], a[236:239], v[80:95]
ds_read_b64_tr_b16 a[194:195], v21 offset:25600
v_mfma_f32_32x32x16_bf16 v[144:159], a[212:215], a[240:243], v[144:159]
ds_read_b64_tr_b16 a[196:197], v22 offset:24576
ds_read_b64_tr_b16 a[198:199], v22 offset:25600
buffer_load_dwordx4 v26, s[20:23], s45 offen offset:1024 nt lds
v_mfma_f32_32x32x16_bf16 v[208:223], a[212:215], a[244:247], v[208:223]
ds_read_b64_tr_b16 a[200:201], v23 offset:24576
v_mfma_f32_32x32x16_bf16 v[96:111], a[216:219], a[236:239], v[96:111]
ds_read_b64_tr_b16 a[202:203], v23 offset:25600
ds_read_b64_tr_b16 a[204:205], v24 offset:24576
buffer_load_dwordx4 v27, s[20:23], s45 offen offset:2048 nt lds
v_accvgpr_write_b32 a90, 0
v_mfma_f32_32x32x16_bf16 v[160:175], a[216:219], a[240:243], v[160:175]
ds_read_b64_tr_b16 a[206:207], v24 offset:25600
v_accvgpr_write_b32 a91, 0
v_mfma_f32_32x32x16_bf16 v[224:239], a[216:219], a[244:247], v[224:239]
buffer_load_dwordx4 v28, s[20:23], s45 offen offset:3072 nt lds
v_accvgpr_write_b32 a92, 0
v_mfma_f32_32x32x16_bf16 v[112:127], a[220:223], a[236:239], v[112:127]
v_accvgpr_write_b32 a93, 0
v_mfma_f32_32x32x16_bf16 v[176:191], a[220:223], a[240:243], v[176:191]
s_add_u32 s51, s51, 262144
s_cmp_eq_u32 s51, s52
s_cselect_b32 s51, s53, s51
v_accvgpr_write_b32 a94, 0
v_mfma_f32_32x32x16_bf16 v[240:255], a[220:223], a[244:247], v[240:255]
v_accvgpr_write_b32 a95, 0
s_waitcnt lgkmcnt(0)
v_mfma_f32_32x32x16_bf16 v[64:79], a[192:195], a[224:227], v[64:79]
v_mfma_f32_32x32x16_bf16 v[128:143], a[192:195], a[228:231], v[128:143]
ds_read_b128 a[236:239], v34 offset:0
ds_read_b128 a[240:243], v34 offset:4096
v_mfma_f32_32x32x16_bf16 v[192:207], a[192:195], a[232:235], v[192:207]
ds_read_b128 a[244:247], v34 offset:8192
ds_read_b64_tr_b16 a[208:209], v21 offset:28672
v_mfma_f32_32x32x16_bf16 v[80:95], a[196:199], a[224:227], v[80:95]
ds_read_b64_tr_b16 a[210:211], v21 offset:29696
v_mfma_f32_32x32x16_bf16 v[144:159], a[196:199], a[228:231], v[144:159]
ds_read_b64_tr_b16 a[212:213], v22 offset:28672
ds_read_b64_tr_b16 a[214:215], v22 offset:29696
v_mfma_f32_32x32x16_bf16 v[208:223], a[196:199], a[232:235], v[208:223]
ds_read_b64_tr_b16 a[216:217], v23 offset:28672
v_mfma_f32_32x32x16_bf16 v[96:111], a[200:203], a[224:227], v[96:111]
ds_read_b64_tr_b16 a[218:219], v23 offset:29696
ds_read_b64_tr_b16 a[220:221], v24 offset:28672
v_accvgpr_write_b32 a96, 0
v_mfma_f32_32x32x16_bf16 v[160:175], a[200:203], a[228:231], v[160:175]
ds_read_b64_tr_b16 a[222:223], v24 offset:29696
v_accvgpr_write_b32 a97, 0
v_mfma_f32_32x32x16_bf16 v[224:239], a[200:203], a[232:235], v[224:239]
s_add_u32 m0, s28, 8192
s_add_u32 s46, s29, s54
v_accvgpr_write_b32 a98, 0
v_mfma_f32_32x32x16_bf16 v[112:127], a[204:207], a[224:227], v[112:127]
buffer_load_dwordx4 v13, s[8:11], s46 offen offset:0 nt lds
v_accvgpr_write_b32 a99, 0
v_mfma_f32_32x32x16_bf16 v[176:191], a[204:207], a[228:231], v[176:191]
v_accvgpr_write_b32 a100, 0
v_mfma_f32_32x32x16_bf16 v[240:255], a[204:207], a[232:235], v[240:255]
v_accvgpr_write_b32 a101, 0
s_waitcnt lgkmcnt(0)
v_mfma_f32_32x32x16_bf16 v[64:79], a[208:211], a[236:239], v[64:79]
s_waitcnt vmcnt(10)
s_barrier
v_mfma_f32_32x32x16_bf16 v[128:143], a[208:211], a[240:243], v[128:143]
ds_read_b128 a[224:227], v35
ds_read_b128 a[228:231], v39
s_add_u32 m0, s34, 139264
s_add_u32 s44, s48, 0
buffer_load_dwordx4 v29, s[16:19], s44 offen offset:0  lds
v_mfma_f32_32x32x16_bf16 v[192:207], a[208:211], a[244:247], v[192:207]
ds_read_b128 a[232:235], v43
ds_read_b64_tr_b16 a[192:193], v21 offset:40960
buffer_load_dwordx4 v30, s[16:19], s44 offen offset:1024  lds
v_mfma_f32_32x32x16_bf16 v[80:95], a[212:215], a[236:239], v[80:95]
ds_read_b64_tr_b16 a[194:195], v21 offset:41984
s_add_u32 m0, s34, 147456
s_add_u32 s44, s48, 73728
buffer_load_dwordx4 v29, s[16:19], s44 offen offset:0  lds
v_mfma_f32_32x32x16_bf16 v[144:159], a[212:215], a[240:243], v[144:159]
ds_read_b64_tr_b16 a[196:197], v22 offset:40960
ds_read_b64_tr_b16 a[198:199], v22 offset:41984
buffer_load_dwordx4 v30, s[16:19], s44 offen offset:1024  lds
v_mfma_f32_32x32x16_bf16 v[208:223], a[212:215], a[244:247], v[208:223]
ds_read_b64_tr_b16 a[200:201], v23 offset:40960
s_add_u32 m0, s34, 155648
s_add_u32 s44, s48, 147456
buffer_load_dwordx4 v29, s[16:19], s44 offen offset:0  lds
v_mfma_f32_32x32x16_bf16 v[96:111], a[216:219], a[236:239], v[96:111]
ds_read_b64_tr_b16 a[202:203], v23 offset:41984
ds_read_b64_tr_b16 a[204:205], v24 offset:40960
buffer_load_dwordx4 v30, s[16:19], s44 offen offset:1024  lds
v_accvgpr_write_b32 a102, 0
v_mfma_f32_32x32x16_bf16 v[160:175], a[216:219], a[240:243], v[160:175]
ds_read_b64_tr_b16 a[206:207], v24 offset:41984
s_add_u32 s48, s48, 128
s_cmp_eq_u32 s48, s49
s_cselect_b32 s48, s50, s48
s_add_u32 m0, s28, 24576
s_mov_b32 s45, s51
v_accvgpr_write_b32 a103, 0
v_mfma_f32_32x32x16_bf16 v[224:239], a[216:219], a[244:247], v[224:239]
buffer_load_dwordx4 v25, s[20:23], s45 offen offset:0 nt lds
v_accvgpr_write_b32 a104, 0
v_mfma_f32_32x32x16_bf16 v[112:127], a[220:223], a[236:239], v[112:127]
buffer_load_dwordx4 v26, s[20:23], s45 offen offset:1024 nt lds
buffer_load_dwordx4 v27, s[20:23], s45 offen offset:2048 nt lds
v_accvgpr_write_b32 a105, 0
v_mfma_f32_32x32x16_bf16 v[176:191], a[220:223], a[240:243], v[176:191]
buffer_load_dwordx4 v28, s[20:23], s45 offen offset:3072 nt lds
v_accvgpr_write_b32 a106, 0
v_mfma_f32_32x32x16_bf16 v[240:255], a[220:223], a[244:247], v[240:255]
s_add_u32 s51, s51, 262144
s_cmp_eq_u32 s51, s52
s_cselect_b32 s51, s53, s51
v_accvgpr_write_b32 a107, 0
s_waitcnt lgkmcnt(0)
v_mfma_f32_32x32x16_bf16 v[64:79], a[192:195], a[224:227], v[64:79]
v_mfma_f32_32x32x16_bf16 v[128:143], a[192:195], a[228:231], v[128:143]
ds_read_b128 a[236:239], v36
ds_read_b128 a[240:243], v40
v_mfma_f32_32x32x16_bf16 v[192:207], a[192:195], a[232:235], v[192:207]
ds_read_b128 a[244:247], v44
ds_read_b64_tr_b16 a[208:209], v21 offset:45056
v_mfma_f32_32x32x16_bf16 v[80:95], a[196:199], a[224:227], v[80:95]
ds_read_b64_tr_b16 a[210:211], v21 offset:46080
v_mfma_f32_32x32x16_bf16 v[144:159], a[196:199], a[228:231], v[144:159]
ds_read_b64_tr_b16 a[212:213], v22 offset:45056
ds_read_b64_tr_b16 a[214:215], v22 offset:46080
v_mfma_f32_32x32x16_bf16 v[208:223], a[196:199], a[232:235], v[208:223]
ds_read_b64_tr_b16 a[216:217], v23 offset:45056
v_mfma_f32_32x32x16_bf16 v[96:111], a[200:203], a[224:227], v[96:111]
ds_read_b64_tr_b16 a[218:219], v23 offset:46080
ds_read_b64_tr_b16 a[220:221], v24 offset:45056
v_accvgpr_write_b32 a108, 0
v_mfma_f32_32x32x16_bf16 v[160:175], a[200:203], a[228:231], v[160:175]
ds_read_b64_tr_b16 a[222:223], v24 offset:46080
v_accvgpr_write_b32 a109, 0
v_mfma_f32_32x32x16_bf16 v[224:239], a[200:203], a[232:235], v[224:239]
s_add_u32 m0, s28, 8192
v_accvgpr_write_b32 a110, 0
v_mfma_f32_32x32x16_bf16 v[112:127], a[204:207], a[224:227], v[112:127]
buffer_load_dwordx4 v14, s[8:11], s46 offen offset:1024 nt lds
v_accvgpr_write_b32 a111, 0
v_mfma_f32_32x32x16_bf16 v[176:191], a[204:207], a[228:231], v[176:191]
v_accvgpr_write_b32 a112, 0
v_mfma_f32_32x32x16_bf16 v[240:255], a[204:207], a[232:235], v[240:255]
v_accvgpr_write_b32 a113, 0
s_waitcnt lgkmcnt(0)
v_mfma_f32_32x32x16_bf16 v[64:79], a[208:211], a[236:239], v[64:79]
s_waitcnt vmcnt(17)
s_barrier
v_mfma_f32_32x32x16_bf16 v[128:143], a[208:211], a[240:243], v[128:143]
ds_read_b128 a[224:227], v37
ds_read_b128 a[228:231], v41
s_add_u32 m0, s28, 40960
s_mov_b32 s45, s51
v_mfma_f32_32x32x16_bf16 v[192:207], a[208:211], a[244:247], v[192:207]
ds_read_b128 a[232:235], v45
ds_read_b64_tr_b16 a[192:193], v21 offset:16384
buffer_load_dwordx4 v25, s[20:23], s45 offen offset:0 nt lds
v_mfma_f32_32x32x16_bf16 v[80:95], a[212:215], a[236:239], v[80:95]
ds_read_b64_tr_b16 a[194:195], v21 offset:17408
v_mfma_f32_32x32x16_bf16 v[144:159], a[212:215], a[240:243], v[144:159]
ds_read_b64_tr_b16 a[196:197], v22 offset:16384
ds_read_b64_tr_b16 a[198:199], v22 offset:17408
buffer_load_dwordx4 v26, s[20:23], s45 offen offset:1024 nt lds
v_mfma_f32_32x32x16_bf16 v[208:223], a[212:215], a[244:247], v[208:223]
ds_read_b64_tr_b16 a[200:201], v23 offset:16384
v_mfma_f32_32x32x16_bf16 v[96:111], a[216:219], a[236:239], v[96:111]
ds_read_b64_tr_b16 a[202:203], v23 offset:17408
ds_read_b64_tr_b16 a[204:205], v24 offset:16384
buffer_load_dwordx4 v27, s[20:23], s45 offen offset:2048 nt lds
v_accvgpr_write_b32 a114, 0
v_mfma_f32_32x32x16_bf16 v[160:175], a[216:219], a[240:243], v[160:175]
ds_read_b64_tr_b16 a[206:207], v24 offset:17408
v_accvgpr_write_b32 a115, 0
v_mfma_f32_32x32x16_bf16 v[224:239], a[216:219], a[244:247], v[224:239]
buffer_load_dwordx4 v28, s[20:23], s45 offen offset:3072 nt lds
v_accvgpr_write_b32 a116, 0
v_mfma_f32_32x32x16_bf16 v[112:127], a[220:223], a[236:239], v[112:127]
v_accvgpr_write_b32 a117, 0
v_mfma_f32_32x32x16_bf16 v[176:191], a[220:223], a[240:243], v[176:191]
s_add_u32 s51, s51, 262144
s_cmp_eq_u32 s51, s52
s_cselect_b32 s51, s53, s51
v_accvgpr_write_b32 a118, 0
v_mfma_f32_32x32x16_bf16 v[240:255], a[220:223], a[244:247], v[240:255]
v_accvgpr_write_b32 a119, 0
s_waitcnt lgkmcnt(0)
v_mfma_f32_32x32x16_bf16 v[64:79], a[192:195], a[224:227], v[64:79]
v_mfma_f32_32x32x16_bf16 v[128:143], a[192:195], a[228:231], v[128:143]
ds_read_b128 a[236:239], v38
ds_read_b128 a[240:243], v42
v_mfma_f32_32x32x16_bf16 v[192:207], a[192:195], a[232:235], v[192:207]
ds_read_b128 a[244:247], v46
ds_read_b64_tr_b16 a[208:209], v21 offset:20480
v_mfma_f32_32x32x16_bf16 v[80:95], a[196:199], a[224:227], v[80:95]
ds_read_b64_tr_b16 a[210:211], v21 offset:21504
v_mfma_f32_32x32x16_bf16 v[144:159], a[196:199], a[228:231], v[144:159]
ds_read_b64_tr_b16 a[212:213], v22 offset:20480
ds_read_b64_tr_b16 a[214:215], v22 offset:21504
v_mfma_f32_32x32x16_bf16 v[208:223], a[196:199], a[232:235], v[208:223]
ds_read_b64_tr_b16 a[216:217], v23 offset:20480
v_mfma_f32_32x32x16_bf16 v[96:111], a[200:203], a[224:227], v[96:111]
ds_read_b64_tr_b16 a[218:219], v23 offset:21504
ds_read_b64_tr_b16 a[220:221], v24 offset:20480
v_accvgpr_write_b32 a120, 0
v_mfma_f32_32x32x16_bf16 v[160:175], a[200:203], a[228:231], v[160:175]
ds_read_b64_tr_b16 a[222:223], v24 offset:21504
v_accvgpr_write_b32 a121, 0
v_mfma_f32_32x32x16_bf16 v[224:239], a[200:203], a[232:235], v[224:239]
s_add_u32 m0, s28, 8192
v_accvgpr_write_b32 a122, 0
v_mfma_f32_32x32x16_bf16 v[112:127], a[204:207], a[224:227], v[112:127]
buffer_load_dwordx4 v15, s[8:11], s46 offen offset:2048 nt lds
v_accvgpr_write_b32 a123, 0
v_mfma_f32_32x32x16_bf16 v[176:191], a[204:207], a[228:231], v[176:191]
v_accvgpr_write_b32 a124, 0
v_mfma_f32_32x32x16_bf16 v[240:255], a[204:207], a[232:235], v[240:255]
v_accvgpr_write_b32 a125, 0
s_waitcnt lgkmcnt(0)
v_mfma_f32_32x32x16_bf16 v[64:79], a[208:211], a[236:239], v[64:79]
s_waitcnt vmcnt(10)
s_barrier
v_mfma_f32_32x32x16_bf16 v[128:143], a[208:211], a[240:243], v[128:143]
ds_read_b128 a[224:227], v31 offset:0
ds_read_b128 a[228:231], v31 offset:4096
s_add_u32 m0, s34, 57344
s_add_u32 s44, s48, 0
buffer_load_dwordx4 v29, s[16:19], s44 offen offset:0  lds
v_mfma_f32_32x32x16_bf16 v[192:207], a[208:211], a[244:247], v[192:207]
ds_read_b128 a[232:235], v31 offset:8192
ds_read_b64_tr_b16 a[192:193], v21 offset:49152
buffer_load_dwordx4 v30, s[16:19], s44 offen offset:1024  lds
v_mfma_f32_32x32x16_bf16 v[80:95], a[212:215], a[236:239], v[80:95]
ds_read_b64_tr_b16 a[194:195], v21 offset:50176
s_add_u32 m0, s34, 122880
s_add_u32 s44, s48, 73728
buffer_load_dwordx4 v29, s[16:19], s44 offen offset:0  lds
v_mfma_f32_32x32x16_bf16 v[144:159], a[212:215], a[240:243], v[144:159]
ds_read_b64_tr_b16 a[196:197], v22 offset:49152
ds_read_b64_tr_b16 a[198:199], v22 offset:50176
buffer_load_dwordx4 v30, s[16:19], s44 offen offset:1024  lds
v_mfma_f32_32x32x16_bf16 v[208:223], a[212:215], a[244:247], v[208:223]
ds_read_b64_tr_b16 a[200:201], v23 offset:49152
s_add_u32 m0, s34, 131072
s_add_u32 s44, s48, 147456
buffer_load_dwordx4 v29, s[16:19], s44 offen offset:0  lds
v_mfma_f32_32x32x16_bf16 v[96:111], a[216:219], a[236:239], v[96:111]
ds_read_b64_tr_b16 a[202:203], v23 offset:50176
ds_read_b64_tr_b16 a[204:205], v24 offset:49152
buffer_load_dwordx4 v30, s[16:19], s44 offen offset:1024  lds
v_accvgpr_write_b32 a126, 0
v_mfma_f32_32x32x16_bf16 v[160:175], a[216:219], a[240:243], v[160:175]
ds_read_b64_tr_b16 a[206:207], v24 offset:50176
s_add_u32 s48, s48, 128
s_cmp_eq_u32 s48, s49
s_cselect_b32 s48, s50, s48
s_add_u32 m0, s28, 16384
s_mov_b32 s45, s51
v_accvgpr_write_b32 a127, 0
v_mfma_f32_32x32x16_bf16 v[224:239], a[216:219], a[244:247], v[224:239]
buffer_load_dwordx4 v25, s[20:23], s45 offen offset:0 nt lds
v_accvgpr_write_b32 a128, 0
v_mfma_f32_32x32x16_bf16 v[112:127], a[220:223], a[236:239], v[112:127]
buffer_load_dwordx4 v26, s[20:23], s45 offen offset:1024 nt lds
buffer_load_dwordx4 v27, s[20:23], s45 offen offset:2048 nt lds
v_accvgpr_write_b32 a129, 0
v_mfma_f32_32x32x16_bf16 v[176:191], a[220:223], a[240:243], v[176:191]
buffer_load_dwordx4 v28, s[20:23], s45 offen offset:3072 nt lds
v_accvgpr_write_b32 a130, 0
v_mfma_f32_32x32x16_bf16 v[240:255], a[220:223], a[244:247], v[240:255]
s_add_u32 s51, s51, 262144
s_cmp_eq_u32 s51, s52
s_cselect_b32 s51, s53, s51
v_accvgpr_write_b32 a131, 0
s_waitcnt lgkmcnt(0)
v_mfma_f32_32x32x16_bf16 v[64:79], a[192:195], a[224:227], v[64:79]
v_mfma_f32_32x32x16_bf16 v[128:143], a[192:195], a[228:231], v[128:143]
ds_read_b128 a[236:239], v32 offset:0
ds_read_b128 a[240:243], v32 offset:4096
v_mfma_f32_32x32x16_bf16 v[192:207], a[192:195], a[232:235], v[192:207]
ds_read_b128 a[244:247], v32 offset:8192
ds_read_b64_tr_b16 a[208:209], v21 offset:53248
v_mfma_f32_32x32x16_bf16 v[80:95], a[196:199], a[224:227], v[80:95]
ds_read_b64_tr_b16 a[210:211], v21 offset:54272
v_mfma_f32_32x32x16_bf16 v[144:159], a[196:199], a[228:231], v[144:159]
ds_read_b64_tr_b16 a[212:213], v22 offset:53248
ds_read_b64_tr_b16 a[214:215], v22 offset:54272
v_mfma_f32_32x32x16_bf16 v[208:223], a[196:199], a[232:235], v[208:223]
ds_read_b64_tr_b16 a[216:217], v23 offset:53248
v_mfma_f32_32x32x16_bf16 v[96:111], a[200:203], a[224:227], v[96:111]
ds_read_b64_tr_b16 a[218:219], v23 offset:54272
ds_read_b64_tr_b16 a[220:221], v24 offset:53248
v_accvgpr_write_b32 a132, 0
v_mfma_f32_32x32x16_bf16 v[160:175], a[200:203], a[228:231], v[160:175]
ds_read_b64_tr_b16 a[222:223], v24 offset:54272
v_accvgpr_write_b32 a133, 0
v_mfma_f32_32x32x16_bf16 v[224:239], a[200:203], a[232:235], v[224:239]
s_add_u32 m0, s28, 8192
v_accvgpr_write_b32 a134, 0
v_mfma_f32_32x32x16_bf16 v[112:127], a[204:207], a[224:227], v[112:127]
buffer_load_dwordx4 v16, s[8:11], s46 offen offset:3072 nt lds
s_add_u32 s54, s54, 8192
s_and_b32 s54, s54, 0x1ffff
v_accvgpr_write_b32 a135, 0
v_mfma_f32_32x32x16_bf16 v[176:191], a[204:207], a[228:231], v[176:191]
v_accvgpr_write_b32 a136, 0
v_mfma_f32_32x32x16_bf16 v[240:255], a[204:207], a[232:235], v[240:255]
v_accvgpr_write_b32 a137, 0
s_waitcnt lgkmcnt(0)
v_mfma_f32_32x32x16_bf16 v[64:79], a[208:211], a[236:239], v[64:79]
s_waitcnt vmcnt(17)
s_barrier
v_mfma_f32_32x32x16_bf16 v[128:143], a[208:211], a[240:243], v[128:143]
ds_read_b128 a[224:227], v33 offset:0
ds_read_b128 a[228:231], v33 offset:4096
s_add_u32 m0, s28, 49152
s_mov_b32 s45, s51
v_mfma_f32_32x32x16_bf16 v[192:207], a[208:211], a[244:247], v[192:207]
ds_read_b128 a[232:235], v33 offset:8192
ds_read_b64_tr_b16 a[192:193], v21 offset:24576
buffer_load_dwordx4 v25, s[20:23], s45 offen offset:0 nt lds
v_mfma_f32_32x32x16_bf16 v[80:95], a[212:215], a[236:239], v[80:95]
ds_read_b64_tr_b16 a[194:195], v21 offset:25600
v_mfma_f32_32x32x16_bf16 v[144:159], a[212:215], a[240:243], v[144:159]
ds_read_b64_tr_b16 a[196:197], v22 offset:24576
ds_read_b64_tr_b16 a[198:199], v22 offset:25600
buffer_load_dwordx4 v26, s[20:23], s45 offen offset:1024 nt lds
v_mfma_f32_32x32x16_bf16 v[208:223], a[212:215], a[244:247], v[208:223]
ds_read_b64_tr_b16 a[200:201], v23 offset:24576
v_mfma_f32_32x32x16_bf16 v[96:111], a[216:219], a[236:239], v[96:111]
ds_read_b64_tr_b16 a[202:203], v23 offset:25600
ds_read_b64_tr_b16 a[204:205], v24 offset:24576
buffer_load_dwordx4 v27, s[20:23], s45 offen offset:2048 nt lds
v_accvgpr_write_b32 a138, 0
v_mfma_f32_32x32x16_bf16 v[160:175], a[216:219], a[240:243], v[160:175]
ds_read_b64_tr_b16 a[206:207], v24 offset:25600
v_accvgpr_write_b32 a139, 0
v_mfma_f32_32x32x16_bf16 v[224:239], a[216:219], a[244:247], v[224:239]
buffer_load_dwordx4 v28, s[20:23], s45 offen offset:3072 nt lds
v_accvgpr_write_b32 a140, 0
v_mfma_f32_32x32x16_bf16 v[112:127], a[220:223], a[236:239], v[112:127]
v_accvgpr_write_b32 a141, 0
v_mfma_f32_32x32x16_bf16 v[176:191], a[220:223], a[240:243], v[176:191]
s_add_u32 s51, s51, 262144
s_cmp_eq_u32 s51, s52
s_cselect_b32 s51, s53, s51
v_accvgpr_write_b32 a142, 0
v_mfma_f32_32x32x16_bf16 v[240:255], a[220:223], a[244:247], v[240:255]
v_accvgpr_write_b32 a143, 0
s_waitcnt lgkmcnt(0)
v_mfma_f32_32x32x16_bf16 v[64:79], a[192:195], a[224:227], v[64:79]
v_mfma_f32_32x32x16_bf16 v[128:143], a[192:195], a[228:231], v[128:143]
ds_read_b128 a[236:239], v34 offset:0
ds_read_b128 a[240:243], v34 offset:4096
v_mfma_f32_32x32x16_bf16 v[192:207], a[192:195], a[232:235], v[192:207]
ds_read_b128 a[244:247], v34 offset:8192
ds_read_b64_tr_b16 a[208:209], v21 offset:28672
v_mfma_f32_32x32x16_bf16 v[80:95], a[196:199], a[224:227], v[80:95]
ds_read_b64_tr_b16 a[210:211], v21 offset:29696
v_mfma_f32_32x32x16_bf16 v[144:159], a[196:199], a[228:231], v[144:159]
ds_read_b64_tr_b16 a[212:213], v22 offset:28672
ds_read_b64_tr_b16 a[214:215], v22 offset:29696
v_mfma_f32_32x32x16_bf16 v[208:223], a[196:199], a[232:235], v[208:223]
ds_read_b64_tr_b16 a[216:217], v23 offset:28672
v_mfma_f32_32x32x16_bf16 v[96:111], a[200:203], a[224:227], v[96:111]
ds_read_b64_tr_b16 a[218:219], v23 offset:29696
ds_read_b64_tr_b16 a[220:221], v24 offset:28672
v_accvgpr_write_b32 a144, 0
v_mfma_f32_32x32x16_bf16 v[160:175], a[200:203], a[228:231], v[160:175]
ds_read_b64_tr_b16 a[222:223], v24 offset:29696
v_accvgpr_write_b32 a145, 0
v_mfma_f32_32x32x16_bf16 v[224:239], a[200:203], a[232:235], v[224:239]
v_accvgpr_write_b32 a146, 0
v_mfma_f32_32x32x16_bf16 v[112:127], a[204:207], a[224:227], v[112:127]
v_accvgpr_write_b32 a147, 0
v_mfma_f32_32x32x16_bf16 v[176:191], a[204:207], a[228:231], v[176:191]
v_accvgpr_write_b32 a148, 0
v_mfma_f32_32x32x16_bf16 v[240:255], a[204:207], a[232:235], v[240:255]
v_accvgpr_write_b32 a149, 0
s_waitcnt lgkmcnt(0)
v_mfma_f32_32x32x16_bf16 v[64:79], a[208:211], a[236:239], v[64:79]
s_waitcnt vmcnt(9)
s_barrier
v_mfma_f32_32x32x16_bf16 v[128:143], a[208:211], a[240:243], v[128:143]
ds_read_b128 a[224:227], v35
ds_read_b128 a[228:231], v39
s_add_u32 m0, s34, 139264
s_add_u32 s44, s48, 0
buffer_load_dwordx4 v29, s[16:19], s44 offen offset:0  lds
v_mfma_f32_32x32x16_bf16 v[192:207], a[208:211], a[244:247], v[192:207]
ds_read_b128 a[232:235], v43
ds_read_b64_tr_b16 a[192:193], v21 offset:40960
buffer_load_dwordx4 v30, s[16:19], s44 offen offset:1024  lds
v_mfma_f32_32x32x16_bf16 v[80:95], a[212:215], a[236:239], v[80:95]
ds_read_b64_tr_b16 a[194:195], v21 offset:41984
s_add_u32 m0, s34, 147456
s_add_u32 s44, s48, 73728
buffer_load_dwordx4 v29, s[16:19], s44 offen offset:0  lds
v_mfma_f32_32x32x16_bf16 v[144:159], a[212:215], a[240:243], v[144:159]
ds_read_b64_tr_b16 a[196:197], v22 offset:40960
ds_read_b64_tr_b16 a[198:199], v22 offset:41984
buffer_load_dwordx4 v30, s[16:19], s44 offen offset:1024  lds
v_mfma_f32_32x32x16_bf16 v[208:223], a[212:215], a[244:247], v[208:223]
ds_read_b64_tr_b16 a[200:201], v23 offset:40960
s_add_u32 m0, s34, 155648
s_add_u32 s44, s48, 147456
buffer_load_dwordx4 v29, s[16:19], s44 offen offset:0  lds
v_mfma_f32_32x32x16_bf16 v[96:111], a[216:219], a[236:239], v[96:111]
ds_read_b64_tr_b16 a[202:203], v23 offset:41984
ds_read_b64_tr_b16 a[204:205], v24 offset:40960
buffer_load_dwordx4 v30, s[16:19], s44 offen offset:1024  lds
v_accvgpr_write_b32 a150, 0
v_mfma_f32_32x32x16_bf16 v[160:175], a[216:219], a[240:243], v[160:175]
ds_read_b64_tr_b16 a[206:207], v24 offset:41984
s_add_u32 s48, s48, 128
s_cmp_eq_u32 s48, s49
s_cselect_b32 s48, s50, s48
s_add_u32 m0, s28, 24576
s_mov_b32 s45, s51
v_accvgpr_write_b32 a151, 0
v_mfma_f32_32x32x16_bf16 v[224:239], a[216:219], a[244:247], v[224:239]
buffer_load_dwordx4 v25, s[20:23], s45 offen offset:0 nt lds
v_accvgpr_write_b32 a152, 0
v_mfma_f32_32x32x16_bf16 v[112:127], a[220:223], a[236:239], v[112:127]
buffer_load_dwordx4 v26, s[20:23], s45 offen offset:1024 nt lds
buffer_load_dwordx4 v27, s[20:23], s45 offen offset:2048 nt lds
v_accvgpr_write_b32 a153, 0
v_mfma_f32_32x32x16_bf16 v[176:191], a[220:223], a[240:243], v[176:191]
buffer_load_dwordx4 v28, s[20:23], s45 offen offset:3072 nt lds
v_accvgpr_write_b32 a154, 0
v_mfma_f32_32x32x16_bf16 v[240:255], a[220:223], a[244:247], v[240:255]
s_add_u32 s51, s51, 262144
s_cmp_eq_u32 s51, s52
s_cselect_b32 s51, s53, s51
v_accvgpr_write_b32 a155, 0
s_waitcnt lgkmcnt(0)
v_mfma_f32_32x32x16_bf16 v[64:79], a[192:195], a[224:227], v[64:79]
v_mfma_f32_32x32x16_bf16 v[128:143], a[192:195], a[228:231], v[128:143]
ds_read_b128 a[236:239], v36
ds_read_b128 a[240:243], v40
v_mfma_f32_32x32x16_bf16 v[192:207], a[192:195], a[232:235], v[192:207]
ds_read_b128 a[244:247], v44
ds_read_b64_tr_b16 a[208:209], v21 offset:45056
v_mfma_f32_32x32x16_bf16 v[80:95], a[196:199], a[224:227], v[80:95]
ds_read_b64_tr_b16 a[210:211], v21 offset:46080
v_mfma_f32_32x32x16_bf16 v[144:159], a[196:199], a[228:231], v[144:159]
ds_read_b64_tr_b16 a[212:213], v22 offset:45056
ds_read_b64_tr_b16 a[214:215], v22 offset:46080
v_mfma_f32_32x32x16_bf16 v[208:223], a[196:199], a[232:235], v[208:223]
ds_read_b64_tr_b16 a[216:217], v23 offset:45056
v_mfma_f32_32x32x16_bf16 v[96:111], a[200:203], a[224:227], v[96:111]
ds_read_b64_tr_b16 a[218:219], v23 offset:46080
ds_read_b64_tr_b16 a[220:221], v24 offset:45056
v_accvgpr_write_b32 a156, 0
v_mfma_f32_32x32x16_bf16 v[160:175], a[200:203], a[228:231], v[160:175]
ds_read_b64_tr_b16 a[222:223], v24 offset:46080
v_accvgpr_write_b32 a157, 0
v_mfma_f32_32x32x16_bf16 v[224:239], a[200:203], a[232:235], v[224:239]
v_accvgpr_write_b32 a158, 0
v_mfma_f32_32x32x16_bf16 v[112:127], a[204:207], a[224:227], v[112:127]
v_accvgpr_write_b32 a159, 0
v_mfma_f32_32x32x16_bf16 v[176:191], a[204:207], a[228:231], v[176:191]
v_accvgpr_write_b32 a160, 0
v_mfma_f32_32x32x16_bf16 v[240:255], a[204:207], a[232:235], v[240:255]
v_accvgpr_write_b32 a161, 0
s_waitcnt lgkmcnt(0)
v_mfma_f32_32x32x16_bf16 v[64:79], a[208:211], a[236:239], v[64:79]
s_waitcnt vmcnt(15)
s_barrier
v_mfma_f32_32x32x16_bf16 v[128:143], a[208:211], a[240:243], v[128:143]
ds_read_b128 a[224:227], v37
ds_read_b128 a[228:231], v41
s_add_u32 m0, s28, 40960
s_add_u32 s47, s29, s55
v_mfma_f32_32x32x16_bf16 v[192:207], a[208:211], a[244:247], v[192:207]
ds_read_b128 a[232:235], v45
ds_read_b64_tr_b16 a[192:193], v21 offset:16384
v_mfma_f32_32x32x16_bf16 v[80:95], a[212:215], a[236:239], v[80:95]
ds_read_b64_tr_b16 a[194:195], v21 offset:17408
buffer_load_dwordx4 v17, s[12:15], s47 offen offset:0 nt lds
v_mfma_f32_32x32x16_bf16 v[144:159], a[212:215], a[240:243], v[144:159]
ds_read_b64_tr_b16 a[196:197], v22 offset:16384
ds_read_b64_tr_b16 a[198:199], v22 offset:17408
v_mfma_f32_32x32x16_bf16 v[208:223], a[212:215], a[244:247], v[208:223]
ds_read_b64_tr_b16 a[200:201], v23 offset:16384
buffer_load_dwordx4 v17, s[12:15], s47 offen offset:1024 nt lds
v_mfma_f32_32x32x16_bf16 v[96:111], a[216:219], a[236:239], v[96:111]
ds_read_b64_tr_b16 a[202:203], v23 offset:17408
ds_read_b64_tr_b16 a[204:205], v24 offset:16384
v_accvgpr_write_b32 a162, 0
v_mfma_f32_32x32x16_bf16 v[160:175], a[216:219], a[240:243], v[160:175]
ds_read_b64_tr_b16 a[206:207], v24 offset:17408
buffer_load_dwordx4 v17, s[12:15], s47 offen offset:2048 nt lds
v_accvgpr_write_b32 a163, 0
v_mfma_f32_32x32x16_bf16 v[224:239], a[216:219], a[244:247], v[224:239]
v_accvgpr_write_b32 a164, 0
v_mfma_f32_32x32x16_bf16 v[112:127], a[220:223], a[236:239], v[112:127]
buffer_load_dwordx4 v17, s[12:15], s47 offen offset:3072 nt lds
s_add_u32 s55, s55, 8192
s_and_b32 s55, s55, 0x1ffff
v_accvgpr_write_b32 a165, 0
v_mfma_f32_32x32x16_bf16 v[176:191], a[220:223], a[240:243], v[176:191]
v_accvgpr_write_b32 a166, 0
v_mfma_f32_32x32x16_bf16 v[240:255], a[220:223], a[244:247], v[240:255]
v_accvgpr_write_b32 a167, 0
s_waitcnt lgkmcnt(0)
v_mfma_f32_32x32x16_bf16 v[64:79], a[192:195], a[224:227], v[64:79]
v_mfma_f32_32x32x16_bf16 v[128:143], a[192:195], a[228:231], v[128:143]
ds_read_b128 a[236:239], v38
ds_read_b128 a[240:243], v42
v_mfma_f32_32x32x16_bf16 v[192:207], a[192:195], a[232:235], v[192:207]
ds_read_b128 a[244:247], v46
ds_read_b64_tr_b16 a[208:209], v21 offset:20480
v_mfma_f32_32x32x16_bf16 v[80:95], a[196:199], a[224:227], v[80:95]
ds_read_b64_tr_b16 a[210:211], v21 offset:21504
v_mfma_f32_32x32x16_bf16 v[144:159], a[196:199], a[228:231], v[144:159]
ds_read_b64_tr_b16 a[212:213], v22 offset:20480
ds_read_b64_tr_b16 a[214:215], v22 offset:21504
v_mfma_f32_32x32x16_bf16 v[208:223], a[196:199], a[232:235], v[208:223]
ds_read_b64_tr_b16 a[216:217], v23 offset:20480
v_mfma_f32_32x32x16_bf16 v[96:111], a[200:203], a[224:227], v[96:111]
ds_read_b64_tr_b16 a[218:219], v23 offset:21504
ds_read_b64_tr_b16 a[220:221], v24 offset:20480
v_accvgpr_write_b32 a168, 0
v_mfma_f32_32x32x16_bf16 v[160:175], a[200:203], a[228:231], v[160:175]
ds_read_b64_tr_b16 a[222:223], v24 offset:21504
v_accvgpr_write_b32 a169, 0
v_mfma_f32_32x32x16_bf16 v[224:239], a[200:203], a[232:235], v[224:239]
v_accvgpr_write_b32 a170, 0
v_mfma_f32_32x32x16_bf16 v[112:127], a[204:207], a[224:227], v[112:127]
v_accvgpr_write_b32 a171, 0
v_mfma_f32_32x32x16_bf16 v[176:191], a[204:207], a[228:231], v[176:191]
v_accvgpr_write_b32 a172, 0
v_mfma_f32_32x32x16_bf16 v[240:255], a[204:207], a[232:235], v[240:255]
v_accvgpr_write_b32 a173, 0
s_waitcnt lgkmcnt(0)
v_mfma_f32_32x32x16_bf16 v[64:79], a[208:211], a[236:239], v[64:79]
s_waitcnt vmcnt(8)
s_barrier
v_mfma_f32_32x32x16_bf16 v[128:143], a[208:211], a[240:243], v[128:143]
ds_read_b128 a[224:227], v31 offset:0
ds_read_b128 a[228:231], v31 offset:4096
s_add_u32 m0, s28, 16384
s_add_u32 s46, s29, s54
v_mfma_f32_32x32x16_bf16 v[192:207], a[208:211], a[244:247], v[192:207]
ds_read_b128 a[232:235], v31 offset:8192
ds_read_b64_tr_b16 a[192:193], v21 offset:49152
v_mfma_f32_32x32x16_bf16 v[80:95], a[212:215], a[236:239], v[80:95]
ds_read_b64_tr_b16 a[194:195], v21 offset:50176
buffer_load_dwordx4 v13, s[8:11], s46 offen offset:0 nt lds
v_mfma_f32_32x32x16_bf16 v[144:159], a[212:215], a[240:243], v[144:159]
ds_read_b64_tr_b16 a[196:197], v22 offset:49152
ds_read_b64_tr_b16 a[198:199], v22 offset:50176
v_mfma_f32_32x32x16_bf16 v[208:223], a[212:215], a[244:247], v[208:223]
ds_read_b64_tr_b16 a[200:201], v23 offset:49152
buffer_load_dwordx4 v14, s[8:11], s46 offen offset:1024 nt lds
v_mfma_f32_32x32x16_bf16 v[96:111], a[216:219], a[236:239], v[96:111]
ds_read_b64_tr_b16 a[202:203], v23 offset:50176
ds_read_b64_tr_b16 a[204:205], v24 offset:49152
v_accvgpr_write_b32 a174, 0
v_mfma_f32_32x32x16_bf16 v[160:175], a[216:219], a[240:243], v[160:175]
ds_read_b64_tr_b16 a[206:207], v24 offset:50176
buffer_load_dwordx4 v15, s[8:11], s46 offen offset:2048 nt lds
v_accvgpr_write_b32 a175, 0
v_mfma_f32_32x32x16_bf16 v[224:239], a[216:219], a[244:247], v[224:239]
v_accvgpr_write_b32 a176, 0
v_mfma_f32_32x32x16_bf16 v[112:127], a[220:223], a[236:239], v[112:127]
buffer_load_dwordx4 v16, s[8:11], s46 offen offset:3072 nt lds
s_add_u32 s54, s54, 8192
s_and_b32 s54, s54, 0x1ffff
v_accvgpr_write_b32 a177, 0
v_mfma_f32_32x32x16_bf16 v[176:191], a[220:223], a[240:243], v[176:191]
v_accvgpr_write_b32 a178, 0
v_mfma_f32_32x32x16_bf16 v[240:255], a[220:223], a[244:247], v[240:255]
v_accvgpr_write_b32 a179, 0
s_waitcnt lgkmcnt(0)
v_mfma_f32_32x32x16_bf16 v[64:79], a[192:195], a[224:227], v[64:79]
v_mfma_f32_32x32x16_bf16 v[128:143], a[192:195], a[228:231], v[128:143]
ds_read_b128 a[236:239], v32 offset:0
ds_read_b128 a[240:243], v32 offset:4096
v_mfma_f32_32x32x16_bf16 v[192:207], a[192:195], a[232:235], v[192:207]
ds_read_b128 a[244:247], v32 offset:8192
ds_read_b64_tr_b16 a[208:209], v21 offset:53248
v_mfma_f32_32x32x16_bf16 v[80:95], a[196:199], a[224:227], v[80:95]
ds_read_b64_tr_b16 a[210:211], v21 offset:54272
v_mfma_f32_32x32x16_bf16 v[144:159], a[196:199], a[228:231], v[144:159]
ds_read_b64_tr_b16 a[212:213], v22 offset:53248
ds_read_b64_tr_b16 a[214:215], v22 offset:54272
v_mfma_f32_32x32x16_bf16 v[208:223], a[196:199], a[232:235], v[208:223]
ds_read_b64_tr_b16 a[216:217], v23 offset:53248
v_mfma_f32_32x32x16_bf16 v[96:111], a[200:203], a[224:227], v[96:111]
ds_read_b64_tr_b16 a[218:219], v23 offset:54272
ds_read_b64_tr_b16 a[220:221], v24 offset:53248
v_accvgpr_write_b32 a180, 0
v_mfma_f32_32x32x16_bf16 v[160:175], a[200:203], a[228:231], v[160:175]
ds_read_b64_tr_b16 a[222:223], v24 offset:54272
v_accvgpr_write_b32 a181, 0
v_mfma_f32_32x32x16_bf16 v[224:239], a[200:203], a[232:235], v[224:239]
v_accvgpr_write_b32 a182, 0
v_mfma_f32_32x32x16_bf16 v[112:127], a[204:207], a[224:227], v[112:127]
v_accvgpr_write_b32 a183, 0
v_mfma_f32_32x32x16_bf16 v[176:191], a[204:207], a[228:231], v[176:191]
v_accvgpr_write_b32 a184, 0
v_mfma_f32_32x32x16_bf16 v[240:255], a[204:207], a[232:235], v[240:255]
v_accvgpr_write_b32 a185, 0
s_waitcnt lgkmcnt(0)
v_mfma_f32_32x32x16_bf16 v[64:79], a[208:211], a[236:239], v[64:79]
s_waitcnt vmcnt(8)
s_barrier
v_mfma_f32_32x32x16_bf16 v[128:143], a[208:211], a[240:243], v[128:143]
ds_read_b128 a[224:227], v33 offset:0
ds_read_b128 a[228:231], v33 offset:4096
s_add_u32 m0, s28, 49152
s_add_u32 s47, s29, s55
v_mfma_f32_32x32x16_bf16 v[192:207], a[208:211], a[244:247], v[192:207]
ds_read_b128 a[232:235], v33 offset:8192
ds_read_b64_tr_b16 a[192:193], v21 offset:24576
v_mfma_f32_32x32x16_bf16 v[80:95], a[212:215], a[236:239], v[80:95]
ds_read_b64_tr_b16 a[194:195], v21 offset:25600
buffer_load_dwordx4 v17, s[12:15], s47 offen offset:0 nt lds
v_mfma_f32_32x32x16_bf16 v[144:159], a[212:215], a[240:243], v[144:159]
ds_read_b64_tr_b16 a[196:197], v22 offset:24576
ds_read_b64_tr_b16 a[198:199], v22 offset:25600
v_mfma_f32_32x32x16_bf16 v[208:223], a[212:215], a[244:247], v[208:223]
ds_read_b64_tr_b16 a[200:201], v23 offset:24576
buffer_load_dwordx4 v17, s[12:15], s47 offen offset:1024 nt lds
v_mfma_f32_32x32x16_bf16 v[96:111], a[216:219], a[236:239], v[96:111]
ds_read_b64_tr_b16 a[202:203], v23 offset:25600
ds_read_b64_tr_b16 a[204:205], v24 offset:24576
v_accvgpr_write_b32 a186, 0
v_mfma_f32_32x32x16_bf16 v[160:175], a[216:219], a[240:243], v[160:175]
ds_read_b64_tr_b16 a[206:207], v24 offset:25600
buffer_load_dwordx4 v17, s[12:15], s47 offen offset:2048 nt lds
v_accvgpr_write_b32 a187, 0
v_mfma_f32_32x32x16_bf16 v[224:239], a[216:219], a[244:247], v[224:239]
v_accvgpr_write_b32 a188, 0
v_mfma_f32_32x32x16_bf16 v[112:127], a[220:223], a[236:239], v[112:127]
buffer_load_dwordx4 v17, s[12:15], s47 offen offset:3072 nt lds
s_add_u32 s55, s55, 8192
s_and_b32 s55, s55, 0x1ffff
v_accvgpr_write_b32 a189, 0
v_mfma_f32_32x32x16_bf16 v[176:191], a[220:223], a[240:243], v[176:191]
v_accvgpr_write_b32 a190, 0
v_mfma_f32_32x32x16_bf16 v[240:255], a[220:223], a[244:247], v[240:255]
v_accvgpr_write_b32 a191, 0
s_waitcnt lgkmcnt(0)
v_mfma_f32_32x32x16_bf16 v[64:79], a[192:195], a[224:227], v[64:79]
v_mfma_f32_32x32x16_bf16 v[128:143], a[192:195], a[228:231], v[128:143]
ds_read_b128 a[236:239], v34 offset:0
ds_read_b128 a[240:243], v34 offset:4096
v_mfma_f32_32x32x16_bf16 v[192:207], a[192:195], a[232:235], v[192:207]
ds_read_b128 a[244:247], v34 offset:8192
ds_read_b64_tr_b16 a[208:209], v21 offset:28672
v_mfma_f32_32x32x16_bf16 v[80:95], a[196:199], a[224:227], v[80:95]
ds_read_b64_tr_b16 a[210:211], v21 offset:29696
v_mfma_f32_32x32x16_bf16 v[144:159], a[196:199], a[228:231], v[144:159]
ds_read_b64_tr_b16 a[212:213], v22 offset:28672
ds_read_b64_tr_b16 a[214:215], v22 offset:29696
v_mfma_f32_32x32x16_bf16 v[208:223], a[196:199], a[232:235], v[208:223]
ds_read_b64_tr_b16 a[216:217], v23 offset:28672
v_mfma_f32_32x32x16_bf16 v[96:111], a[200:203], a[224:227], v[96:111]
ds_read_b64_tr_b16 a[218:219], v23 offset:29696
ds_read_b64_tr_b16 a[220:221], v24 offset:28672
v_mfma_f32_32x32x16_bf16 v[160:175], a[200:203], a[228:231], v[160:175]
ds_read_b64_tr_b16 a[222:223], v24 offset:29696
v_mfma_f32_32x32x16_bf16 v[224:239], a[200:203], a[232:235], v[224:239]
v_mfma_f32_32x32x16_bf16 v[112:127], a[204:207], a[224:227], v[112:127]
v_mfma_f32_32x32x16_bf16 v[176:191], a[204:207], a[228:231], v[176:191]
v_mfma_f32_32x32x16_bf16 v[240:255], a[204:207], a[232:235], v[240:255]
s_waitcnt lgkmcnt(0)
v_mfma_f32_32x32x16_bf16 v[64:79], a[208:211], a[236:239], v[64:79]
s_barrier
v_mfma_f32_32x32x16_bf16 v[128:143], a[208:211], a[240:243], v[128:143]
s_add_u32 m0, s28, 24576
s_add_u32 s46, s29, s54
v_mfma_f32_32x32x16_bf16 v[192:207], a[208:211], a[244:247], v[192:207]
v_mfma_f32_32x32x16_bf16 v[80:95], a[212:215], a[236:239], v[80:95]
buffer_load_dwordx4 v13, s[8:11], s46 offen offset:0 nt lds
v_mfma_f32_32x32x16_bf16 v[144:159], a[212:215], a[240:243], v[144:159]
v_mfma_f32_32x32x16_bf16 v[208:223], a[212:215], a[244:247], v[208:223]
buffer_load_dwordx4 v14, s[8:11], s46 offen offset:1024 nt lds
v_mfma_f32_32x32x16_bf16 v[96:111], a[216:219], a[236:239], v[96:111]
v_mfma_f32_32x32x16_bf16 v[160:175], a[216:219], a[240:243], v[160:175]
buffer_load_dwordx4 v15, s[8:11], s46 offen offset:2048 nt lds
v_mfma_f32_32x32x16_bf16 v[224:239], a[216:219], a[244:247], v[224:239]
v_mfma_f32_32x32x16_bf16 v[112:127], a[220:223], a[236:239], v[112:127]
buffer_load_dwordx4 v16, s[8:11], s46 offen offset:3072 nt lds
s_add_u32 s54, s54, 8192
s_and_b32 s54, s54, 0x1ffff
v_mfma_f32_32x32x16_bf16 v[176:191], a[220:223], a[240:243], v[176:191]
v_mfma_f32_32x32x16_bf16 v[240:255], a[220:223], a[244:247], v[240:255]
s_nop 7
ds_read_b128 a[192:195], v1 offset:0
ds_read_b128 a[196:199], v2 offset:0
ds_read_b128 a[200:203], v3 offset:0
ds_read_b128 a[204:207], v4 offset:0
ds_read_b128 a[208:211], v5 offset:0
ds_read_b128 a[212:215], v6 offset:0
ds_read_b128 a[216:219], v7 offset:0
ds_read_b128 a[220:223], v8 offset:0
s_nop 7
v_pk_mul_f32 v[240:241], v[240:241], s[42:43]
v_pk_mul_f32 v[242:243], v[242:243], s[42:43]
v_pk_mul_f32 v[244:245], v[244:245], s[42:43]
v_pk_mul_f32 v[246:247], v[246:247], s[42:43]
v_pk_mul_f32 v[248:249], v[248:249], s[42:43]
v_pk_mul_f32 v[250:251], v[250:251], s[42:43]
v_pk_mul_f32 v[252:253], v[252:253], s[42:43]
v_pk_mul_f32 v[254:255], v[254:255], s[42:43]
v_cvt_pk_bf16_f32 v255, v254, v255
v_cvt_pk_bf16_f32 v254, v252, v253
v_cvt_pk_bf16_f32 v253, v250, v251
v_cvt_pk_bf16_f32 v252, v248, v249
v_cvt_pk_bf16_f32 v251, v246, v247
v_cvt_pk_bf16_f32 v250, v244, v245
v_cvt_pk_bf16_f32 v249, v242, v243
v_cvt_pk_bf16_f32 v248, v240, v241
v_pk_mul_f32 v[224:225], v[224:225], s[42:43]
v_pk_mul_f32 v[226:227], v[226:227], s[42:43]
v_pk_mul_f32 v[228:229], v[228:229], s[42:43]
v_pk_mul_f32 v[230:231], v[230:231], s[42:43]
v_pk_mul_f32 v[232:233], v[232:233], s[42:43]
v_pk_mul_f32 v[234:235], v[234:235], s[42:43]
v_pk_mul_f32 v[236:237], v[236:237], s[42:43]
v_pk_mul_f32 v[238:239], v[238:239], s[42:43]
v_cvt_pk_bf16_f32 v247, v238, v239
v_cvt_pk_bf16_f32 v246, v236, v237
v_cvt_pk_bf16_f32 v245, v234, v235
v_cvt_pk_bf16_f32 v244, v232, v233
v_cvt_pk_bf16_f32 v243, v230, v231
v_cvt_pk_bf16_f32 v242, v228, v229
v_cvt_pk_bf16_f32 v241, v226, v227
v_cvt_pk_bf16_f32 v240, v224, v225
v_pk_mul_f32 v[208:209], v[208:209], s[42:43]
v_pk_mul_f32 v[210:211], v[210:211], s[42:43]
v_pk_mul_f32 v[212:213], v[212:213], s[42:43]
v_pk_mul_f32 v[214:215], v[214:215], s[42:43]
v_pk_mul_f32 v[216:217], v[216:217], s[42:43]
v_pk_mul_f32 v[218:219], v[218:219], s[42:43]
v_pk_mul_f32 v[220:221], v[220:221], s[42:43]
v_pk_mul_f32 v[222:223], v[222:223], s[42:43]
v_cvt_pk_bf16_f32 v239, v222, v223
v_cvt_pk_bf16_f32 v238, v220, v221
v_cvt_pk_bf16_f32 v237, v218, v219
v_cvt_pk_bf16_f32 v236, v216, v217
v_cvt_pk_bf16_f32 v235, v214, v215
v_cvt_pk_bf16_f32 v234, v212, v213
v_cvt_pk_bf16_f32 v233, v210, v211
v_cvt_pk_bf16_f32 v232, v208, v209
v_pk_mul_f32 v[192:193], v[192:193], s[42:43]
v_pk_mul_f32 v[194:195], v[194:195], s[42:43]
v_pk_mul_f32 v[196:197], v[196:197], s[42:43]
v_pk_mul_f32 v[198:199], v[198:199], s[42:43]
v_pk_mul_f32 v[200:201], v[200:201], s[42:43]
v_pk_mul_f32 v[202:203], v[202:203], s[42:43]
v_pk_mul_f32 v[204:205], v[204:205], s[42:43]
v_pk_mul_f32 v[206:207], v[206:207], s[42:43]
v_cvt_pk_bf16_f32 v231, v206, v207
v_cvt_pk_bf16_f32 v230, v204, v205
v_cvt_pk_bf16_f32 v229, v202, v203
v_cvt_pk_bf16_f32 v228, v200, v201
v_cvt_pk_bf16_f32 v227, v198, v199
v_cvt_pk_bf16_f32 v226, v196, v197
v_cvt_pk_bf16_f32 v225, v194, v195
v_cvt_pk_bf16_f32 v224, v192, v193
v_pk_mul_f32 v[176:177], v[176:177], s[42:43]
v_pk_mul_f32 v[178:179], v[178:179], s[42:43]
v_pk_mul_f32 v[180:181], v[180:181], s[42:43]
v_pk_mul_f32 v[182:183], v[182:183], s[42:43]
v_pk_mul_f32 v[184:185], v[184:185], s[42:43]
v_pk_mul_f32 v[186:187], v[186:187], s[42:43]
v_pk_mul_f32 v[188:189], v[188:189], s[42:43]
v_pk_mul_f32 v[190:191], v[190:191], s[42:43]
v_cvt_pk_bf16_f32 v223, v190, v191
v_cvt_pk_bf16_f32 v222, v188, v189
v_cvt_pk_bf16_f32 v221, v186, v187
v_cvt_pk_bf16_f32 v220, v184, v185
v_cvt_pk_bf16_f32 v219, v182, v183
v_cvt_pk_bf16_f32 v218, v180, v181
v_cvt_pk_bf16_f32 v217, v178, v179
v_cvt_pk_bf16_f32 v216, v176, v177
v_pk_mul_f32 v[160:161], v[160:161], s[42:43]
v_pk_mul_f32 v[162:163], v[162:163], s[42:43]
v_pk_mul_f32 v[164:165], v[164:165], s[42:43]
v_pk_mul_f32 v[166:167], v[166:167], s[42:43]
v_pk_mul_f32 v[168:169], v[168:169], s[42:43]
v_pk_mul_f32 v[170:171], v[170:171], s[42:43]
v_pk_mul_f32 v[172:173], v[172:173], s[42:43]
v_pk_mul_f32 v[174:175], v[174:175], s[42:43]
v_cvt_pk_bf16_f32 v215, v174, v175
v_cvt_pk_bf16_f32 v214, v172, v173
v_cvt_pk_bf16_f32 v213, v170, v171
v_cvt_pk_bf16_f32 v212, v168, v169
v_cvt_pk_bf16_f32 v211, v166, v167
v_cvt_pk_bf16_f32 v210, v164, v165
v_cvt_pk_bf16_f32 v209, v162, v163
v_cvt_pk_bf16_f32 v208, v160, v161
v_pk_mul_f32 v[144:145], v[144:145], s[42:43]
v_pk_mul_f32 v[146:147], v[146:147], s[42:43]
v_pk_mul_f32 v[148:149], v[148:149], s[42:43]
v_pk_mul_f32 v[150:151], v[150:151], s[42:43]
v_pk_mul_f32 v[152:153], v[152:153], s[42:43]
v_pk_mul_f32 v[154:155], v[154:155], s[42:43]
v_pk_mul_f32 v[156:157], v[156:157], s[42:43]
v_pk_mul_f32 v[158:159], v[158:159], s[42:43]
v_cvt_pk_bf16_f32 v207, v158, v159
v_cvt_pk_bf16_f32 v206, v156, v157
v_cvt_pk_bf16_f32 v205, v154, v155
v_cvt_pk_bf16_f32 v204, v152, v153
v_cvt_pk_bf16_f32 v203, v150, v151
v_cvt_pk_bf16_f32 v202, v148, v149
v_cvt_pk_bf16_f32 v201, v146, v147
v_cvt_pk_bf16_f32 v200, v144, v145
v_pk_mul_f32 v[128:129], v[128:129], s[42:43]
v_pk_mul_f32 v[130:131], v[130:131], s[42:43]
v_pk_mul_f32 v[132:133], v[132:133], s[42:43]
v_pk_mul_f32 v[134:135], v[134:135], s[42:43]
v_pk_mul_f32 v[136:137], v[136:137], s[42:43]
v_pk_mul_f32 v[138:139], v[138:139], s[42:43]
v_pk_mul_f32 v[140:141], v[140:141], s[42:43]
v_pk_mul_f32 v[142:143], v[142:143], s[42:43]
v_cvt_pk_bf16_f32 v199, v142, v143
v_cvt_pk_bf16_f32 v198, v140, v141
v_cvt_pk_bf16_f32 v197, v138, v139
v_cvt_pk_bf16_f32 v196, v136, v137
v_cvt_pk_bf16_f32 v195, v134, v135
v_cvt_pk_bf16_f32 v194, v132, v133
v_cvt_pk_bf16_f32 v193, v130, v131
v_cvt_pk_bf16_f32 v192, v128, v129
v_pk_mul_f32 v[112:113], v[112:113], s[42:43]
v_pk_mul_f32 v[114:115], v[114:115], s[42:43]
v_pk_mul_f32 v[116:117], v[116:117], s[42:43]
v_pk_mul_f32 v[118:119], v[118:119], s[42:43]
v_pk_mul_f32 v[120:121], v[120:121], s[42:43]
v_pk_mul_f32 v[122:123], v[122:123], s[42:43]
v_pk_mul_f32 v[124:125], v[124:125], s[42:43]
v_pk_mul_f32 v[126:127], v[126:127], s[42:43]
v_cvt_pk_bf16_f32 v191, v126, v127
v_cvt_pk_bf16_f32 v190, v124, v125
v_cvt_pk_bf16_f32 v189, v122, v123
v_cvt_pk_bf16_f32 v188, v120, v121
v_cvt_pk_bf16_f32 v187, v118, v119
v_cvt_pk_bf16_f32 v186, v116, v117
v_cvt_pk_bf16_f32 v185, v114, v115
v_cvt_pk_bf16_f32 v184, v112, v113
v_pk_mul_f32 v[96:97], v[96:97], s[42:43]
v_pk_mul_f32 v[98:99], v[98:99], s[42:43]
v_pk_mul_f32 v[100:101], v[100:101], s[42:43]
v_pk_mul_f32 v[102:103], v[102:103], s[42:43]
v_pk_mul_f32 v[104:105], v[104:105], s[42:43]
v_pk_mul_f32 v[106:107], v[106:107], s[42:43]
v_pk_mul_f32 v[108:109], v[108:109], s[42:43]
v_pk_mul_f32 v[110:111], v[110:111], s[42:43]
v_cvt_pk_bf16_f32 v183, v110, v111
v_cvt_pk_bf16_f32 v182, v108, v109
v_cvt_pk_bf16_f32 v181, v106, v107
v_cvt_pk_bf16_f32 v180, v104, v105
v_cvt_pk_bf16_f32 v179, v102, v103
v_cvt_pk_bf16_f32 v178, v100, v101
v_cvt_pk_bf16_f32 v177, v98, v99
v_cvt_pk_bf16_f32 v176, v96, v97
v_pk_mul_f32 v[80:81], v[80:81], s[42:43]
v_pk_mul_f32 v[82:83], v[82:83], s[42:43]
v_pk_mul_f32 v[84:85], v[84:85], s[42:43]
v_pk_mul_f32 v[86:87], v[86:87], s[42:43]
v_pk_mul_f32 v[88:89], v[88:89], s[42:43]
v_pk_mul_f32 v[90:91], v[90:91], s[42:43]
v_pk_mul_f32 v[92:93], v[92:93], s[42:43]
v_pk_mul_f32 v[94:95], v[94:95], s[42:43]
v_cvt_pk_bf16_f32 v175, v94, v95
v_cvt_pk_bf16_f32 v174, v92, v93
v_cvt_pk_bf16_f32 v173, v90, v91
v_cvt_pk_bf16_f32 v172, v88, v89
v_cvt_pk_bf16_f32 v171, v86, v87
v_cvt_pk_bf16_f32 v170, v84, v85
v_cvt_pk_bf16_f32 v169, v82, v83
v_cvt_pk_bf16_f32 v168, v80, v81
v_pk_mul_f32 v[64:65], v[64:65], s[42:43]
v_pk_mul_f32 v[66:67], v[66:67], s[42:43]
v_pk_mul_f32 v[68:69], v[68:69], s[42:43]
v_pk_mul_f32 v[70:71], v[70:71], s[42:43]
v_pk_mul_f32 v[72:73], v[72:73], s[42:43]
v_pk_mul_f32 v[74:75], v[74:75], s[42:43]
v_pk_mul_f32 v[76:77], v[76:77], s[42:43]
v_pk_mul_f32 v[78:79], v[78:79], s[42:43]
v_cvt_pk_bf16_f32 v167, v78, v79
v_cvt_pk_bf16_f32 v166, v76, v77
v_cvt_pk_bf16_f32 v165, v74, v75
v_cvt_pk_bf16_f32 v164, v72, v73
v_cvt_pk_bf16_f32 v163, v70, v71
v_cvt_pk_bf16_f32 v162, v68, v69
v_cvt_pk_bf16_f32 v161, v66, v67
v_cvt_pk_bf16_f32 v160, v64, v65
s_waitcnt lgkmcnt(0)
s_nop 1
v_mfma_f32_32x32x16_bf16 v[64:79], a[192:195], v[160:163], 0
v_mfma_f32_32x32x16_bf16 v[64:79], a[196:199], v[164:167], v[64:79]
v_mfma_f32_32x32x16_bf16 v[64:79], a[200:203], v[168:171], v[64:79]
v_mfma_f32_32x32x16_bf16 v[64:79], a[204:207], v[172:175], v[64:79]
v_mfma_f32_32x32x16_bf16 v[64:79], a[208:211], v[176:179], v[64:79]
v_mfma_f32_32x32x16_bf16 v[64:79], a[212:215], v[180:183], v[64:79]
v_mfma_f32_32x32x16_bf16 v[64:79], a[216:219], v[184:187], v[64:79]
v_mfma_f32_32x32x16_bf16 v[64:79], a[220:223], v[188:191], v[64:79]
s_nop 7
s_nop 7
v_mfma_f32_32x32x16_bf16 v[80:95], a[192:195], v[192:195], 0
s_barrier
v_max3_f32 v47, v64, v65, v66
v_max3_f32 v47, v47, v67, v68
v_max3_f32 v47, v47, v69, v70
v_max3_f32 v47, v47, v71, v72
v_max3_f32 v47, v47, v73, v74
v_max3_f32 v47, v47, v75, v76
v_max3_f32 v47, v47, v77, v78
v_max_f32 v47, v47, v79
v_mov_b32 v48, v47
s_nop 1
v_permlane32_swap_b32 v47, v48
s_nop 0
v_max_f32 v47, v47, v48
v_mul_f32 v112, -1.0, v47
v_mfma_f32_32x32x16_bf16 v[80:95], a[196:199], v[196:199], v[80:95]
ds_read_b64_tr_b16 a[224:225], v9 offset:0
ds_read_b64_tr_b16 a[226:227], v9 offset:2048
ds_read_b64_tr_b16 a[228:229], v10 offset:0
ds_read_b64_tr_b16 a[230:231], v10 offset:2048
s_add_u32 m0, s28, 0
s_add_u32 s46, s29, s54
v_add_f32 v64, v64, v112
v_add_f32 v65, v65, v112
v_add_f32 v66, v66, v112
v_add_f32 v67, v67, v112
v_add_f32 v68, v68, v112
v_add_f32 v69, v69, v112
v_add_f32 v70, v70, v112
v_add_f32 v71, v71, v112
v_add_f32 v72, v72, v112
v_add_f32 v73, v73, v112
v_add_f32 v74, v74, v112
v_mfma_f32_32x32x16_bf16 v[80:95], a[200:203], v[200:203], v[80:95]
ds_read_b64_tr_b16 a[232:233], v11 offset:0
ds_read_b64_tr_b16 a[234:235], v11 offset:2048
s_waitcnt vmcnt(5)
buffer_load_dwordx4 v13, s[8:11], s46 offen offset:0 nt lds
v_add_f32 v75, v75, v112
v_add_f32 v76, v76, v112
v_add_f32 v77, v77, v112
v_add_f32 v78, v78, v112
v_add_f32 v79, v79, v112
v_exp_f32 v64, v64
v_exp_f32 v65, v65
v_add_f32 v18, v18, v64
v_exp_f32 v66, v66
v_mfma_f32_32x32x16_bf16 v[80:95], a[204:207], v[204:207], v[80:95]
ds_read_b64_tr_b16 a[236:237], v12 offset:0
ds_read_b64_tr_b16 a[238:239], v12 offset:2048
v_add_f32 v18, v18, v65
v_cvt_pk_bf16_f32 v96, v64, v65
v_exp_f32 v67, v67
v_add_f32 v18, v18, v66
v_exp_f32 v68, v68
v_add_f32 v18, v18, v67
v_cvt_pk_bf16_f32 v97, v66, v67
v_exp_f32 v69, v69
v_add_f32 v18, v18, v68
v_exp_f32 v70, v70
v_add_f32 v18, v18, v69
v_mfma_f32_32x32x16_bf16 v[80:95], a[208:211], v[208:211], v[80:95]
ds_read_b64_tr_b16 a[240:241], v9 offset:4096
ds_read_b64_tr_b16 a[242:243], v9 offset:6144
v_cvt_pk_bf16_f32 v98, v68, v69
v_exp_f32 v71, v71
v_add_f32 v18, v18, v70
v_exp_f32 v72, v72
v_add_f32 v18, v18, v71
v_cvt_pk_bf16_f32 v99, v70, v71
v_exp_f32 v73, v73
v_add_f32 v18, v18, v72
v_exp_f32 v74, v74
v_add_f32 v18, v18, v73
v_mfma_f32_32x32x16_bf16 v[80:95], a[212:215], v[212:215], v[80:95]
ds_read_b64_tr_b16 a[244:245], v10 offset:4096
ds_read_b64_tr_b16 a[246:247], v10 offset:6144
v_cvt_pk_bf16_f32 v100, v72, v73
v_exp_f32 v75, v75
v_add_f32 v18, v18, v74
v_exp_f32 v76, v76
v_add_f32 v18, v18, v75
v_cvt_pk_bf16_f32 v101, v74, v75
v_exp_f32 v77, v77
v_add_f32 v18, v18, v76
v_exp_f32 v78, v78
v_add_f32 v18, v18, v77
v_mfma_f32_32x32x16_bf16 v[80:95], a[216:219], v[216:219], v[80:95]
ds_read_b64_tr_b16 a[248:249], v11 offset:4096
ds_read_b64_tr_b16 a[250:251], v11 offset:6144
v_cvt_pk_bf16_f32 v102, v76, v77
v_exp_f32 v79, v79
v_add_f32 v18, v18, v78
v_add_f32 v18, v18, v79
v_cvt_pk_bf16_f32 v103, v78, v79
v_mov_b32 v113, v112
v_mov_b32 v114, v112
v_mov_b32 v115, v112
v_mov_b32 v116, v112
v_mov_b32 v117, v112
v_mov_b32 v118, v112
v_mov_b32 v119, v112
v_mov_b32 v120, v112
v_mov_b32 v121, v112
v_mfma_f32_32x32x16_bf16 v[80:95], a[220:223], v[220:223], v[80:95]
ds_read_b64_tr_b16 a[252:253], v12 offset:4096
ds_read_b64_tr_b16 a[254:255], v12 offset:6144
s_add_u32 m0, s28, 0
s_nop 0
s_waitcnt vmcnt(5)
buffer_load_dwordx4 v14, s[8:11], s46 offen offset:1024 nt lds
s_add_u32 m0, s28, 0
s_nop 0
s_waitcnt vmcnt(5)
buffer_load_dwordx4 v15, s[8:11], s46 offen offset:2048 nt lds
v_mov_b32 v122, v112
v_mov_b32 v123, v112
v_mov_b32 v124, v112
v_mov_b32 v125, v112
v_mov_b32 v126, v112
v_mov_b32 v127, v112
s_nop 3
v_mfma_f32_32x32x16_bf16 v[64:79], a[192:195], v[224:227], 0
ds_read_b128 a[192:195], v1 offset:8192
v_max3_f32 v47, v80, v81, v82
v_max3_f32 v47, v47, v83, v84
v_max3_f32 v47, v47, v85, v86
v_max3_f32 v47, v47, v87, v88
v_max3_f32 v47, v47, v89, v90
v_max3_f32 v47, v47, v91, v92
v_mfma_f32_32x32x16_bf16 v[64:79], a[196:199], v[228:231], v[64:79]
ds_read_b128 a[196:199], v2 offset:8192
v_max3_f32 v47, v47, v93, v94
v_max_f32 v47, v47, v95
v_mov_b32 v48, v47
s_nop 1
v_permlane32_swap_b32 v47, v48
s_nop 0
v_max_f32 v47, v47, v48
v_mfma_f32_32x32x16_bf16 v[64:79], a[200:203], v[232:235], v[64:79]
ds_read_b128 a[200:203], v3 offset:8192
v_mul_f32 v128, -1.0, v47
v_add_f32 v80, v80, v128
v_add_f32 v81, v81, v128
v_add_f32 v82, v82, v128
v_add_f32 v83, v83, v128
v_add_f32 v84, v84, v128
v_mfma_f32_32x32x16_bf16 v[64:79], a[204:207], v[236:239], v[64:79]
ds_read_b128 a[204:207], v4 offset:8192
v_add_f32 v85, v85, v128
v_add_f32 v86, v86, v128
v_add_f32 v87, v87, v128
v_add_f32 v88, v88, v128
v_add_f32 v89, v89, v128
v_add_f32 v90, v90, v128
v_add_f32 v91, v91, v128
v_mfma_f32_32x32x16_bf16 v[64:79], a[208:211], v[240:243], v[64:79]
ds_read_b128 a[208:211], v5 offset:8192
v_add_f32 v92, v92, v128
v_add_f32 v93, v93, v128
v_add_f32 v94, v94, v128
v_add_f32 v95, v95, v128
v_exp_f32 v80, v80
v_mfma_f32_32x32x16_bf16 v[64:79], a[212:215], v[244:247], v[64:79]
ds_read_b128 a[212:215], v6 offset:8192
s_add_u32 m0, s28, 0
v_exp_f32 v81, v81
v_add_f32 v19, v19, v80
v_exp_f32 v82, v82
v_mfma_f32_32x32x16_bf16 v[64:79], a[216:219], v[248:251], v[64:79]
ds_read_b128 a[216:219], v7 offset:8192
s_waitcnt vmcnt(5)
buffer_load_dwordx4 v16, s[8:11], s46 offen offset:3072 nt lds
s_add_u32 s54, s54, 8192
s_and_b32 s54, s54, 0x1ffff
v_add_f32 v19, v19, v81
v_cvt_pk_bf16_f32 v104, v80, v81
v_mfma_f32_32x32x16_bf16 v[64:79], a[220:223], v[252:255], v[64:79]
ds_read_b128 a[220:223], v8 offset:8192
v_exp_f32 v83, v83
v_add_f32 v19, v19, v82
v_exp_f32 v84, v84
v_add_f32 v19, v19, v83
v_cvt_pk_bf16_f32 v105, v82, v83
s_waitcnt lgkmcnt(8)
v_mfma_f32_32x32x16_bf16 a[0:15], a[224:227], v[96:99], a[0:15]
v_exp_f32 v85, v85
v_add_f32 v19, v19, v84
v_exp_f32 v86, v86
v_add_f32 v19, v19, v85
v_cvt_pk_bf16_f32 v106, v84, v85
v_mfma_f32_32x32x16_bf16 a[16:31], a[228:231], v[96:99], a[16:31]
v_exp_f32 v87, v87
v_add_f32 v19, v19, v86
v_exp_f32 v88, v88
v_add_f32 v19, v19, v87
v_cvt_pk_bf16_f32 v107, v86, v87
v_mfma_f32_32x32x16_bf16 a[32:47], a[232:235], v[96:99], a[32:47]
v_exp_f32 v89, v89
v_add_f32 v19, v19, v88
v_exp_f32 v90, v90
v_add_f32 v19, v19, v89
v_cvt_pk_bf16_f32 v108, v88, v89
v_exp_f32 v91, v91
v_mfma_f32_32x32x16_bf16 a[48:63], a[236:239], v[96:99], a[48:63]
s_add_u32 m0, s28, 57344
s_add_u32 s47, s29, s55
v_add_f32 v19, v19, v90
v_exp_f32 v92, v92
v_add_f32 v19, v19, v91
v_cvt_pk_bf16_f32 v109, v90, v91
v_mfma_f32_32x32x16_bf16 a[0:15], a[240:243], v[100:103], a[0:15]
s_waitcnt vmcnt(5)
buffer_load_dwordx4 v17, s[12:15], s47 offen offset:0 nt lds
v_exp_f32 v93, v93
v_add_f32 v19, v19, v92
v_exp_f32 v94, v94
v_mfma_f32_32x32x16_bf16 a[16:31], a[244:247], v[100:103], a[16:31]
v_add_f32 v19, v19, v93
v_cvt_pk_bf16_f32 v110, v92, v93
v_exp_f32 v95, v95
v_add_f32 v19, v19, v94
v_add_f32 v19, v19, v95
v_cvt_pk_bf16_f32 v111, v94, v95
v_mfma_f32_32x32x16_bf16 a[32:47], a[248:251], v[100:103], a[32:47]
v_mov_b32 v129, v128
v_mov_b32 v130, v128
v_mov_b32 v131, v128
v_mov_b32 v132, v128
v_mov_b32 v133, v128
v_mov_b32 v134, v128
v_mov_b32 v135, v128
v_mov_b32 v136, v128
v_mfma_f32_32x32x16_bf16 a[48:63], a[252:255], v[100:103], a[48:63]
v_mov_b32 v137, v128
v_mov_b32 v138, v128
v_mov_b32 v139, v128
v_mov_b32 v140, v128
v_mov_b32 v141, v128
v_mov_b32 v142, v128
v_mov_b32 v143, v128
s_waitcnt lgkmcnt(0)
v_mfma_f32_32x32x16_bf16 v[80:95], a[192:195], v[160:163], v[112:127]
v_max3_f32 v47, v64, v65, v66
v_max3_f32 v47, v47, v67, v68
v_max3_f32 v47, v47, v69, v70
v_max3_f32 v47, v47, v71, v72
v_max3_f32 v47, v47, v73, v74
v_max3_f32 v47, v47, v75, v76
v_max3_f32 v47, v47, v77, v78
v_mfma_f32_32x32x16_bf16 v[80:95], a[196:199], v[164:167], v[80:95]
v_max_f32 v47, v47, v79
v_mov_b32 v48, v47
s_nop 1
v_permlane32_swap_b32 v47, v48
s_nop 0
v_max_f32 v47, v47, v48
v_mfma_f32_32x32x16_bf16 v[80:95], a[200:203], v[168:171], v[80:95]
s_add_u32 m0, s28, 57344
v_mul_f32 v144, -1.0, v47
v_add_f32 v64, v64, v144
v_add_f32 v65, v65, v144
v_add_f32 v66, v66, v144
v_add_f32 v67, v67, v144
v_add_f32 v68, v68, v144
v_mfma_f32_32x32x16_bf16 v[80:95], a[204:207], v[172:175], v[80:95]
s_waitcnt vmcnt(5)
buffer_load_dwordx4 v17, s[12:15], s47 offen offset:1024 nt lds
v_add_f32 v69, v69, v144
v_add_f32 v70, v70, v144
v_add_f32 v71, v71, v144
v_add_f32 v72, v72, v144
v_add_f32 v73, v73, v144
v_mfma_f32_32x32x16_bf16 v[80:95], a[208:211], v[176:179], v[80:95]
v_add_f32 v74, v74, v144
v_add_f32 v75, v75, v144
v_add_f32 v76, v76, v144
v_add_f32 v77, v77, v144
v_add_f32 v78, v78, v144
v_add_f32 v79, v79, v144
v_mfma_f32_32x32x16_bf16 v[80:95], a[212:215], v[180:183], v[80:95]
v_exp_f32 v64, v64
v_exp_f32 v65, v65
v_add_f32 v20, v20, v64
v_exp_f32 v66, v66
v_mfma_f32_32x32x16_bf16 v[80:95], a[216:219], v[184:187], v[80:95]
v_add_f32 v20, v20, v65
v_cvt_pk_bf16_f32 v96, v64, v65
v_exp_f32 v67, v67
v_add_f32 v20, v20, v66
v_exp_f32 v68, v68
v_mfma_f32_32x32x16_bf16 v[80:95], a[220:223], v[188:191], v[80:95]
v_add_f32 v20, v20, v67
v_cvt_pk_bf16_f32 v97, v66, v67
v_exp_f32 v69, v69
v_add_f32 v20, v20, v68
v_exp_f32 v70, v70
v_mfma_f32_32x32x16_bf16 a[64:79], a[224:227], v[104:107], a[64:79]
v_add_f32 v20, v20, v69
v_cvt_pk_bf16_f32 v98, v68, v69
v_exp_f32 v71, v71
v_add_f32 v20, v20, v70
v_exp_f32 v72, v72
v_mfma_f32_32x32x16_bf16 a[80:95], a[228:231], v[104:107], a[80:95]
s_add_u32 m0, s28, 57344
v_add_f32 v20, v20, v71
v_cvt_pk_bf16_f32 v99, v70, v71
v_exp_f32 v73, v73
v_add_f32 v20, v20, v72
v_mfma_f32_32x32x16_bf16 a[96:111], a[232:235], v[104:107], a[96:111]
s_waitcnt vmcnt(5)
buffer_load_dwordx4 v17, s[12:15], s47 offen offset:2048 nt lds
v_exp_f32 v74, v74
v_add_f32 v20, v20, v73
v_cvt_pk_bf16_f32 v100, v72, v73
v_mfma_f32_32x32x16_bf16 a[112:127], a[236:239], v[104:107], a[112:127]
v_exp_f32 v75, v75
v_add_f32 v20, v20, v74
v_exp_f32 v76, v76
v_add_f32 v20, v20, v75
v_cvt_pk_bf16_f32 v101, v74, v75
v_mfma_f32_32x32x16_bf16 a[64:79], a[240:243], v[108:111], a[64:79]
v_exp_f32 v77, v77
v_add_f32 v20, v20, v76
v_exp_f32 v78, v78
v_add_f32 v20, v20, v77
v_cvt_pk_bf16_f32 v102, v76, v77
v_mfma_f32_32x32x16_bf16 a[80:95], a[244:247], v[108:111], a[80:95]
v_exp_f32 v79, v79
v_add_f32 v20, v20, v78
v_add_f32 v20, v20, v79
v_cvt_pk_bf16_f32 v103, v78, v79
v_mov_b32 v145, v144
v_mov_b32 v146, v144
v_mfma_f32_32x32x16_bf16 a[96:111], a[248:251], v[108:111], a[96:111]
v_mov_b32 v147, v144
v_mov_b32 v148, v144
v_mov_b32 v149, v144
v_mov_b32 v150, v144
v_mov_b32 v151, v144
v_mov_b32 v152, v144
v_mfma_f32_32x32x16_bf16 a[112:127], a[252:255], v[108:111], a[112:127]
v_mov_b32 v153, v144
v_mov_b32 v154, v144
v_mov_b32 v155, v144
v_mov_b32 v156, v144
v_mov_b32 v157, v144
v_mov_b32 v158, v144
v_mov_b32 v159, v144
L_slot3:
v_mfma_f32_32x32x16_bf16 v[64:79], a[192:195], v[192:195], v[128:143]
s_barrier
s_add_u32 m0, s28, 57344
v_exp_f32 v80, v80
v_mfma_f32_32x32x16_bf16 v[64:79], a[196:199], v[196:199], v[64:79]
s_waitcnt vmcnt(5)
buffer_load_dwordx4 v17, s[12:15], s47 offen offset:3072 nt lds
s_add_u32 s55, s55, 8192
s_and_b32 s55, s55, 0x1ffff
v_exp_f32 v81, v81
v_mfma_f32_32x32x16_bf16 v[64:79], a[200:203], v[200:203], v[64:79]
v_add_f32 v18, v18, v80
v_exp_f32 v82, v82
v_add_f32 v18, v18, v81
v_cvt_pk_bf16_f32 v104, v80, v81
v_mfma_f32_32x32x16_bf16 v[64:79], a[204:207], v[204:207], v[64:79]
v_exp_f32 v83, v83
v_add_f32 v18, v18, v82
v_exp_f32 v84, v84
v_add_f32 v18, v18, v83
v_mfma_f32_32x32x16_bf16 v[64:79], a[208:211], v[208:211], v[64:79]
v_cvt_pk_bf16_f32 v105, v82, v83
v_exp_f32 v85, v85
v_add_f32 v18, v18, v84
v_mfma_f32_32x32x16_bf16 v[64:79], a[212:215], v[212:215], v[64:79]
v_exp_f32 v86, v86
v_add_f32 v18, v18, v85
v_cvt_pk_bf16_f32 v106, v84, v85
v_exp_f32 v87, v87
v_mfma_f32_32x32x16_bf16 v[64:79], a[216:219], v[216:219], v[64:79]
s_add_u32 m0, s28, 8192
s_add_u32 s46, s29, s54
v_add_f32 v18, v18, v86
v_exp_f32 v88, v88
v_add_f32 v18, v18, v87
v_mfma_f32_32x32x16_bf16 v[64:79], a[220:223], v[220:223], v[64:79]
s_waitcnt vmcnt(5)
buffer_load_dwordx4 v13, s[8:11], s46 offen offset:0 nt lds
v_cvt_pk_bf16_f32 v107, v86, v87
v_exp_f32 v89, v89
v_mfma_f32_32x32x16_bf16 a[128:143], a[224:227], v[96:99], a[128:143]
ds_read_b64_tr_b16 a[224:225], v9 offset:8192
ds_read_b64_tr_b16 a[226:227], v9 offset:10240
v_add_f32 v18, v18, v88
v_exp_f32 v90, v90
v_mfma_f32_32x32x16_bf16 a[144:159], a[228:231], v[96:99], a[144:159]
ds_read_b64_tr_b16 a[228:229], v10 offset:8192
ds_read_b64_tr_b16 a[230:231], v10 offset:10240
v_add_f32 v18, v18, v89
v_cvt_pk_bf16_f32 v108, v88, v89
v_exp_f32 v91, v91
v_mfma_f32_32x32x16_bf16 a[160:175], a[232:235], v[96:99], a[160:175]
ds_read_b64_tr_b16 a[232:233], v11 offset:8192
ds_read_b64_tr_b16 a[234:235], v11 offset:10240
v_add_f32 v18, v18, v90
v_exp_f32 v92, v92
v_mfma_f32_32x32x16_bf16 a[176:191], a[236:239], v[96:99], a[176:191]
ds_read_b64_tr_b16 a[236:237], v12 offset:8192
ds_read_b64_tr_b16 a[238:239], v12 offset:10240
v_add_f32 v18, v18, v91
v_cvt_pk_bf16_f32 v109, v90, v91
v_exp_f32 v93, v93
v_mfma_f32_32x32x16_bf16 a[128:143], a[240:243], v[100:103], a[128:143]
ds_read_b64_tr_b16 a[240:241], v9 offset:12288
ds_read_b64_tr_b16 a[242:243], v9 offset:14336
v_add_f32 v18, v18, v92
v_exp_f32 v94, v94
v_mfma_f32_32x32x16_bf16 a[144:159], a[244:247], v[100:103], a[144:159]
ds_read_b64_tr_b16 a[244:245], v10 offset:12288
ds_read_b64_tr_b16 a[246:247], v10 offset:14336
s_add_u32 m0, s28, 8192
v_add_f32 v18, v18, v93
v_cvt_pk_bf16_f32 v110, v92, v93
v_mfma_f32_32x32x16_bf16 a[160:175], a[248:251], v[100:103], a[160:175]
ds_read_b64_tr_b16 a[248:249], v11 offset:12288
ds_read_b64_tr_b16 a[250:251], v11 offset:14336
s_waitcnt vmcnt(5)
buffer_load_dwordx4 v14, s[8:11], s46 offen offset:1024 nt lds
v_exp_f32 v95, v95
v_mfma_f32_32x32x16_bf16 a[176:191], a[252:255], v[100:103], a[176:191]
ds_read_b64_tr_b16 a[252:253], v12 offset:12288
ds_read_b64_tr_b16 a[254:255], v12 offset:14336
v_add_f32 v18, v18, v94
v_add_f32 v18, v18, v95
v_cvt_pk_bf16_f32 v111, v94, v95
v_mfma_f32_32x32x16_bf16 v[80:95], a[192:195], v[224:227], v[144:159]
ds_read_b128 a[192:195], v1 offset:16384
v_exp_f32 v64, v64
v_exp_f32 v65, v65
v_mfma_f32_32x32x16_bf16 v[80:95], a[196:199], v[228:231], v[80:95]
ds_read_b128 a[196:199], v2 offset:16384
v_add_f32 v19, v19, v64
v_exp_f32 v66, v66
v_mfma_f32_32x32x16_bf16 v[80:95], a[200:203], v[232:235], v[80:95]
ds_read_b128 a[200:203], v3 offset:16384
v_add_f32 v19, v19, v65
v_cvt_pk_bf16_f32 v96, v64, v65
v_exp_f32 v67, v67
v_mfma_f32_32x32x16_bf16 v[80:95], a[204:207], v[236:239], v[80:95]
ds_read_b128 a[204:207], v4 offset:16384
s_add_u32 m0, s28, 8192
v_add_f32 v19, v19, v66
v_exp_f32 v68, v68
v_mfma_f32_32x32x16_bf16 v[80:95], a[208:211], v[240:243], v[80:95]
ds_read_b128 a[208:211], v5 offset:16384
s_waitcnt vmcnt(5)
buffer_load_dwordx4 v15, s[8:11], s46 offen offset:2048 nt lds
v_add_f32 v19, v19, v67
v_mfma_f32_32x32x16_bf16 v[80:95], a[212:215], v[244:247], v[80:95]
ds_read_b128 a[212:215], v6 offset:16384
v_cvt_pk_bf16_f32 v97, v66, v67
v_exp_f32 v69, v69
v_mfma_f32_32x32x16_bf16 v[80:95], a[216:219], v[248:251], v[80:95]
ds_read_b128 a[216:219], v7 offset:16384
v_add_f32 v19, v19, v68
v_exp_f32 v70, v70
v_add_f32 v19, v19, v69
v_mfma_f32_32x32x16_bf16 v[80:95], a[220:223], v[252:255], v[80:95]
ds_read_b128 a[220:223], v8 offset:16384
v_cvt_pk_bf16_f32 v98, v68, v69
v_exp_f32 v71, v71
s_waitcnt lgkmcnt(8)
v_mfma_f32_32x32x16_bf16 a[0:15], a[224:227], v[104:107], a[0:15]
v_add_f32 v19, v19, v70
v_exp_f32 v72, v72
v_add_f32 v19, v19, v71
v_cvt_pk_bf16_f32 v99, v70, v71
v_mfma_f32_32x32x16_bf16 a[16:31], a[228:231], v[104:107], a[16:31]
v_exp_f32 v73, v73
v_add_f32 v19, v19, v72
v_exp_f32 v74, v74
v_mfma_f32_32x32x16_bf16 a[32:47], a[232:235], v[104:107], a[32:47]
s_add_u32 m0, s28, 8192
v_add_f32 v19, v19, v73
v_cvt_pk_bf16_f32 v100, v72, v73
v_mfma_f32_32x32x16_bf16 a[48:63], a[236:239], v[104:107], a[48:63]
s_waitcnt vmcnt(5)
buffer_load_dwordx4 v16, s[8:11], s46 offen offset:3072 nt lds
s_add_u32 s54, s54, 8192
s_and_b32 s54, s54, 0x1ffff
v_exp_f32 v75, v75
v_mfma_f32_32x32x16_bf16 a[0:15], a[240:243], v[108:111], a[0:15]
v_add_f32 v19, v19, v74
v_exp_f32 v76, v76
v_add_f32 v19, v19, v75
v_mfma_f32_32x32x16_bf16 a[16:31], a[244:247], v[108:111], a[16:31]
v_cvt_pk_bf16_f32 v101, v74, v75
v_exp_f32 v77, v77
v_add_f32 v19, v19, v76
v_mfma_f32_32x32x16_bf16 a[32:47], a[248:251], v[108:111], a[32:47]
v_exp_f32 v78, v78
v_add_f32 v19, v19, v77
v_cvt_pk_bf16_f32 v102, v76, v77
v_mfma_f32_32x32x16_bf16 a[48:63], a[252:255], v[108:111], a[48:63]
v_exp_f32 v79, v79
v_add_f32 v19, v19, v78
v_add_f32 v19, v19, v79
v_cvt_pk_bf16_f32 v103, v78, v79
s_waitcnt lgkmcnt(0)
v_mfma_f32_32x32x16_bf16 v[64:79], a[192:195], v[160:163], v[112:127]
v_exp_f32 v80, v80
v_exp_f32 v81, v81
v_mfma_f32_32x32x16_bf16 v[64:79], a[196:199], v[164:167], v[64:79]
s_add_u32 m0, s28, 32768
s_add_u32 s47, s29, s55
v_add_f32 v20, v20, v80
v_exp_f32 v82, v82
v_mfma_f32_32x32x16_bf16 v[64:79], a[200:203], v[168:171], v[64:79]
s_waitcnt vmcnt(5)
buffer_load_dwordx4 v17, s[12:15], s47 offen offset:0 nt lds
v_add_f32 v20, v20, v81
v_mfma_f32_32x32x16_bf16 v[64:79], a[204:207], v[172:175], v[64:79]
v_cvt_pk_bf16_f32 v104, v80, v81
v_exp_f32 v83, v83
v_add_f32 v20, v20, v82
v_mfma_f32_32x32x16_bf16 v[64:79], a[208:211], v[176:179], v[64:79]
v_exp_f32 v84, v84
v_add_f32 v20, v20, v83
v_cvt_pk_bf16_f32 v105, v82, v83
v_mfma_f32_32x32x16_bf16 v[64:79], a[212:215], v[180:183], v[64:79]
v_exp_f32 v85, v85
v_add_f32 v20, v20, v84
v_exp_f32 v86, v86
v_mfma_f32_32x32x16_bf16 v[64:79], a[216:219], v[184:187], v[64:79]
v_add_f32 v20, v20, v85
v_cvt_pk_bf16_f32 v106, v84, v85
v_exp_f32 v87, v87
v_mfma_f32_32x32x16_bf16 v[64:79], a[220:223], v[188:191], v[64:79]
s_add_u32 m0, s28, 32768
v_add_f32 v20, v20, v86
v_exp_f32 v88, v88
v_mfma_f32_32x32x16_bf16 a[64:79], a[224:227], v[96:99], a[64:79]
s_waitcnt vmcnt(5)
buffer_load_dwordx4 v17, s[12:15], s47 offen offset:1024 nt lds
v_add_f32 v20, v20, v87
v_cvt_pk_bf16_f32 v107, v86, v87
v_mfma_f32_32x32x16_bf16 a[80:95], a[228:231], v[96:99], a[80:95]
v_exp_f32 v89, v89
v_add_f32 v20, v20, v88
v_exp_f32 v90, v90
v_mfma_f32_32x32x16_bf16 a[96:111], a[232:235], v[96:99], a[96:111]
v_add_f32 v20, v20, v89
v_cvt_pk_bf16_f32 v108, v88, v89
v_exp_f32 v91, v91
v_mfma_f32_32x32x16_bf16 a[112:127], a[236:239], v[96:99], a[112:127]
v_add_f32 v20, v20, v90
v_exp_f32 v92, v92
v_add_f32 v20, v20, v91
v_mfma_f32_32x32x16_bf16 a[64:79], a[240:243], v[100:103], a[64:79]
v_cvt_pk_bf16_f32 v109, v90, v91
v_exp_f32 v93, v93
v_add_f32 v20, v20, v92
v_mfma_f32_32x32x16_bf16 a[80:95], a[244:247], v[100:103], a[80:95]
v_exp_f32 v94, v94
v_add_f32 v20, v20, v93
v_cvt_pk_bf16_f32 v110, v92, v93
v_mfma_f32_32x32x16_bf16 a[96:111], a[248:251], v[100:103], a[96:111]
s_add_u32 m0, s28, 32768
v_exp_f32 v95, v95
v_add_f32 v20, v20, v94
v_mfma_f32_32x32x16_bf16 a[112:127], a[252:255], v[100:103], a[112:127]
s_waitcnt vmcnt(5)
buffer_load_dwordx4 v17, s[12:15], s47 offen offset:2048 nt lds
v_add_f32 v20, v20, v95
v_cvt_pk_bf16_f32 v111, v94, v95
v_mfma_f32_32x32x16_bf16 v[80:95], a[192:195], v[192:195], v[128:143]
s_barrier
v_exp_f32 v64, v64
v_exp_f32 v65, v65
v_mfma_f32_32x32x16_bf16 v[80:95], a[196:199], v[196:199], v[80:95]
v_add_f32 v18, v18, v64
v_exp_f32 v66, v66
v_add_f32 v18, v18, v65
v_mfma_f32_32x32x16_bf16 v[80:95], a[200:203], v[200:203], v[80:95]
v_cvt_pk_bf16_f32 v96, v64, v65
v_exp_f32 v67, v67
v_add_f32 v18, v18, v66
v_exp_f32 v68, v68
v_mfma_f32_32x32x16_bf16 v[80:95], a[204:207], v[204:207], v[80:95]
v_add_f32 v18, v18, v67
v_cvt_pk_bf16_f32 v97, v66, v67
v_exp_f32 v69, v69
v_add_f32 v18, v18, v68
v_mfma_f32_32x32x16_bf16 v[80:95], a[208:211], v[208:211], v[80:95]
v_exp_f32 v70, v70
v_add_f32 v18, v18, v69
v_cvt_pk_bf16_f32 v98, v68, v69
v_mfma_f32_32x32x16_bf16 v[80:95], a[212:215], v[212:215], v[80:95]
s_add_u32 m0, s28, 32768
v_exp_f32 v71, v71
v_add_f32 v18, v18, v70
v_exp_f32 v72, v72
v_mfma_f32_32x32x16_bf16 v[80:95], a[216:219], v[216:219], v[80:95]
s_waitcnt vmcnt(5)
buffer_load_dwordx4 v17, s[12:15], s47 offen offset:3072 nt lds
s_add_u32 s55, s55, 8192
s_and_b32 s55, s55, 0x1ffff
v_add_f32 v18, v18, v71
v_mfma_f32_32x32x16_bf16 v[80:95], a[220:223], v[220:223], v[80:95]
v_cvt_pk_bf16_f32 v99, v70, v71
v_exp_f32 v73, v73
v_add_f32 v18, v18, v72
v_exp_f32 v74, v74
v_mfma_f32_32x32x16_bf16 a[128:143], a[224:227], v[104:107], a[128:143]
ds_read_b64_tr_b16 a[224:225], v9 offset:16384
ds_read_b64_tr_b16 a[226:227], v9 offset:18432
v_add_f32 v18, v18, v73
v_cvt_pk_bf16_f32 v100, v72, v73
v_mfma_f32_32x32x16_bf16 a[144:159], a[228:231], v[104:107], a[144:159]
ds_read_b64_tr_b16 a[228:229], v10 offset:16384
ds_read_b64_tr_b16 a[230:231], v10 offset:18432
v_exp_f32 v75, v75
v_add_f32 v18, v18, v74
v_mfma_f32_32x32x16_bf16 a[160:175], a[232:235], v[104:107], a[160:175]
ds_read_b64_tr_b16 a[232:233], v11 offset:16384
ds_read_b64_tr_b16 a[234:235], v11 offset:18432
v_exp_f32 v76, v76
v_add_f32 v18, v18, v75
v_cvt_pk_bf16_f32 v101, v74, v75
v_mfma_f32_32x32x16_bf16 a[176:191], a[236:239], v[104:107], a[176:191]
ds_read_b64_tr_b16 a[236:237], v12 offset:16384
ds_read_b64_tr_b16 a[238:239], v12 offset:18432
s_add_u32 m0, s28, 16384
s_add_u32 s46, s29, s54
v_exp_f32 v77, v77
v_mfma_f32_32x32x16_bf16 a[128:143], a[240:243], v[108:111], a[128:143]
ds_read_b64_tr_b16 a[240:241], v9 offset:20480
ds_read_b64_tr_b16 a[242:243], v9 offset:22528
s_waitcnt vmcnt(5)
buffer_load_dwordx4 v13, s[8:11], s46 offen offset:0 nt lds
v_mfma_f32_32x32x16_bf16 a[144:159], a[244:247], v[108:111], a[144:159]
ds_read_b64_tr_b16 a[244:245], v10 offset:20480
ds_read_b64_tr_b16 a[246:247], v10 offset:22528
v_add_f32 v18, v18, v76
v_exp_f32 v78, v78
v_add_f32 v18, v18, v77
v_mfma_f32_32x32x16_bf16 a[160:175], a[248:251], v[108:111], a[160:175]
ds_read_b64_tr_b16 a[248:249], v11 offset:20480
ds_read_b64_tr_b16 a[250:251], v11 offset:22528
v_cvt_pk_bf16_f32 v102, v76, v77
v_exp_f32 v79, v79
v_mfma_f32_32x32x16_bf16 a[176:191], a[252:255], v[108:111], a[176:191]
ds_read_b64_tr_b16 a[252:253], v12 offset:20480
ds_read_b64_tr_b16 a[254:255], v12 offset:22528
v_add_f32 v18, v18, v78
v_add_f32 v18, v18, v79
v_cvt_pk_bf16_f32 v103, v78, v79
v_mfma_f32_32x32x16_bf16 v[64:79], a[192:195], v[224:227], v[144:159]
ds_read_b128 a[192:195], v1 offset:24576
v_exp_f32 v80, v80
v_exp_f32 v81, v81
v_mfma_f32_32x32x16_bf16 v[64:79], a[196:199], v[228:231], v[64:79]
ds_read_b128 a[196:199], v2 offset:24576
v_add_f32 v19, v19, v80
v_exp_f32 v82, v82
v_mfma_f32_32x32x16_bf16 v[64:79], a[200:203], v[232:235], v[64:79]
ds_read_b128 a[200:203], v3 offset:24576
s_add_u32 m0, s28, 16384
v_add_f32 v19, v19, v81
v_cvt_pk_bf16_f32 v104, v80, v81
v_mfma_f32_32x32x16_bf16 v[64:79], a[204:207], v[236:239], v[64:79]
ds_read_b128 a[204:207], v4 offset:24576
s_waitcnt vmcnt(5)
buffer_load_dwordx4 v14, s[8:11], s46 offen offset:1024 nt lds
v_exp_f32 v83, v83
v_mfma_f32_32x32x16_bf16 v[64:79], a[208:211], v[240:243], v[64:79]
ds_read_b128 a[208:211], v5 offset:24576
v_add_f32 v19, v19, v82
v_exp_f32 v84, v84
v_mfma_f32_32x32x16_bf16 v[64:79], a[212:215], v[244:247], v[64:79]
ds_read_b128 a[212:215], v6 offset:24576
v_add_f32 v19, v19, v83
v_cvt_pk_bf16_f32 v105, v82, v83
v_exp_f32 v85, v85
v_mfma_f32_32x32x16_bf16 v[64:79], a[216:219], v[248:251], v[64:79]
ds_read_b128 a[216:219], v7 offset:24576
v_add_f32 v19, v19, v84
v_exp_f32 v86, v86
v_mfma_f32_32x32x16_bf16 v[64:79], a[220:223], v[252:255], v[64:79]
ds_read_b128 a[220:223], v8 offset:24576
v_add_f32 v19, v19, v85
v_cvt_pk_bf16_f32 v106, v84, v85
v_exp_f32 v87, v87
s_waitcnt lgkmcnt(8)
v_mfma_f32_32x32x16_bf16 a[0:15], a[224:227], v[96:99], a[0:15]
v_add_f32 v19, v19, v86
v_exp_f32 v88, v88
v_mfma_f32_32x32x16_bf16 a[16:31], a[228:231], v[96:99], a[16:31]
s_add_u32 m0, s28, 16384
v_add_f32 v19, v19, v87
v_cvt_pk_bf16_f32 v107, v86, v87
v_exp_f32 v89, v89
v_mfma_f32_32x32x16_bf16 a[32:47], a[232:235], v[96:99], a[32:47]
s_waitcnt vmcnt(5)
buffer_load_dwordx4 v15, s[8:11], s46 offen offset:2048 nt lds
v_add_f32 v19, v19, v88
v_exp_f32 v90, v90
v_mfma_f32_32x32x16_bf16 a[48:63], a[236:239], v[96:99], a[48:63]
v_add_f32 v19, v19, v89
v_cvt_pk_bf16_f32 v108, v88, v89
v_exp_f32 v91, v91
v_mfma_f32_32x32x16_bf16 a[0:15], a[240:243], v[100:103], a[0:15]
v_add_f32 v19, v19, v90
v_exp_f32 v92, v92
v_add_f32 v19, v19, v91
v_mfma_f32_32x32x16_bf16 a[16:31], a[244:247], v[100:103], a[16:31]
v_cvt_pk_bf16_f32 v109, v90, v91
v_exp_f32 v93, v93
v_add_f32 v19, v19, v92
v_mfma_f32_32x32x16_bf16 a[32:47], a[248:251], v[100:103], a[32:47]
v_exp_f32 v94, v94
v_add_f32 v19, v19, v93
v_cvt_pk_bf16_f32 v110, v92, v93
v_mfma_f32_32x32x16_bf16 a[48:63], a[252:255], v[100:103], a[48:63]
v_exp_f32 v95, v95
v_add_f32 v19, v19, v94
v_add_f32 v19, v19, v95
v_cvt_pk_bf16_f32 v111, v94, v95
s_waitcnt lgkmcnt(0)
v_mfma_f32_32x32x16_bf16 v[80:95], a[192:195], v[160:163], v[112:127]
s_add_u32 m0, s28, 16384
v_exp_f32 v64, v64
v_exp_f32 v65, v65
v_mfma_f32_32x32x16_bf16 v[80:95], a[196:199], v[164:167], v[80:95]
s_waitcnt vmcnt(5)
buffer_load_dwordx4 v16, s[8:11], s46 offen offset:3072 nt lds
s_add_u32 s54, s54, 8192
s_and_b32 s54, s54, 0x1ffff
v_mfma_f32_32x32x16_bf16 v[80:95], a[200:203], v[168:171], v[80:95]
v_add_f32 v20, v20, v64
v_exp_f32 v66, v66
v_add_f32 v20, v20, v65
v_mfma_f32_32x32x16_bf16 v[80:95], a[204:207], v[172:175], v[80:95]
v_cvt_pk_bf16_f32 v96, v64, v65
v_exp_f32 v67, v67
v_add_f32 v20, v20, v66
v_mfma_f32_32x32x16_bf16 v[80:95], a[208:211], v[176:179], v[80:95]
v_exp_f32 v68, v68
v_add_f32 v20, v20, v67
v_cvt_pk_bf16_f32 v97, v66, v67
v_mfma_f32_32x32x16_bf16 v[80:95], a[212:215], v[180:183], v[80:95]
v_exp_f32 v69, v69
v_add_f32 v20, v20, v68
v_exp_f32 v70, v70
v_mfma_f32_32x32x16_bf16 v[80:95], a[216:219], v[184:187], v[80:95]
s_add_u32 m0, s28, 40960
s_add_u32 s47, s29, s55
v_add_f32 v20, v20, v69
v_cvt_pk_bf16_f32 v98, v68, v69
v_mfma_f32_32x32x16_bf16 v[80:95], a[220:223], v[188:191], v[80:95]
s_waitcnt vmcnt(5)
buffer_load_dwordx4 v17, s[12:15], s47 offen offset:0 nt lds
v_exp_f32 v71, v71
v_mfma_f32_32x32x16_bf16 a[64:79], a[224:227], v[104:107], a[64:79]
v_add_f32 v20, v20, v70
v_exp_f32 v72, v72
v_add_f32 v20, v20, v71
v_mfma_f32_32x32x16_bf16 a[80:95], a[228:231], v[104:107], a[80:95]
v_cvt_pk_bf16_f32 v99, v70, v71
v_exp_f32 v73, v73
v_add_f32 v20, v20, v72
v_mfma_f32_32x32x16_bf16 a[96:111], a[232:235], v[104:107], a[96:111]
v_exp_f32 v74, v74
v_add_f32 v20, v20, v73
v_cvt_pk_bf16_f32 v100, v72, v73
v_mfma_f32_32x32x16_bf16 a[112:127], a[236:239], v[104:107], a[112:127]
v_exp_f32 v75, v75
v_add_f32 v20, v20, v74
v_exp_f32 v76, v76
v_mfma_f32_32x32x16_bf16 a[64:79], a[240:243], v[108:111], a[64:79]
v_add_f32 v20, v20, v75
v_cvt_pk_bf16_f32 v101, v74, v75
v_exp_f32 v77, v77
v_mfma_f32_32x32x16_bf16 a[80:95], a[244:247], v[108:111], a[80:95]
s_add_u32 m0, s28, 40960
v_add_f32 v20, v20, v76
v_exp_f32 v78, v78
v_add_f32 v20, v20, v77
v_mfma_f32_32x32x16_bf16 a[96:111], a[248:251], v[108:111], a[96:111]
s_waitcnt vmcnt(5)
buffer_load_dwordx4 v17, s[12:15], s47 offen offset:1024 nt lds
v_cvt_pk_bf16_f32 v102, v76, v77
v_mfma_f32_32x32x16_bf16 a[112:127], a[252:255], v[108:111], a[112:127]
v_exp_f32 v79, v79
v_add_f32 v20, v20, v78
v_add_f32 v20, v20, v79
v_cvt_pk_bf16_f32 v103, v78, v79
v_mfma_f32_32x32x16_bf16 v[64:79], a[192:195], v[192:195], v[128:143]
s_barrier
v_exp_f32 v80, v80
v_exp_f32 v81, v81
v_mfma_f32_32x32x16_bf16 v[64:79], a[196:199], v[196:199], v[64:79]
v_add_f32 v18, v18, v80
v_exp_f32 v82, v82
v_add_f32 v18, v18, v81
v_mfma_f32_32x32x16_bf16 v[64:79], a[200:203], v[200:203], v[64:79]
v_cvt_pk_bf16_f32 v104, v80, v81
v_exp_f32 v83, v83
v_add_f32 v18, v18, v82
v_exp_f32 v84, v84
v_mfma_f32_32x32x16_bf16 v[64:79], a[204:207], v[204:207], v[64:79]
s_add_u32 m0, s28, 40960
v_add_f32 v18, v18, v83
v_cvt_pk_bf16_f32 v105, v82, v83
v_exp_f32 v85, v85
v_mfma_f32_32x32x16_bf16 v[64:79], a[208:211], v[208:211], v[64:79]
s_waitcnt vmcnt(5)
buffer_load_dwordx4 v17, s[12:15], s47 offen offset:2048 nt lds
v_add_f32 v18, v18, v84
v_exp_f32 v86, v86
v_mfma_f32_32x32x16_bf16 v[64:79], a[212:215], v[212:215], v[64:79]
v_add_f32 v18, v18, v85
v_cvt_pk_bf16_f32 v106, v84, v85
v_exp_f32 v87, v87
v_add_f32 v18, v18, v86
v_mfma_f32_32x32x16_bf16 v[64:79], a[216:219], v[216:219], v[64:79]
v_exp_f32 v88, v88
v_add_f32 v18, v18, v87
v_cvt_pk_bf16_f32 v107, v86, v87
v_mfma_f32_32x32x16_bf16 v[64:79], a[220:223], v[220:223], v[64:79]
v_exp_f32 v89, v89
v_add_f32 v18, v18, v88
v_exp_f32 v90, v90
v_add_f32 v18, v18, v89
v_mfma_f32_32x32x16_bf16 a[128:143], a[224:227], v[96:99], a[128:143]
ds_read_b64_tr_b16 a[224:225], v9 offset:24576
ds_read_b64_tr_b16 a[226:227], v9 offset:26624
v_cvt_pk_bf16_f32 v108, v88, v89
v_exp_f32 v91, v91
v_mfma_f32_32x32x16_bf16 a[144:159], a[228:231], v[96:99], a[144:159]
ds_read_b64_tr_b16 a[228:229], v10 offset:24576
ds_read_b64_tr_b16 a[230:231], v10 offset:26624
v_add_f32 v18, v18, v90
v_exp_f32 v92, v92
v_mfma_f32_32x32x16_bf16 a[160:175], a[232:235], v[96:99], a[160:175]
ds_read_b64_tr_b16 a[232:233], v11 offset:24576
ds_read_b64_tr_b16 a[234:235], v11 offset:26624
s_add_u32 m0, s28, 40960
v_add_f32 v18, v18, v91
v_cvt_pk_bf16_f32 v109, v90, v91
v_mfma_f32_32x32x16_bf16 a[176:191], a[236:239], v[96:99], a[176:191]
ds_read_b64_tr_b16 a[236:237], v12 offset:24576
ds_read_b64_tr_b16 a[238:239], v12 offset:26624
s_waitcnt vmcnt(5)
buffer_load_dwordx4 v17, s[12:15], s47 offen offset:3072 nt lds
s_add_u32 s55, s55, 8192
s_and_b32 s55, s55, 0x1ffff
v_mfma_f32_32x32x16_bf16 a[128:143], a[240:243], v[100:103], a[128:143]
ds_read_b64_tr_b16 a[240:241], v9 offset:28672
ds_read_b64_tr_b16 a[242:243], v9 offset:30720
v_exp_f32 v93, v93
v_add_f32 v18, v18, v92
v_mfma_f32_32x32x16_bf16 a[144:159], a[244:247], v[100:103], a[144:159]
ds_read_b64_tr_b16 a[244:245], v10 offset:28672
ds_read_b64_tr_b16 a[246:247], v10 offset:30720
v_exp_f32 v94, v94
v_add_f32 v18, v18, v93
v_mfma_f32_32x32x16_bf16 a[160:175], a[248:251], v[100:103], a[160:175]
ds_read_b64_tr_b16 a[248:249], v11 offset:28672
ds_read_b64_tr_b16 a[250:251], v11 offset:30720
v_cvt_pk_bf16_f32 v110, v92, v93
v_exp_f32 v95, v95
v_mfma_f32_32x32x16_bf16 a[176:191], a[252:255], v[100:103], a[176:191]
ds_read_b64_tr_b16 a[252:253], v12 offset:28672
ds_read_b64_tr_b16 a[254:255], v12 offset:30720
v_add_f32 v18, v18, v94
v_add_f32 v18, v18, v95
v_cvt_pk_bf16_f32 v111, v94, v95
v_mfma_f32_32x32x16_bf16 v[80:95], a[192:195], v[224:227], v[144:159]
ds_read_b128 a[192:195], v1 offset:0
v_exp_f32 v64, v64
v_exp_f32 v65, v65
v_mfma_f32_32x32x16_bf16 v[80:95], a[196:199], v[228:231], v[80:95]
ds_read_b128 a[196:199], v2 offset:0
s_add_u32 m0, s28, 24576
s_add_u32 s46, s29, s54
v_add_f32 v19, v19, v64
v_mfma_f32_32x32x16_bf16 v[80:95], a[200:203], v[232:235], v[80:95]
ds_read_b128 a[200:203], v3 offset:0
s_waitcnt vmcnt(5)
buffer_load_dwordx4 v13, s[8:11], s46 offen offset:0 nt lds
v_exp_f32 v66, v66
v_mfma_f32_32x32x16_bf16 v[80:95], a[204:207], v[236:239], v[80:95]
ds_read_b128 a[204:207], v4 offset:0
v_add_f32 v19, v19, v65
v_cvt_pk_bf16_f32 v96, v64, v65
v_exp_f32 v67, v67
v_mfma_f32_32x32x16_bf16 v[80:95], a[208:211], v[240:243], v[80:95]
ds_read_b128 a[208:211], v5 offset:0
v_add_f32 v19, v19, v66
v_exp_f32 v68, v68
v_mfma_f32_32x32x16_bf16 v[80:95], a[212:215], v[244:247], v[80:95]
ds_read_b128 a[212:215], v6 offset:0
v_add_f32 v19, v19, v67
v_cvt_pk_bf16_f32 v97, v66, v67
v_exp_f32 v69, v69
v_mfma_f32_32x32x16_bf16 v[80:95], a[216:219], v[248:251], v[80:95]
ds_read_b128 a[216:219], v7 offset:0
v_add_f32 v19, v19, v68
v_exp_f32 v70, v70
v_mfma_f32_32x32x16_bf16 v[80:95], a[220:223], v[252:255], v[80:95]
ds_read_b128 a[220:223], v8 offset:0
s_add_u32 m0, s28, 24576
v_add_f32 v19, v19, v69
v_cvt_pk_bf16_f32 v98, v68, v69
v_exp_f32 v71, v71
s_waitcnt lgkmcnt(8)
v_mfma_f32_32x32x16_bf16 a[0:15], a[224:227], v[104:107], a[0:15]
s_waitcnt vmcnt(5)
buffer_load_dwordx4 v14, s[8:11], s46 offen offset:1024 nt lds
v_add_f32 v19, v19, v70
v_mfma_f32_32x32x16_bf16 a[16:31], a[228:231], v[104:107], a[16:31]
v_exp_f32 v72, v72
v_add_f32 v19, v19, v71
v_cvt_pk_bf16_f32 v99, v70, v71
v_exp_f32 v73, v73
v_mfma_f32_32x32x16_bf16 a[32:47], a[232:235], v[104:107], a[32:47]
v_add_f32 v19, v19, v72
v_exp_f32 v74, v74
v_add_f32 v19, v19, v73
v_mfma_f32_32x32x16_bf16 a[48:63], a[236:239], v[104:107], a[48:63]
v_cvt_pk_bf16_f32 v100, v72, v73
v_exp_f32 v75, v75
v_add_f32 v19, v19, v74
v_mfma_f32_32x32x16_bf16 a[0:15], a[240:243], v[108:111], a[0:15]
v_exp_f32 v76, v76
v_add_f32 v19, v19, v75
v_cvt_pk_bf16_f32 v101, v74, v75
v_exp_f32 v77, v77
v_mfma_f32_32x32x16_bf16 a[16:31], a[244:247], v[108:111], a[16:31]
v_add_f32 v19, v19, v76
v_exp_f32 v78, v78
v_add_f32 v19, v19, v77
v_mfma_f32_32x32x16_bf16 a[32:47], a[248:251], v[108:111], a[32:47]
s_add_u32 m0, s28, 24576
v_cvt_pk_bf16_f32 v102, v76, v77
v_exp_f32 v79, v79
v_mfma_f32_32x32x16_bf16 a[48:63], a[252:255], v[108:111], a[48:63]
s_waitcnt vmcnt(5)
buffer_load_dwordx4 v15, s[8:11], s46 offen offset:2048 nt lds
v_add_f32 v19, v19, v78
v_add_f32 v19, v19, v79
v_cvt_pk_bf16_f32 v103, v78, v79
s_waitcnt lgkmcnt(0)
v_mfma_f32_32x32x16_bf16 v[64:79], a[192:195], v[160:163], v[112:127]
v_exp_f32 v80, v80
v_exp_f32 v81, v81
v_mfma_f32_32x32x16_bf16 v[64:79], a[196:199], v[164:167], v[64:79]
v_add_f32 v20, v20, v80
v_exp_f32 v82, v82
v_add_f32 v20, v20, v81
v_mfma_f32_32x32x16_bf16 v[64:79], a[200:203], v[168:171], v[64:79]
v_cvt_pk_bf16_f32 v104, v80, v81
v_exp_f32 v83, v83
v_add_f32 v20, v20, v82
v_mfma_f32_32x32x16_bf16 v[64:79], a[204:207], v[172:175], v[64:79]
v_exp_f32 v84, v84
v_add_f32 v20, v20, v83
v_cvt_pk_bf16_f32 v105, v82, v83
v_mfma_f32_32x32x16_bf16 v[64:79], a[208:211], v[176:179], v[64:79]
v_exp_f32 v85, v85
v_add_f32 v20, v20, v84
v_exp_f32 v86, v86
v_mfma_f32_32x32x16_bf16 v[64:79], a[212:215], v[180:183], v[64:79]
s_add_u32 m0, s28, 24576
v_add_f32 v20, v20, v85
v_cvt_pk_bf16_f32 v106, v84, v85
v_mfma_f32_32x32x16_bf16 v[64:79], a[216:219], v[184:187], v[64:79]
s_waitcnt vmcnt(5)
buffer_load_dwordx4 v16, s[8:11], s46 offen offset:3072 nt lds
s_add_u32 s54, s54, 8192
s_and_b32 s54, s54, 0x1ffff
v_mfma_f32_32x32x16_bf16 v[64:79], a[220:223], v[188:191], v[64:79]
v_exp_f32 v87, v87
v_add_f32 v20, v20, v86
v_exp_f32 v88, v88
v_mfma_f32_32x32x16_bf16 a[64:79], a[224:227], v[96:99], a[64:79]
v_add_f32 v20, v20, v87
v_cvt_pk_bf16_f32 v107, v86, v87
v_exp_f32 v89, v89
v_mfma_f32_32x32x16_bf16 a[80:95], a[228:231], v[96:99], a[80:95]
v_add_f32 v20, v20, v88
v_exp_f32 v90, v90
v_add_f32 v20, v20, v89
v_mfma_f32_32x32x16_bf16 a[96:111], a[232:235], v[96:99], a[96:111]
v_cvt_pk_bf16_f32 v108, v88, v89
v_exp_f32 v91, v91
v_add_f32 v20, v20, v90
v_mfma_f32_32x32x16_bf16 a[112:127], a[236:239], v[96:99], a[112:127]
s_add_u32 m0, s28, 49152
s_add_u32 s47, s29, s55
v_exp_f32 v92, v92
v_mfma_f32_32x32x16_bf16 a[64:79], a[240:243], v[100:103], a[64:79]
s_waitcnt vmcnt(5)
buffer_load_dwordx4 v17, s[12:15], s47 offen offset:0 nt lds
v_add_f32 v20, v20, v91
v_cvt_pk_bf16_f32 v109, v90, v91
v_mfma_f32_32x32x16_bf16 a[80:95], a[244:247], v[100:103], a[80:95]
v_exp_f32 v93, v93
v_add_f32 v20, v20, v92
v_mfma_f32_32x32x16_bf16 a[96:111], a[248:251], v[100:103], a[96:111]
v_exp_f32 v94, v94
v_add_f32 v20, v20, v93
v_cvt_pk_bf16_f32 v110, v92, v93
v_mfma_f32_32x32x16_bf16 a[112:127], a[252:255], v[100:103], a[112:127]
v_exp_f32 v95, v95
v_add_f32 v20, v20, v94
v_add_f32 v20, v20, v95
v_cvt_pk_bf16_f32 v111, v94, v95
v_mfma_f32_32x32x16_bf16 v[80:95], a[192:195], v[192:195], v[128:143]
s_barrier
v_exp_f32 v64, v64
v_exp_f32 v65, v65
v_mfma_f32_32x32x16_bf16 v[80:95], a[196:199], v[196:199], v[80:95]
v_add_f32 v18, v18, v64
v_exp_f32 v66, v66
v_add_f32 v18, v18, v65
v_mfma_f32_32x32x16_bf16 v[80:95], a[200:203], v[200:203], v[80:95]
s_add_u32 m0, s28, 49152
v_cvt_pk_bf16_f32 v96, v64, v65
v_exp_f32 v67, v67
v_add_f32 v18, v18, v66
v_mfma_f32_32x32x16_bf16 v[80:95], a[204:207], v[204:207], v[80:95]
s_waitcnt vmcnt(5)
buffer_load_dwordx4 v17, s[12:15], s47 offen offset:1024 nt lds
v_exp_f32 v68, v68
v_add_f32 v18, v18, v67
v_mfma_f32_32x32x16_bf16 v[80:95], a[208:211], v[208:211], v[80:95]
v_cvt_pk_bf16_f32 v97, v66, v67
v_exp_f32 v69, v69
v_add_f32 v18, v18, v68
v_exp_f32 v70, v70
v_mfma_f32_32x32x16_bf16 v[80:95], a[212:215], v[212:215], v[80:95]
v_add_f32 v18, v18, v69
v_cvt_pk_bf16_f32 v98, v68, v69
v_exp_f32 v71, v71
v_mfma_f32_32x32x16_bf16 v[80:95], a[216:219], v[216:219], v[80:95]
v_add_f32 v18, v18, v70
v_exp_f32 v72, v72
v_add_f32 v18, v18, v71
v_cvt_pk_bf16_f32 v99, v70, v71
v_mfma_f32_32x32x16_bf16 v[80:95], a[220:223], v[220:223], v[80:95]
v_exp_f32 v73, v73
v_add_f32 v18, v18, v72
v_exp_f32 v74, v74
v_mfma_f32_32x32x16_bf16 a[128:143], a[224:227], v[104:107], a[128:143]
ds_read_b64_tr_b16 a[224:225], v9 offset:0
ds_read_b64_tr_b16 a[226:227], v9 offset:2048
v_add_f32 v18, v18, v73
v_cvt_pk_bf16_f32 v100, v72, v73
v_exp_f32 v75, v75
v_mfma_f32_32x32x16_bf16 a[144:159], a[228:231], v[104:107], a[144:159]
ds_read_b64_tr_b16 a[228:229], v10 offset:0
ds_read_b64_tr_b16 a[230:231], v10 offset:2048
s_add_u32 m0, s28, 49152
v_add_f32 v18, v18, v74
v_mfma_f32_32x32x16_bf16 a[160:175], a[232:235], v[104:107], a[160:175]
ds_read_b64_tr_b16 a[232:233], v11 offset:0
ds_read_b64_tr_b16 a[234:235], v11 offset:2048
s_waitcnt vmcnt(5)
buffer_load_dwordx4 v17, s[12:15], s47 offen offset:2048 nt lds
v_exp_f32 v76, v76
v_mfma_f32_32x32x16_bf16 a[176:191], a[236:239], v[104:107], a[176:191]
ds_read_b64_tr_b16 a[236:237], v12 offset:0
ds_read_b64_tr_b16 a[238:239], v12 offset:2048
v_add_f32 v18, v18, v75
v_cvt_pk_bf16_f32 v101, v74, v75
v_mfma_f32_32x32x16_bf16 a[128:143], a[240:243], v[108:111], a[128:143]
ds_read_b64_tr_b16 a[240:241], v9 offset:4096
ds_read_b64_tr_b16 a[242:243], v9 offset:6144
v_exp_f32 v77, v77
v_add_f32 v18, v18, v76
v_mfma_f32_32x32x16_bf16 a[144:159], a[244:247], v[108:111], a[144:159]
ds_read_b64_tr_b16 a[244:245], v10 offset:4096
ds_read_b64_tr_b16 a[246:247], v10 offset:6144
v_exp_f32 v78, v78
v_add_f32 v18, v18, v77
v_mfma_f32_32x32x16_bf16 a[160:175], a[248:251], v[108:111], a[160:175]
ds_read_b64_tr_b16 a[248:249], v11 offset:4096
ds_read_b64_tr_b16 a[250:251], v11 offset:6144
v_cvt_pk_bf16_f32 v102, v76, v77
v_exp_f32 v79, v79
v_mfma_f32_32x32x16_bf16 a[176:191], a[252:255], v[108:111], a[176:191]
ds_read_b64_tr_b16 a[252:253], v12 offset:4096
ds_read_b64_tr_b16 a[254:255], v12 offset:6144
v_add_f32 v18, v18, v78
v_add_f32 v18, v18, v79
v_cvt_pk_bf16_f32 v103, v78, v79
v_mfma_f32_32x32x16_bf16 v[64:79], a[192:195], v[224:227], v[144:159]
ds_read_b128 a[192:195], v1 offset:8192
s_add_u32 m0, s28, 49152
v_exp_f32 v80, v80
v_mfma_f32_32x32x16_bf16 v[64:79], a[196:199], v[228:231], v[64:79]
ds_read_b128 a[196:199], v2 offset:8192
s_waitcnt vmcnt(5)
buffer_load_dwordx4 v17, s[12:15], s47 offen offset:3072 nt lds
s_add_u32 s55, s55, 8192
s_and_b32 s55, s55, 0x1ffff
v_mfma_f32_32x32x16_bf16 v[64:79], a[200:203], v[232:235], v[64:79]
ds_read_b128 a[200:203], v3 offset:8192
v_exp_f32 v81, v81
v_add_f32 v19, v19, v80
v_exp_f32 v82, v82
v_mfma_f32_32x32x16_bf16 v[64:79], a[204:207], v[236:239], v[64:79]
ds_read_b128 a[204:207], v4 offset:8192
v_add_f32 v19, v19, v81
v_cvt_pk_bf16_f32 v104, v80, v81
v_exp_f32 v83, v83
v_mfma_f32_32x32x16_bf16 v[64:79], a[208:211], v[240:243], v[64:79]
ds_read_b128 a[208:211], v5 offset:8192
v_add_f32 v19, v19, v82
v_exp_f32 v84, v84
v_mfma_f32_32x32x16_bf16 v[64:79], a[212:215], v[244:247], v[64:79]
ds_read_b128 a[212:215], v6 offset:8192
v_add_f32 v19, v19, v83
v_cvt_pk_bf16_f32 v105, v82, v83
v_exp_f32 v85, v85
v_mfma_f32_32x32x16_bf16 v[64:79], a[216:219], v[248:251], v[64:79]
ds_read_b128 a[216:219], v7 offset:8192
s_add_u32 m0, s28, 0
s_add_u32 s46, s29, s54
v_add_f32 v19, v19, v84
v_mfma_f32_32x32x16_bf16 v[64:79], a[220:223], v[252:255], v[64:79]
ds_read_b128 a[220:223], v8 offset:8192
s_waitcnt vmcnt(5)
buffer_load_dwordx4 v13, s[8:11], s46 offen offset:0 nt lds
v_exp_f32 v86, v86
s_waitcnt lgkmcnt(8)
v_mfma_f32_32x32x16_bf16 a[0:15], a[224:227], v[96:99], a[0:15]
v_add_f32 v19, v19, v85
v_cvt_pk_bf16_f32 v106, v84, v85
v_exp_f32 v87, v87
v_add_f32 v19, v19, v86
v_mfma_f32_32x32x16_bf16 a[16:31], a[228:231], v[96:99], a[16:31]
v_exp_f32 v88, v88
v_add_f32 v19, v19, v87
v_cvt_pk_bf16_f32 v107, v86, v87
v_mfma_f32_32x32x16_bf16 a[32:47], a[232:235], v[96:99], a[32:47]
v_exp_f32 v89, v89
v_add_f32 v19, v19, v88
v_exp_f32 v90, v90
v_mfma_f32_32x32x16_bf16 a[48:63], a[236:239], v[96:99], a[48:63]
v_add_f32 v19, v19, v89
v_cvt_pk_bf16_f32 v108, v88, v89
v_exp_f32 v91, v91
v_add_f32 v19, v19, v90
v_mfma_f32_32x32x16_bf16 a[0:15], a[240:243], v[100:103], a[0:15]
v_exp_f32 v92, v92
v_add_f32 v19, v19, v91
v_cvt_pk_bf16_f32 v109, v90, v91
v_mfma_f32_32x32x16_bf16 a[16:31], a[244:247], v[100:103], a[16:31]
s_add_u32 m0, s28, 0
v_exp_f32 v93, v93
v_add_f32 v19, v19, v92
v_exp_f32 v94, v94
v_mfma_f32_32x32x16_bf16 a[32:47], a[248:251], v[100:103], a[32:47]
s_waitcnt vmcnt(5)
buffer_load_dwordx4 v14, s[8:11], s46 offen offset:1024 nt lds
v_add_f32 v19, v19, v93
v_cvt_pk_bf16_f32 v110, v92, v93
v_mfma_f32_32x32x16_bf16 a[48:63], a[252:255], v[100:103], a[48:63]
v_exp_f32 v95, v95
v_add_f32 v19, v19, v94
v_add_f32 v19, v19, v95
v_cvt_pk_bf16_f32 v111, v94, v95
s_waitcnt lgkmcnt(0)
v_mfma_f32_32x32x16_bf16 v[80:95], a[192:195], v[160:163], v[112:127]
v_exp_f32 v64, v64
v_exp_f32 v65, v65
v_mfma_f32_32x32x16_bf16 v[80:95], a[196:199], v[164:167], v[80:95]
v_add_f32 v20, v20, v64
v_exp_f32 v66, v66
v_add_f32 v20, v20, v65
v_mfma_f32_32x32x16_bf16 v[80:95], a[200:203], v[168:171], v[80:95]
v_cvt_pk_bf16_f32 v96, v64, v65
v_exp_f32 v67, v67
v_add_f32 v20, v20, v66
v_mfma_f32_32x32x16_bf16 v[80:95], a[204:207], v[172:175], v[80:95]
s_add_u32 m0, s28, 0
v_exp_f32 v68, v68
v_add_f32 v20, v20, v67
v_mfma_f32_32x32x16_bf16 v[80:95], a[208:211], v[176:179], v[80:95]
s_waitcnt vmcnt(5)
buffer_load_dwordx4 v15, s[8:11], s46 offen offset:2048 nt lds
v_cvt_pk_bf16_f32 v97, v66, v67
v_exp_f32 v69, v69
v_mfma_f32_32x32x16_bf16 v[80:95], a[212:215], v[180:183], v[80:95]
v_add_f32 v20, v20, v68
v_exp_f32 v70, v70
v_mfma_f32_32x32x16_bf16 v[80:95], a[216:219], v[184:187], v[80:95]
v_add_f32 v20, v20, v69
v_cvt_pk_bf16_f32 v98, v68, v69
v_exp_f32 v71, v71
v_mfma_f32_32x32x16_bf16 v[80:95], a[220:223], v[188:191], v[80:95]
v_add_f32 v20, v20, v70
v_exp_f32 v72, v72
v_add_f32 v20, v20, v71
v_mfma_f32_32x32x16_bf16 a[64:79], a[224:227], v[104:107], a[64:79]
v_cvt_pk_bf16_f32 v99, v70, v71
v_exp_f32 v73, v73
v_add_f32 v20, v20, v72
v_mfma_f32_32x32x16_bf16 a[80:95], a[228:231], v[104:107], a[80:95]
v_exp_f32 v74, v74
v_add_f32 v20, v20, v73
v_cvt_pk_bf16_f32 v100, v72, v73
v_mfma_f32_32x32x16_bf16 a[96:111], a[232:235], v[104:107], a[96:111]
s_add_u32 m0, s28, 0
v_exp_f32 v75, v75
v_add_f32 v20, v20, v74
v_mfma_f32_32x32x16_bf16 a[112:127], a[236:239], v[104:107], a[112:127]
s_waitcnt vmcnt(5)
buffer_load_dwordx4 v16, s[8:11], s46 offen offset:3072 nt lds
s_add_u32 s54, s54, 8192
s_and_b32 s54, s54, 0x1ffff
v_mfma_f32_32x32x16_bf16 a[64:79], a[240:243], v[108:111], a[64:79]
v_exp_f32 v76, v76
v_add_f32 v20, v20, v75
v_cvt_pk_bf16_f32 v101, v74, v75
v_mfma_f32_32x32x16_bf16 a[80:95], a[244:247], v[108:111], a[80:95]
v_exp_f32 v77, v77
v_add_f32 v20, v20, v76
v_exp_f32 v78, v78
v_mfma_f32_32x32x16_bf16 a[96:111], a[248:251], v[108:111], a[96:111]
v_add_f32 v20, v20, v77
v_cvt_pk_bf16_f32 v102, v76, v77
v_exp_f32 v79, v79
v_mfma_f32_32x32x16_bf16 a[112:127], a[252:255], v[108:111], a[112:127]
v_add_f32 v20, v20, v78
v_add_f32 v20, v20, v79
v_cvt_pk_bf16_f32 v103, v78, v79
v_mfma_f32_32x32x16_bf16 v[64:79], a[192:195], v[192:195], v[128:143]
s_barrier
v_exp_f32 v80, v80
v_exp_f32 v81, v81
v_mfma_f32_32x32x16_bf16 v[64:79], a[196:199], v[196:199], v[64:79]
s_add_u32 m0, s28, 57344
s_add_u32 s47, s29, s55
v_add_f32 v18, v18, v80
v_exp_f32 v82, v82
v_mfma_f32_32x32x16_bf16 v[64:79], a[200:203], v[200:203], v[64:79]
s_waitcnt vmcnt(5)
buffer_load_dwordx4 v17, s[12:15], s47 offen offset:0 nt lds
v_add_f32 v18, v18, v81
v_cvt_pk_bf16_f32 v104, v80, v81
v_mfma_f32_32x32x16_bf16 v[64:79], a[204:207], v[204:207], v[64:79]
v_exp_f32 v83, v83
v_add_f32 v18, v18, v82
v_exp_f32 v84, v84
v_add_f32 v18, v18, v83
v_mfma_f32_32x32x16_bf16 v[64:79], a[208:211], v[208:211], v[64:79]
v_cvt_pk_bf16_f32 v105, v82, v83
v_exp_f32 v85, v85
v_add_f32 v18, v18, v84
v_exp_f32 v86, v86
v_mfma_f32_32x32x16_bf16 v[64:79], a[212:215], v[212:215], v[64:79]
v_add_f32 v18, v18, v85
v_cvt_pk_bf16_f32 v106, v84, v85
v_exp_f32 v87, v87
v_add_f32 v18, v18, v86
v_mfma_f32_32x32x16_bf16 v[64:79], a[216:219], v[216:219], v[64:79]
v_exp_f32 v88, v88
v_add_f32 v18, v18, v87
v_cvt_pk_bf16_f32 v107, v86, v87
v_mfma_f32_32x32x16_bf16 v[64:79], a[220:223], v[220:223], v[64:79]
s_add_u32 m0, s28, 57344
v_exp_f32 v89, v89
v_add_f32 v18, v18, v88
v_exp_f32 v90, v90
v_mfma_f32_32x32x16_bf16 a[128:143], a[224:227], v[96:99], a[128:143]
ds_read_b64_tr_b16 a[224:225], v9 offset:8192
ds_read_b64_tr_b16 a[226:227], v9 offset:10240
s_waitcnt vmcnt(5)
buffer_load_dwordx4 v17, s[12:15], s47 offen offset:1024 nt lds
v_add_f32 v18, v18, v89
v_mfma_f32_32x32x16_bf16 a[144:159], a[228:231], v[96:99], a[144:159]
ds_read_b64_tr_b16 a[228:229], v10 offset:8192
ds_read_b64_tr_b16 a[230:231], v10 offset:10240
v_cvt_pk_bf16_f32 v108, v88, v89
v_exp_f32 v91, v91
v_add_f32 v18, v18, v90
v_mfma_f32_32x32x16_bf16 a[160:175], a[232:235], v[96:99], a[160:175]
ds_read_b64_tr_b16 a[232:233], v11 offset:8192
ds_read_b64_tr_b16 a[234:235], v11 offset:10240
v_exp_f32 v92, v92
v_add_f32 v18, v18, v91
v_mfma_f32_32x32x16_bf16 a[176:191], a[236:239], v[96:99], a[176:191]
ds_read_b64_tr_b16 a[236:237], v12 offset:8192
ds_read_b64_tr_b16 a[238:239], v12 offset:10240
v_cvt_pk_bf16_f32 v109, v90, v91
v_exp_f32 v93, v93
v_mfma_f32_32x32x16_bf16 a[128:143], a[240:243], v[100:103], a[128:143]
ds_read_b64_tr_b16 a[240:241], v9 offset:12288
ds_read_b64_tr_b16 a[242:243], v9 offset:14336
v_add_f32 v18, v18, v92
v_exp_f32 v94, v94
v_mfma_f32_32x32x16_bf16 a[144:159], a[244:247], v[100:103], a[144:159]
ds_read_b64_tr_b16 a[244:245], v10 offset:12288
ds_read_b64_tr_b16 a[246:247], v10 offset:14336
v_add_f32 v18, v18, v93
v_cvt_pk_bf16_f32 v110, v92, v93
v_exp_f32 v95, v95
v_mfma_f32_32x32x16_bf16 a[160:175], a[248:251], v[100:103], a[160:175]
ds_read_b64_tr_b16 a[248:249], v11 offset:12288
ds_read_b64_tr_b16 a[250:251], v11 offset:14336
s_add_u32 m0, s28, 57344
v_add_f32 v18, v18, v94
v_add_f32 v18, v18, v95
v_mfma_f32_32x32x16_bf16 a[176:191], a[252:255], v[100:103], a[176:191]
ds_read_b64_tr_b16 a[252:253], v12 offset:12288
ds_read_b64_tr_b16 a[254:255], v12 offset:14336
s_waitcnt vmcnt(5)
buffer_load_dwordx4 v17, s[12:15], s47 offen offset:2048 nt lds
v_cvt_pk_bf16_f32 v111, v94, v95
v_mfma_f32_32x32x16_bf16 v[80:95], a[192:195], v[224:227], v[144:159]
ds_read_b128 a[192:195], v1 offset:16384
v_exp_f32 v64, v64
v_exp_f32 v65, v65
v_mfma_f32_32x32x16_bf16 v[80:95], a[196:199], v[228:231], v[80:95]
ds_read_b128 a[196:199], v2 offset:16384
v_add_f32 v19, v19, v64
v_exp_f32 v66, v66
v_mfma_f32_32x32x16_bf16 v[80:95], a[200:203], v[232:235], v[80:95]
ds_read_b128 a[200:203], v3 offset:16384
v_add_f32 v19, v19, v65
v_cvt_pk_bf16_f32 v96, v64, v65
v_exp_f32 v67, v67
v_mfma_f32_32x32x16_bf16 v[80:95], a[204:207], v[236:239], v[80:95]
ds_read_b128 a[204:207], v4 offset:16384
v_add_f32 v19, v19, v66
v_exp_f32 v68, v68
v_mfma_f32_32x32x16_bf16 v[80:95], a[208:211], v[240:243], v[80:95]
ds_read_b128 a[208:211], v5 offset:16384
v_add_f32 v19, v19, v67
v_cvt_pk_bf16_f32 v97, v66, v67
v_exp_f32 v69, v69
v_mfma_f32_32x32x16_bf16 v[80:95], a[212:215], v[244:247], v[80:95]
ds_read_b128 a[212:215], v6 offset:16384
s_add_u32 m0, s28, 57344
v_add_f32 v19, v19, v68
v_exp_f32 v70, v70
v_mfma_f32_32x32x16_bf16 v[80:95], a[216:219], v[248:251], v[80:95]
ds_read_b128 a[216:219], v7 offset:16384
s_waitcnt vmcnt(5)
buffer_load_dwordx4 v17, s[12:15], s47 offen offset:3072 nt lds
s_add_u32 s55, s55, 8192
s_and_b32 s55, s55, 0x1ffff
v_mfma_f32_32x32x16_bf16 v[80:95], a[220:223], v[252:255], v[80:95]
ds_read_b128 a[220:223], v8 offset:16384
v_add_f32 v19, v19, v69
v_cvt_pk_bf16_f32 v98, v68, v69
s_waitcnt lgkmcnt(8)
v_mfma_f32_32x32x16_bf16 a[0:15], a[224:227], v[104:107], a[0:15]
v_exp_f32 v71, v71
v_add_f32 v19, v19, v70
v_exp_f32 v72, v72
v_mfma_f32_32x32x16_bf16 a[16:31], a[228:231], v[104:107], a[16:31]
v_add_f32 v19, v19, v71
v_cvt_pk_bf16_f32 v99, v70, v71
v_exp_f32 v73, v73
v_add_f32 v19, v19, v72
v_mfma_f32_32x32x16_bf16 a[32:47], a[232:235], v[104:107], a[32:47]
v_exp_f32 v74, v74
v_add_f32 v19, v19, v73
v_cvt_pk_bf16_f32 v100, v72, v73
v_mfma_f32_32x32x16_bf16 a[48:63], a[236:239], v[104:107], a[48:63]
s_add_u32 m0, s28, 8192
s_add_u32 s46, s29, s54
v_exp_f32 v75, v75
v_add_f32 v19, v19, v74
v_mfma_f32_32x32x16_bf16 a[0:15], a[240:243], v[108:111], a[0:15]
s_waitcnt vmcnt(5)
buffer_load_dwordx4 v13, s[8:11], s46 offen offset:0 nt lds
v_exp_f32 v76, v76
v_mfma_f32_32x32x16_bf16 a[16:31], a[244:247], v[108:111], a[16:31]
v_add_f32 v19, v19, v75
v_cvt_pk_bf16_f32 v101, v74, v75
v_exp_f32 v77, v77
v_add_f32 v19, v19, v76
v_mfma_f32_32x32x16_bf16 a[32:47], a[248:251], v[108:111], a[32:47]
v_exp_f32 v78, v78
v_add_f32 v19, v19, v77
v_cvt_pk_bf16_f32 v102, v76, v77
v_mfma_f32_32x32x16_bf16 a[48:63], a[252:255], v[108:111], a[48:63]
v_exp_f32 v79, v79
v_add_f32 v19, v19, v78
v_add_f32 v19, v19, v79
v_cvt_pk_bf16_f32 v103, v78, v79
s_waitcnt lgkmcnt(0)
v_mfma_f32_32x32x16_bf16 v[64:79], a[192:195], v[160:163], v[112:127]
v_exp_f32 v80, v80
v_exp_f32 v81, v81
v_mfma_f32_32x32x16_bf16 v[64:79], a[196:199], v[164:167], v[64:79]
v_add_f32 v20, v20, v80
v_exp_f32 v82, v82
v_add_f32 v20, v20, v81
v_mfma_f32_32x32x16_bf16 v[64:79], a[200:203], v[168:171], v[64:79]
s_add_u32 m0, s28, 8192
v_cvt_pk_bf16_f32 v104, v80, v81
v_exp_f32 v83, v83
v_mfma_f32_32x32x16_bf16 v[64:79], a[204:207], v[172:175], v[64:79]
s_waitcnt vmcnt(5)
buffer_load_dwordx4 v14, s[8:11], s46 offen offset:1024 nt lds
v_add_f32 v20, v20, v82
v_mfma_f32_32x32x16_bf16 v[64:79], a[208:211], v[176:179], v[64:79]
v_exp_f32 v84, v84
v_add_f32 v20, v20, v83
v_cvt_pk_bf16_f32 v105, v82, v83
v_mfma_f32_32x32x16_bf16 v[64:79], a[212:215], v[180:183], v[64:79]
v_exp_f32 v85, v85
v_add_f32 v20, v20, v84
v_exp_f32 v86, v86
v_mfma_f32_32x32x16_bf16 v[64:79], a[216:219], v[184:187], v[64:79]
v_add_f32 v20, v20, v85
v_cvt_pk_bf16_f32 v106, v84, v85
v_exp_f32 v87, v87
v_mfma_f32_32x32x16_bf16 v[64:79], a[220:223], v[188:191], v[64:79]
v_add_f32 v20, v20, v86
v_exp_f32 v88, v88
v_mfma_f32_32x32x16_bf16 a[64:79], a[224:227], v[96:99], a[64:79]
v_add_f32 v20, v20, v87
v_cvt_pk_bf16_f32 v107, v86, v87
v_exp_f32 v89, v89
v_mfma_f32_32x32x16_bf16 a[80:95], a[228:231], v[96:99], a[80:95]
s_add_u32 m0, s28, 8192
v_add_f32 v20, v20, v88
v_exp_f32 v90, v90
v_mfma_f32_32x32x16_bf16 a[96:111], a[232:235], v[96:99], a[96:111]
s_waitcnt vmcnt(5)
buffer_load_dwordx4 v15, s[8:11], s46 offen offset:2048 nt lds
v_add_f32 v20, v20, v89
v_cvt_pk_bf16_f32 v108, v88, v89
v_mfma_f32_32x32x16_bf16 a[112:127], a[236:239], v[96:99], a[112:127]
v_exp_f32 v91, v91
v_add_f32 v20, v20, v90
v_mfma_f32_32x32x16_bf16 a[64:79], a[240:243], v[100:103], a[64:79]
v_exp_f32 v92, v92
v_add_f32 v20, v20, v91
v_cvt_pk_bf16_f32 v109, v90, v91
v_mfma_f32_32x32x16_bf16 a[80:95], a[244:247], v[100:103], a[80:95]
v_exp_f32 v93, v93
v_add_f32 v20, v20, v92
v_exp_f32 v94, v94
v_mfma_f32_32x32x16_bf16 a[96:111], a[248:251], v[100:103], a[96:111]
v_add_f32 v20, v20, v93
v_cvt_pk_bf16_f32 v110, v92, v93
v_exp_f32 v95, v95
v_mfma_f32_32x32x16_bf16 a[112:127], a[252:255], v[100:103], a[112:127]
v_add_f32 v20, v20, v94
v_add_f32 v20, v20, v95
v_cvt_pk_bf16_f32 v111, v94, v95
v_mfma_f32_32x32x16_bf16 v[80:95], a[192:195], v[192:195], v[128:143]
s_barrier
s_add_u32 m0, s28, 8192
v_exp_f32 v64, v64
v_mfma_f32_32x32x16_bf16 v[80:95], a[196:199], v[196:199], v[80:95]
s_waitcnt vmcnt(5)
buffer_load_dwordx4 v16, s[8:11], s46 offen offset:3072 nt lds
s_add_u32 s54, s54, 8192
s_and_b32 s54, s54, 0x1ffff
v_exp_f32 v65, v65
v_mfma_f32_32x32x16_bf16 v[80:95], a[200:203], v[200:203], v[80:95]
v_add_f32 v18, v18, v64
v_exp_f32 v66, v66
v_add_f32 v18, v18, v65
v_cvt_pk_bf16_f32 v96, v64, v65
v_mfma_f32_32x32x16_bf16 v[80:95], a[204:207], v[204:207], v[80:95]
v_exp_f32 v67, v67
v_add_f32 v18, v18, v66
v_exp_f32 v68, v68
v_add_f32 v18, v18, v67
v_mfma_f32_32x32x16_bf16 v[80:95], a[208:211], v[208:211], v[80:95]
v_cvt_pk_bf16_f32 v97, v66, v67
v_exp_f32 v69, v69
v_add_f32 v18, v18, v68
v_mfma_f32_32x32x16_bf16 v[80:95], a[212:215], v[212:215], v[80:95]
v_exp_f32 v70, v70
v_add_f32 v18, v18, v69
v_cvt_pk_bf16_f32 v98, v68, v69
v_exp_f32 v71, v71
v_mfma_f32_32x32x16_bf16 v[80:95], a[216:219], v[216:219], v[80:95]
s_add_u32 m0, s28, 32768
s_add_u32 s47, s29, s55
v_add_f32 v18, v18, v70
v_exp_f32 v72, v72
v_add_f32 v18, v18, v71
v_mfma_f32_32x32x16_bf16 v[80:95], a[220:223], v[220:223], v[80:95]
s_waitcnt vmcnt(5)
buffer_load_dwordx4 v17, s[12:15], s47 offen offset:0 nt lds
v_cvt_pk_bf16_f32 v99, v70, v71
v_exp_f32 v73, v73
v_mfma_f32_32x32x16_bf16 a[128:143], a[224:227], v[104:107], a[128:143]
ds_read_b64_tr_b16 a[224:225], v9 offset:16384
ds_read_b64_tr_b16 a[226:227], v9 offset:18432
v_add_f32 v18, v18, v72
v_exp_f32 v74, v74
v_mfma_f32_32x32x16_bf16 a[144:159], a[228:231], v[104:107], a[144:159]
ds_read_b64_tr_b16 a[228:229], v10 offset:16384
ds_read_b64_tr_b16 a[230:231], v10 offset:18432
v_add_f32 v18, v18, v73
v_cvt_pk_bf16_f32 v100, v72, v73
v_exp_f32 v75, v75
v_mfma_f32_32x32x16_bf16 a[160:175], a[232:235], v[104:107], a[160:175]
ds_read_b64_tr_b16 a[232:233], v11 offset:16384
ds_read_b64_tr_b16 a[234:235], v11 offset:18432
v_add_f32 v18, v18, v74
v_exp_f32 v76, v76
v_mfma_f32_32x32x16_bf16 a[176:191], a[236:239], v[104:107], a[176:191]
ds_read_b64_tr_b16 a[236:237], v12 offset:16384
ds_read_b64_tr_b16 a[238:239], v12 offset:18432
v_add_f32 v18, v18, v75
v_cvt_pk_bf16_f32 v101, v74, v75
v_exp_f32 v77, v77
v_mfma_f32_32x32x16_bf16 a[128:143], a[240:243], v[108:111], a[128:143]
ds_read_b64_tr_b16 a[240:241], v9 offset:20480
ds_read_b64_tr_b16 a[242:243], v9 offset:22528
v_add_f32 v18, v18, v76
v_exp_f32 v78, v78
v_mfma_f32_32x32x16_bf16 a[144:159], a[244:247], v[108:111], a[144:159]
ds_read_b64_tr_b16 a[244:245], v10 offset:20480
ds_read_b64_tr_b16 a[246:247], v10 offset:22528
s_add_u32 m0, s28, 32768
v_add_f32 v18, v18, v77
v_cvt_pk_bf16_f32 v102, v76, v77
v_mfma_f32_32x32x16_bf16 a[160:175], a[248:251], v[108:111], a[160:175]
ds_read_b64_tr_b16 a[248:249], v11 offset:20480
ds_read_b64_tr_b16 a[250:251], v11 offset:22528
s_waitcnt vmcnt(5)
buffer_load_dwordx4 v17, s[12:15], s47 offen offset:1024 nt lds
v_exp_f32 v79, v79
v_mfma_f32_32x32x16_bf16 a[176:191], a[252:255], v[108:111], a[176:191]
ds_read_b64_tr_b16 a[252:253], v12 offset:20480
ds_read_b64_tr_b16 a[254:255], v12 offset:22528
v_add_f32 v18, v18, v78
v_add_f32 v18, v18, v79
v_cvt_pk_bf16_f32 v103, v78, v79
v_mfma_f32_32x32x16_bf16 v[64:79], a[192:195], v[224:227], v[144:159]
ds_read_b128 a[192:195], v1 offset:24576
v_exp_f32 v80, v80
v_exp_f32 v81, v81
v_mfma_f32_32x32x16_bf16 v[64:79], a[196:199], v[228:231], v[64:79]
ds_read_b128 a[196:199], v2 offset:24576
v_add_f32 v19, v19, v80
v_exp_f32 v82, v82
v_mfma_f32_32x32x16_bf16 v[64:79], a[200:203], v[232:235], v[64:79]
ds_read_b128 a[200:203], v3 offset:24576
v_add_f32 v19, v19, v81
v_cvt_pk_bf16_f32 v104, v80, v81
v_exp_f32 v83, v83
v_mfma_f32_32x32x16_bf16 v[64:79], a[204:207], v[236:239], v[64:79]
ds_read_b128 a[204:207], v4 offset:24576
s_add_u32 m0, s28, 32768
v_add_f32 v19, v19, v82
v_exp_f32 v84, v84
v_mfma_f32_32x32x16_bf16 v[64:79], a[208:211], v[240:243], v[64:79]
ds_read_b128 a[208:211], v5 offset:24576
s_waitcnt vmcnt(5)
buffer_load_dwordx4 v17, s[12:15], s47 offen offset:2048 nt lds
v_add_f32 v19, v19, v83
v_mfma_f32_32x32x16_bf16 v[64:79], a[212:215], v[244:247], v[64:79]
ds_read_b128 a[212:215], v6 offset:24576
v_cvt_pk_bf16_f32 v105, v82, v83
v_exp_f32 v85, v85
v_mfma_f32_32x32x16_bf16 v[64:79], a[216:219], v[248:251], v[64:79]
ds_read_b128 a[216:219], v7 offset:24576
v_add_f32 v19, v19, v84
v_exp_f32 v86, v86
v_add_f32 v19, v19, v85
v_mfma_f32_32x32x16_bf16 v[64:79], a[220:223], v[252:255], v[64:79]
ds_read_b128 a[220:223], v8 offset:24576
v_cvt_pk_bf16_f32 v106, v84, v85
v_exp_f32 v87, v87
s_waitcnt lgkmcnt(8)
v_mfma_f32_32x32x16_bf16 a[0:15], a[224:227], v[96:99], a[0:15]
v_add_f32 v19, v19, v86
v_exp_f32 v88, v88
v_add_f32 v19, v19, v87
v_cvt_pk_bf16_f32 v107, v86, v87
v_mfma_f32_32x32x16_bf16 a[16:31], a[228:231], v[96:99], a[16:31]
v_exp_f32 v89, v89
v_add_f32 v19, v19, v88
v_exp_f32 v90, v90
v_mfma_f32_32x32x16_bf16 a[32:47], a[232:235], v[96:99], a[32:47]
s_add_u32 m0, s28, 32768
v_add_f32 v19, v19, v89
v_cvt_pk_bf16_f32 v108, v88, v89
v_mfma_f32_32x32x16_bf16 a[48:63], a[236:239], v[96:99], a[48:63]
s_waitcnt vmcnt(5)
buffer_load_dwordx4 v17, s[12:15], s47 offen offset:3072 nt lds
s_add_u32 s55, s55, 8192
s_and_b32 s55, s55, 0x1ffff
v_exp_f32 v91, v91
v_mfma_f32_32x32x16_bf16 a[0:15], a[240:243], v[100:103], a[0:15]
v_add_f32 v19, v19, v90
v_exp_f32 v92, v92
v_add_f32 v19, v19, v91
v_mfma_f32_32x32x16_bf16 a[16:31], a[244:247], v[100:103], a[16:31]
v_cvt_pk_bf16_f32 v109, v90, v91
v_exp_f32 v93, v93
v_add_f32 v19, v19, v92
v_mfma_f32_32x32x16_bf16 a[32:47], a[248:251], v[100:103], a[32:47]
v_exp_f32 v94, v94
v_add_f32 v19, v19, v93
v_cvt_pk_bf16_f32 v110, v92, v93
v_mfma_f32_32x32x16_bf16 a[48:63], a[252:255], v[100:103], a[48:63]
v_exp_f32 v95, v95
v_add_f32 v19, v19, v94
v_add_f32 v19, v19, v95
v_cvt_pk_bf16_f32 v111, v94, v95
s_waitcnt lgkmcnt(0)
v_mfma_f32_32x32x16_bf16 v[80:95], a[192:195], v[160:163], v[112:127]
v_exp_f32 v64, v64
v_exp_f32 v65, v65
v_mfma_f32_32x32x16_bf16 v[80:95], a[196:199], v[164:167], v[80:95]
s_add_u32 m0, s28, 16384
s_add_u32 s46, s29, s54
v_add_f32 v20, v20, v64
v_exp_f32 v66, v66
v_mfma_f32_32x32x16_bf16 v[80:95], a[200:203], v[168:171], v[80:95]
s_waitcnt vmcnt(5)
buffer_load_dwordx4 v13, s[8:11], s46 offen offset:0 nt lds
v_add_f32 v20, v20, v65
v_mfma_f32_32x32x16_bf16 v[80:95], a[204:207], v[172:175], v[80:95]
v_cvt_pk_bf16_f32 v96, v64, v65
v_exp_f32 v67, v67
v_add_f32 v20, v20, v66
v_mfma_f32_32x32x16_bf16 v[80:95], a[208:211], v[176:179], v[80:95]
v_exp_f32 v68, v68
v_add_f32 v20, v20, v67
v_cvt_pk_bf16_f32 v97, v66, v67
v_mfma_f32_32x32x16_bf16 v[80:95], a[212:215], v[180:183], v[80:95]
v_exp_f32 v69, v69
v_add_f32 v20, v20, v68
v_exp_f32 v70, v70
v_mfma_f32_32x32x16_bf16 v[80:95], a[216:219], v[184:187], v[80:95]
v_add_f32 v20, v20, v69
v_cvt_pk_bf16_f32 v98, v68, v69
v_exp_f32 v71, v71
v_mfma_f32_32x32x16_bf16 v[80:95], a[220:223], v[188:191], v[80:95]
s_add_u32 m0, s28, 16384
v_add_f32 v20, v20, v70
v_exp_f32 v72, v72
v_mfma_f32_32x32x16_bf16 a[64:79], a[224:227], v[104:107], a[64:79]
s_waitcnt vmcnt(5)
buffer_load_dwordx4 v14, s[8:11], s46 offen offset:1024 nt lds
v_add_f32 v20, v20, v71
v_cvt_pk_bf16_f32 v99, v70, v71
v_mfma_f32_32x32x16_bf16 a[80:95], a[228:231], v[104:107], a[80:95]
v_exp_f32 v73, v73
v_add_f32 v20, v20, v72
v_exp_f32 v74, v74
v_mfma_f32_32x32x16_bf16 a[96:111], a[232:235], v[104:107], a[96:111]
v_add_f32 v20, v20, v73
v_cvt_pk_bf16_f32 v100, v72, v73
v_exp_f32 v75, v75
v_mfma_f32_32x32x16_bf16 a[112:127], a[236:239], v[104:107], a[112:127]
v_add_f32 v20, v20, v74
v_exp_f32 v76, v76
v_add_f32 v20, v20, v75
v_mfma_f32_32x32x16_bf16 a[64:79], a[240:243], v[108:111], a[64:79]
v_cvt_pk_bf16_f32 v101, v74, v75
v_exp_f32 v77, v77
v_add_f32 v20, v20, v76
v_mfma_f32_32x32x16_bf16 a[80:95], a[244:247], v[108:111], a[80:95]
v_exp_f32 v78, v78
v_add_f32 v20, v20, v77
v_cvt_pk_bf16_f32 v102, v76, v77
v_mfma_f32_32x32x16_bf16 a[96:111], a[248:251], v[108:111], a[96:111]
s_add_u32 m0, s28, 16384
v_exp_f32 v79, v79
v_add_f32 v20, v20, v78
v_mfma_f32_32x32x16_bf16 a[112:127], a[252:255], v[108:111], a[112:127]
s_waitcnt vmcnt(5)
buffer_load_dwordx4 v15, s[8:11], s46 offen offset:2048 nt lds
v_add_f32 v20, v20, v79
v_cvt_pk_bf16_f32 v103, v78, v79
v_mfma_f32_32x32x16_bf16 v[64:79], a[192:195], v[192:195], v[128:143]
s_barrier
v_exp_f32 v80, v80
v_exp_f32 v81, v81
v_mfma_f32_32x32x16_bf16 v[64:79], a[196:199], v[196:199], v[64:79]
v_add_f32 v18, v18, v80
v_exp_f32 v82, v82
v_add_f32 v18, v18, v81
v_mfma_f32_32x32x16_bf16 v[64:79], a[200:203], v[200:203], v[64:79]
v_cvt_pk_bf16_f32 v104, v80, v81
v_exp_f32 v83, v83
v_add_f32 v18, v18, v82
v_exp_f32 v84, v84
v_mfma_f32_32x32x16_bf16 v[64:79], a[204:207], v[204:207], v[64:79]
v_add_f32 v18, v18, v83
v_cvt_pk_bf16_f32 v105, v82, v83
v_exp_f32 v85, v85
v_add_f32 v18, v18, v84
v_mfma_f32_32x32x16_bf16 v[64:79], a[208:211], v[208:211], v[64:79]
v_exp_f32 v86, v86
v_add_f32 v18, v18, v85
v_cvt_pk_bf16_f32 v106, v84, v85
v_mfma_f32_32x32x16_bf16 v[64:79], a[212:215], v[212:215], v[64:79]
s_add_u32 m0, s28, 16384
v_exp_f32 v87, v87
v_add_f32 v18, v18, v86
v_exp_f32 v88, v88
v_mfma_f32_32x32x16_bf16 v[64:79], a[216:219], v[216:219], v[64:79]
s_waitcnt vmcnt(5)
buffer_load_dwordx4 v16, s[8:11], s46 offen offset:3072 nt lds
s_add_u32 s54, s54, 8192
s_and_b32 s54, s54, 0x1ffff
v_add_f32 v18, v18, v87
v_mfma_f32_32x32x16_bf16 v[64:79], a[220:223], v[220:223], v[64:79]
v_cvt_pk_bf16_f32 v107, v86, v87
v_exp_f32 v89, v89
v_add_f32 v18, v18, v88
v_exp_f32 v90, v90
v_mfma_f32_32x32x16_bf16 a[128:143], a[224:227], v[96:99], a[128:143]
ds_read_b64_tr_b16 a[224:225], v9 offset:24576
ds_read_b64_tr_b16 a[226:227], v9 offset:26624
v_add_f32 v18, v18, v89
v_cvt_pk_bf16_f32 v108, v88, v89
v_mfma_f32_32x32x16_bf16 a[144:159], a[228:231], v[96:99], a[144:159]
ds_read_b64_tr_b16 a[228:229], v10 offset:24576
ds_read_b64_tr_b16 a[230:231], v10 offset:26624
v_exp_f32 v91, v91
v_add_f32 v18, v18, v90
v_mfma_f32_32x32x16_bf16 a[160:175], a[232:235], v[96:99], a[160:175]
ds_read_b64_tr_b16 a[232:233], v11 offset:24576
ds_read_b64_tr_b16 a[234:235], v11 offset:26624
v_exp_f32 v92, v92
v_add_f32 v18, v18, v91
v_cvt_pk_bf16_f32 v109, v90, v91
v_mfma_f32_32x32x16_bf16 a[176:191], a[236:239], v[96:99], a[176:191]
ds_read_b64_tr_b16 a[236:237], v12 offset:24576
ds_read_b64_tr_b16 a[238:239], v12 offset:26624
s_add_u32 m0, s28, 40960
s_add_u32 s47, s29, s55
v_exp_f32 v93, v93
v_mfma_f32_32x32x16_bf16 a[128:143], a[240:243], v[100:103], a[128:143]
ds_read_b64_tr_b16 a[240:241], v9 offset:28672
ds_read_b64_tr_b16 a[242:243], v9 offset:30720
s_waitcnt vmcnt(5)
buffer_load_dwordx4 v17, s[12:15], s47 offen offset:0 nt lds
v_mfma_f32_32x32x16_bf16 a[144:159], a[244:247], v[100:103], a[144:159]
ds_read_b64_tr_b16 a[244:245], v10 offset:28672
ds_read_b64_tr_b16 a[246:247], v10 offset:30720
v_add_f32 v18, v18, v92
v_exp_f32 v94, v94
v_add_f32 v18, v18, v93
v_mfma_f32_32x32x16_bf16 a[160:175], a[248:251], v[100:103], a[160:175]
ds_read_b64_tr_b16 a[248:249], v11 offset:28672
ds_read_b64_tr_b16 a[250:251], v11 offset:30720
v_cvt_pk_bf16_f32 v110, v92, v93
v_exp_f32 v95, v95
v_mfma_f32_32x32x16_bf16 a[176:191], a[252:255], v[100:103], a[176:191]
ds_read_b64_tr_b16 a[252:253], v12 offset:28672
ds_read_b64_tr_b16 a[254:255], v12 offset:30720
v_add_f32 v18, v18, v94
v_add_f32 v18, v18, v95
v_cvt_pk_bf16_f32 v111, v94, v95
v_mfma_f32_32x32x16_bf16 v[80:95], a[192:195], v[224:227], v[144:159]
ds_read_b128 a[192:195], v1 offset:0
v_exp_f32 v64, v64
v_exp_f32 v65, v65
v_mfma_f32_32x32x16_bf16 v[80:95], a[196:199], v[228:231], v[80:95]
ds_read_b128 a[196:199], v2 offset:0
v_add_f32 v19, v19, v64
v_exp_f32 v66, v66
v_mfma_f32_32x32x16_bf16 v[80:95], a[200:203], v[232:235], v[80:95]
ds_read_b128 a[200:203], v3 offset:0
s_add_u32 m0, s28, 40960
v_add_f32 v19, v19, v65
v_cvt_pk_bf16_f32 v96, v64, v65
v_mfma_f32_32x32x16_bf16 v[80:95], a[204:207], v[236:239], v[80:95]
ds_read_b128 a[204:207], v4 offset:0
s_waitcnt vmcnt(5)
buffer_load_dwordx4 v17, s[12:15], s47 offen offset:1024 nt lds
v_exp_f32 v67, v67
v_mfma_f32_32x32x16_bf16 v[80:95], a[208:211], v[240:243], v[80:95]
ds_read_b128 a[208:211], v5 offset:0
v_add_f32 v19, v19, v66
v_exp_f32 v68, v68
v_mfma_f32_32x32x16_bf16 v[80:95], a[212:215], v[244:247], v[80:95]
ds_read_b128 a[212:215], v6 offset:0
v_add_f32 v19, v19, v67
v_cvt_pk_bf16_f32 v97, v66, v67
v_exp_f32 v69, v69
v_mfma_f32_32x32x16_bf16 v[80:95], a[216:219], v[248:251], v[80:95]
ds_read_b128 a[216:219], v7 offset:0
v_add_f32 v19, v19, v68
v_exp_f32 v70, v70
v_mfma_f32_32x32x16_bf16 v[80:95], a[220:223], v[252:255], v[80:95]
ds_read_b128 a[220:223], v8 offset:0
v_add_f32 v19, v19, v69
v_cvt_pk_bf16_f32 v98, v68, v69
v_exp_f32 v71, v71
s_waitcnt lgkmcnt(8)
v_mfma_f32_32x32x16_bf16 a[0:15], a[224:227], v[104:107], a[0:15]
v_add_f32 v19, v19, v70
v_exp_f32 v72, v72
v_mfma_f32_32x32x16_bf16 a[16:31], a[228:231], v[104:107], a[16:31]
s_add_u32 m0, s28, 40960
v_add_f32 v19, v19, v71
v_cvt_pk_bf16_f32 v99, v70, v71
v_exp_f32 v73, v73
v_mfma_f32_32x32x16_bf16 a[32:47], a[232:235], v[104:107], a[32:47]
s_waitcnt vmcnt(5)
buffer_load_dwordx4 v17, s[12:15], s47 offen offset:2048 nt lds
v_add_f32 v19, v19, v72
v_exp_f32 v74, v74
v_mfma_f32_32x32x16_bf16 a[48:63], a[236:239], v[104:107], a[48:63]
v_add_f32 v19, v19, v73
v_cvt_pk_bf16_f32 v100, v72, v73
v_exp_f32 v75, v75
v_mfma_f32_32x32x16_bf16 a[0:15], a[240:243], v[108:111], a[0:15]
v_add_f32 v19, v19, v74
v_exp_f32 v76, v76
v_add_f32 v19, v19, v75
v_mfma_f32_32x32x16_bf16 a[16:31], a[244:247], v[108:111], a[16:31]
v_cvt_pk_bf16_f32 v101, v74, v75
v_exp_f32 v77, v77
v_add_f32 v19, v19, v76
v_mfma_f32_32x32x16_bf16 a[32:47], a[248:251], v[108:111], a[32:47]
v_exp_f32 v78, v78
v_add_f32 v19, v19, v77
v_cvt_pk_bf16_f32 v102, v76, v77
v_mfma_f32_32x32x16_bf16 a[48:63], a[252:255], v[108:111], a[48:63]
v_exp_f32 v79, v79
v_add_f32 v19, v19, v78
v_add_f32 v19, v19, v79
v_cvt_pk_bf16_f32 v103, v78, v79
s_waitcnt lgkmcnt(0)
v_mfma_f32_32x32x16_bf16 v[64:79], a[192:195], v[160:163], v[112:127]
s_add_u32 m0, s28, 40960
v_exp_f32 v80, v80
v_exp_f32 v81, v81
v_mfma_f32_32x32x16_bf16 v[64:79], a[196:199], v[164:167], v[64:79]
s_waitcnt vmcnt(5)
buffer_load_dwordx4 v17, s[12:15], s47 offen offset:3072 nt lds
s_add_u32 s55, s55, 8192
s_and_b32 s55, s55, 0x1ffff
v_mfma_f32_32x32x16_bf16 v[64:79], a[200:203], v[168:171], v[64:79]
v_add_f32 v20, v20, v80
v_exp_f32 v82, v82
v_add_f32 v20, v20, v81
v_mfma_f32_32x32x16_bf16 v[64:79], a[204:207], v[172:175], v[64:79]
v_cvt_pk_bf16_f32 v104, v80, v81
v_exp_f32 v83, v83
v_add_f32 v20, v20, v82
v_mfma_f32_32x32x16_bf16 v[64:79], a[208:211], v[176:179], v[64:79]
v_exp_f32 v84, v84
v_add_f32 v20, v20, v83
v_cvt_pk_bf16_f32 v105, v82, v83
v_mfma_f32_32x32x16_bf16 v[64:79], a[212:215], v[180:183], v[64:79]
v_exp_f32 v85, v85
v_add_f32 v20, v20, v84
v_exp_f32 v86, v86
v_mfma_f32_32x32x16_bf16 v[64:79], a[216:219], v[184:187], v[64:79]
s_add_u32 m0, s28, 24576
s_add_u32 s46, s29, s54
v_add_f32 v20, v20, v85
v_cvt_pk_bf16_f32 v106, v84, v85
v_mfma_f32_32x32x16_bf16 v[64:79], a[220:223], v[188:191], v[64:79]
s_waitcnt vmcnt(5)
buffer_load_dwordx4 v13, s[8:11], s46 offen offset:0 nt lds
v_exp_f32 v87, v87
v_mfma_f32_32x32x16_bf16 a[64:79], a[224:227], v[96:99], a[64:79]
v_add_f32 v20, v20, v86
v_exp_f32 v88, v88
v_add_f32 v20, v20, v87
v_mfma_f32_32x32x16_bf16 a[80:95], a[228:231], v[96:99], a[80:95]
v_cvt_pk_bf16_f32 v107, v86, v87
v_exp_f32 v89, v89
v_add_f32 v20, v20, v88
v_mfma_f32_32x32x16_bf16 a[96:111], a[232:235], v[96:99], a[96:111]
v_exp_f32 v90, v90
v_add_f32 v20, v20, v89
v_cvt_pk_bf16_f32 v108, v88, v89
v_mfma_f32_32x32x16_bf16 a[112:127], a[236:239], v[96:99], a[112:127]
v_exp_f32 v91, v91
v_add_f32 v20, v20, v90
v_exp_f32 v92, v92
v_mfma_f32_32x32x16_bf16 a[64:79], a[240:243], v[100:103], a[64:79]
v_add_f32 v20, v20, v91
v_cvt_pk_bf16_f32 v109, v90, v91
v_exp_f32 v93, v93
v_mfma_f32_32x32x16_bf16 a[80:95], a[244:247], v[100:103], a[80:95]
s_add_u32 m0, s28, 24576
v_add_f32 v20, v20, v92
v_exp_f32 v94, v94
v_add_f32 v20, v20, v93
v_mfma_f32_32x32x16_bf16 a[96:111], a[248:251], v[100:103], a[96:111]
s_waitcnt vmcnt(5)
buffer_load_dwordx4 v14, s[8:11], s46 offen offset:1024 nt lds
v_cvt_pk_bf16_f32 v110, v92, v93
v_mfma_f32_32x32x16_bf16 a[112:127], a[252:255], v[100:103], a[112:127]
v_exp_f32 v95, v95
v_add_f32 v20, v20, v94
v_add_f32 v20, v20, v95
v_cvt_pk_bf16_f32 v111, v94, v95
v_mfma_f32_32x32x16_bf16 v[80:95], a[192:195], v[192:195], v[128:143]
s_barrier
v_exp_f32 v64, v64
v_exp_f32 v65, v65
v_mfma_f32_32x32x16_bf16 v[80:95], a[196:199], v[196:199], v[80:95]
v_add_f32 v18, v18, v64
v_exp_f32 v66, v66
v_add_f32 v18, v18, v65
v_mfma_f32_32x32x16_bf16 v[80:95], a[200:203], v[200:203], v[80:95]
v_cvt_pk_bf16_f32 v96, v64, v65
v_exp_f32 v67, v67
v_add_f32 v18, v18, v66
v_exp_f32 v68, v68
v_mfma_f32_32x32x16_bf16 v[80:95], a[204:207], v[204:207], v[80:95]
s_add_u32 m0, s28, 24576
v_add_f32 v18, v18, v67
v_cvt_pk_bf16_f32 v97, v66, v67
v_exp_f32 v69, v69
v_mfma_f32_32x32x16_bf16 v[80:95], a[208:211], v[208:211], v[80:95]
s_waitcnt vmcnt(5)
buffer_load_dwordx4 v15, s[8:11], s46 offen offset:2048 nt lds
v_add_f32 v18, v18, v68
v_exp_f32 v70, v70
v_mfma_f32_32x32x16_bf16 v[80:95], a[212:215], v[212:215], v[80:95]
v_add_f32 v18, v18, v69
v_cvt_pk_bf16_f32 v98, v68, v69
v_exp_f32 v71, v71
v_add_f32 v18, v18, v70
v_mfma_f32_32x32x16_bf16 v[80:95], a[216:219], v[216:219], v[80:95]
v_exp_f32 v72, v72
v_add_f32 v18, v18, v71
v_cvt_pk_bf16_f32 v99, v70, v71
v_mfma_f32_32x32x16_bf16 v[80:95], a[220:223], v[220:223], v[80:95]
v_exp_f32 v73, v73
v_add_f32 v18, v18, v72
v_exp_f32 v74, v74
v_add_f32 v18, v18, v73
v_mfma_f32_32x32x16_bf16 a[128:143], a[224:227], v[104:107], a[128:143]
ds_read_b64_tr_b16 a[224:225], v9 offset:0
ds_read_b64_tr_b16 a[226:227], v9 offset:2048
v_cvt_pk_bf16_f32 v100, v72, v73
v_exp_f32 v75, v75
v_mfma_f32_32x32x16_bf16 a[144:159], a[228:231], v[104:107], a[144:159]
ds_read_b64_tr_b16 a[228:229], v10 offset:0
ds_read_b64_tr_b16 a[230:231], v10 offset:2048
v_add_f32 v18, v18, v74
v_exp_f32 v76, v76
v_mfma_f32_32x32x16_bf16 a[160:175], a[232:235], v[104:107], a[160:175]
ds_read_b64_tr_b16 a[232:233], v11 offset:0
ds_read_b64_tr_b16 a[234:235], v11 offset:2048
s_add_u32 m0, s28, 24576
v_add_f32 v18, v18, v75
v_cvt_pk_bf16_f32 v101, v74, v75
v_mfma_f32_32x32x16_bf16 a[176:191], a[236:239], v[104:107], a[176:191]
ds_read_b64_tr_b16 a[236:237], v12 offset:0
ds_read_b64_tr_b16 a[238:239], v12 offset:2048
s_waitcnt vmcnt(5)
buffer_load_dwordx4 v16, s[8:11], s46 offen offset:3072 nt lds
s_add_u32 s54, s54, 8192
s_and_b32 s54, s54, 0x1ffff
v_mfma_f32_32x32x16_bf16 a[128:143], a[240:243], v[108:111], a[128:143]
ds_read_b64_tr_b16 a[240:241], v9 offset:4096
ds_read_b64_tr_b16 a[242:243], v9 offset:6144
v_exp_f32 v77, v77
v_add_f32 v18, v18, v76
v_mfma_f32_32x32x16_bf16 a[144:159], a[244:247], v[108:111], a[144:159]
ds_read_b64_tr_b16 a[244:245], v10 offset:4096
ds_read_b64_tr_b16 a[246:247], v10 offset:6144
v_exp_f32 v78, v78
v_add_f32 v18, v18, v77
v_mfma_f32_32x32x16_bf16 a[160:175], a[248:251], v[108:111], a[160:175]
ds_read_b64_tr_b16 a[248:249], v11 offset:4096
ds_read_b64_tr_b16 a[250:251], v11 offset:6144
v_cvt_pk_bf16_f32 v102, v76, v77
v_exp_f32 v79, v79
v_mfma_f32_32x32x16_bf16 a[176:191], a[252:255], v[108:111], a[176:191]
ds_read_b64_tr_b16 a[252:253], v12 offset:4096
ds_read_b64_tr_b16 a[254:255], v12 offset:6144
v_add_f32 v18, v18, v78
v_add_f32 v18, v18, v79
v_cvt_pk_bf16_f32 v103, v78, v79
v_mfma_f32_32x32x16_bf16 v[64:79], a[192:195], v[224:227], v[144:159]
ds_read_b128 a[192:195], v1 offset:8192
v_exp_f32 v80, v80
v_exp_f32 v81, v81
v_mfma_f32_32x32x16_bf16 v[64:79], a[196:199], v[228:231], v[64:79]
ds_read_b128 a[196:199], v2 offset:8192
s_add_u32 m0, s28, 49152
s_add_u32 s47, s29, s55
v_add_f32 v19, v19, v80
v_mfma_f32_32x32x16_bf16 v[64:79], a[200:203], v[232:235], v[64:79]
ds_read_b128 a[200:203], v3 offset:8192
s_waitcnt vmcnt(5)
buffer_load_dwordx4 v17, s[12:15], s47 offen offset:0 nt lds
v_exp_f32 v82, v82
v_mfma_f32_32x32x16_bf16 v[64:79], a[204:207], v[236:239], v[64:79]
ds_read_b128 a[204:207], v4 offset:8192
v_add_f32 v19, v19, v81
v_cvt_pk_bf16_f32 v104, v80, v81
v_exp_f32 v83, v83
v_mfma_f32_32x32x16_bf16 v[64:79], a[208:211], v[240:243], v[64:79]
ds_read_b128 a[208:211], v5 offset:8192
v_add_f32 v19, v19, v82
v_exp_f32 v84, v84
v_mfma_f32_32x32x16_bf16 v[64:79], a[212:215], v[244:247], v[64:79]
ds_read_b128 a[212:215], v6 offset:8192
v_add_f32 v19, v19, v83
v_cvt_pk_bf16_f32 v105, v82, v83
v_exp_f32 v85, v85
v_mfma_f32_32x32x16_bf16 v[64:79], a[216:219], v[248:251], v[64:79]
ds_read_b128 a[216:219], v7 offset:8192
v_add_f32 v19, v19, v84
v_exp_f32 v86, v86
v_mfma_f32_32x32x16_bf16 v[64:79], a[220:223], v[252:255], v[64:79]
ds_read_b128 a[220:223], v8 offset:8192
s_add_u32 m0, s28, 49152
v_add_f32 v19, v19, v85
v_cvt_pk_bf16_f32 v106, v84, v85
v_exp_f32 v87, v87
s_waitcnt lgkmcnt(8)
v_mfma_f32_32x32x16_bf16 a[0:15], a[224:227], v[96:99], a[0:15]
s_waitcnt vmcnt(5)
buffer_load_dwordx4 v17, s[12:15], s47 offen offset:1024 nt lds
v_add_f32 v19, v19, v86
v_mfma_f32_32x32x16_bf16 a[16:31], a[228:231], v[96:99], a[16:31]
v_exp_f32 v88, v88
v_add_f32 v19, v19, v87
v_cvt_pk_bf16_f32 v107, v86, v87
v_exp_f32 v89, v89
v_mfma_f32_32x32x16_bf16 a[32:47], a[232:235], v[96:99], a[32:47]
v_add_f32 v19, v19, v88
v_exp_f32 v90, v90
v_add_f32 v19, v19, v89
v_mfma_f32_32x32x16_bf16 a[48:63], a[236:239], v[96:99], a[48:63]
v_cvt_pk_bf16_f32 v108, v88, v89
v_exp_f32 v91, v91
v_add_f32 v19, v19, v90
v_mfma_f32_32x32x16_bf16 a[0:15], a[240:243], v[100:103], a[0:15]
v_exp_f32 v92, v92
v_add_f32 v19, v19, v91
v_cvt_pk_bf16_f32 v109, v90, v91
v_exp_f32 v93, v93
v_mfma_f32_32x32x16_bf16 a[16:31], a[244:247], v[100:103], a[16:31]
v_add_f32 v19, v19, v92
v_exp_f32 v94, v94
v_add_f32 v19, v19, v93
v_mfma_f32_32x32x16_bf16 a[32:47], a[248:251], v[100:103], a[32:47]
s_add_u32 m0, s28, 49152
v_cvt_pk_bf16_f32 v110, v92, v93
v_exp_f32 v95, v95
v_mfma_f32_32x32x16_bf16 a[48:63], a[252:255], v[100:103], a[48:63]
s_waitcnt vmcnt(5)
buffer_load_dwordx4 v17, s[12:15], s47 offen offset:2048 nt lds
v_add_f32 v19, v19, v94
v_add_f32 v19, v19, v95
v_cvt_pk_bf16_f32 v111, v94, v95
s_waitcnt lgkmcnt(0)
v_mfma_f32_32x32x16_bf16 v[80:95], a[192:195], v[160:163], v[112:127]
v_exp_f32 v64, v64
v_exp_f32 v65, v65
v_mfma_f32_32x32x16_bf16 v[80:95], a[196:199], v[164:167], v[80:95]
v_add_f32 v20, v20, v64
v_exp_f32 v66, v66
v_add_f32 v20, v20, v65
v_mfma_f32_32x32x16_bf16 v[80:95], a[200:203], v[168:171], v[80:95]
v_cvt_pk_bf16_f32 v96, v64, v65
v_exp_f32 v67, v67
v_add_f32 v20, v20, v66
v_mfma_f32_32x32x16_bf16 v[80:95], a[204:207], v[172:175], v[80:95]
v_exp_f32 v68, v68
v_add_f32 v20, v20, v67
v_cvt_pk_bf16_f32 v97, v66, v67
v_mfma_f32_32x32x16_bf16 v[80:95], a[208:211], v[176:179], v[80:95]
v_exp_f32 v69, v69
v_add_f32 v20, v20, v68
v_exp_f32 v70, v70
v_mfma_f32_32x32x16_bf16 v[80:95], a[212:215], v[180:183], v[80:95]
s_add_u32 m0, s28, 49152
v_add_f32 v20, v20, v69
v_cvt_pk_bf16_f32 v98, v68, v69
v_mfma_f32_32x32x16_bf16 v[80:95], a[216:219], v[184:187], v[80:95]
s_waitcnt vmcnt(5)
buffer_load_dwordx4 v17, s[12:15], s47 offen offset:3072 nt lds
s_add_u32 s55, s55, 8192
s_and_b32 s55, s55, 0x1ffff
v_mfma_f32_32x32x16_bf16 v[80:95], a[220:223], v[188:191], v[80:95]
v_exp_f32 v71, v71
v_add_f32 v20, v20, v70
v_exp_f32 v72, v72
v_mfma_f32_32x32x16_bf16 a[64:79], a[224:227], v[104:107], a[64:79]
v_add_f32 v20, v20, v71
v_cvt_pk_bf16_f32 v99, v70, v71
v_exp_f32 v73, v73
v_mfma_f32_32x32x16_bf16 a[80:95], a[228:231], v[104:107], a[80:95]
v_add_f32 v20, v20, v72
v_exp_f32 v74, v74
v_add_f32 v20, v20, v73
v_mfma_f32_32x32x16_bf16 a[96:111], a[232:235], v[104:107], a[96:111]
v_cvt_pk_bf16_f32 v100, v72, v73
v_exp_f32 v75, v75
v_add_f32 v20, v20, v74
v_mfma_f32_32x32x16_bf16 a[112:127], a[236:239], v[104:107], a[112:127]
s_add_u32 m0, s28, 0
s_add_u32 s46, s29, s54
v_exp_f32 v76, v76
v_mfma_f32_32x32x16_bf16 a[64:79], a[240:243], v[108:111], a[64:79]
s_waitcnt vmcnt(5)
buffer_load_dwordx4 v13, s[8:11], s46 offen offset:0 nt lds
v_add_f32 v20, v20, v75
v_cvt_pk_bf16_f32 v101, v74, v75
v_mfma_f32_32x32x16_bf16 a[80:95], a[244:247], v[108:111], a[80:95]
v_exp_f32 v77, v77
v_add_f32 v20, v20, v76
v_mfma_f32_32x32x16_bf16 a[96:111], a[248:251], v[108:111], a[96:111]
v_exp_f32 v78, v78
v_add_f32 v20, v20, v77
v_cvt_pk_bf16_f32 v102, v76, v77
v_mfma_f32_32x32x16_bf16 a[112:127], a[252:255], v[108:111], a[112:127]
v_exp_f32 v79, v79
v_add_f32 v20, v20, v78
v_add_f32 v20, v20, v79
v_cvt_pk_bf16_f32 v103, v78, v79
v_mfma_f32_32x32x16_bf16 v[64:79], a[192:195], v[192:195], v[128:143]
s_barrier
v_exp_f32 v80, v80
v_exp_f32 v81, v81
v_mfma_f32_32x32x16_bf16 v[64:79], a[196:199], v[196:199], v[64:79]
v_add_f32 v18, v18, v80
v_exp_f32 v82, v82
v_add_f32 v18, v18, v81
v_mfma_f32_32x32x16_bf16 v[64:79], a[200:203], v[200:203], v[64:79]
s_add_u32 m0, s28, 0
v_cvt_pk_bf16_f32 v104, v80, v81
v_exp_f32 v83, v83
v_add_f32 v18, v18, v82
v_mfma_f32_32x32x16_bf16 v[64:79], a[204:207], v[204:207], v[64:79]
s_waitcnt vmcnt(5)
buffer_load_dwordx4 v14, s[8:11], s46 offen offset:1024 nt lds
v_exp_f32 v84, v84
v_add_f32 v18, v18, v83
v_mfma_f32_32x32x16_bf16 v[64:79], a[208:211], v[208:211], v[64:79]
v_cvt_pk_bf16_f32 v105, v82, v83
v_exp_f32 v85, v85
v_add_f32 v18, v18, v84
v_exp_f32 v86, v86
v_mfma_f32_32x32x16_bf16 v[64:79], a[212:215], v[212:215], v[64:79]
v_add_f32 v18, v18, v85
v_cvt_pk_bf16_f32 v106, v84, v85
v_exp_f32 v87, v87
v_mfma_f32_32x32x16_bf16 v[64:79], a[216:219], v[216:219], v[64:79]
v_add_f32 v18, v18, v86
v_exp_f32 v88, v88
v_add_f32 v18, v18, v87
v_cvt_pk_bf16_f32 v107, v86, v87
v_mfma_f32_32x32x16_bf16 v[64:79], a[220:223], v[220:223], v[64:79]
v_exp_f32 v89, v89
v_add_f32 v18, v18, v88
v_exp_f32 v90, v90
v_mfma_f32_32x32x16_bf16 a[128:143], a[224:227], v[96:99], a[128:143]
ds_read_b64_tr_b16 a[224:225], v9 offset:8192
ds_read_b64_tr_b16 a[226:227], v9 offset:10240
v_add_f32 v18, v18, v89
v_cvt_pk_bf16_f32 v108, v88, v89
v_exp_f32 v91, v91
v_mfma_f32_32x32x16_bf16 a[144:159], a[228:231], v[96:99], a[144:159]
ds_read_b64_tr_b16 a[228:229], v10 offset:8192
ds_read_b64_tr_b16 a[230:231], v10 offset:10240
s_add_u32 m0, s28, 0
v_add_f32 v18, v18, v90
v_mfma_f32_32x32x16_bf16 a[160:175], a[232:235], v[96:99], a[160:175]
ds_read_b64_tr_b16 a[232:233], v11 offset:8192
ds_read_b64_tr_b16 a[234:235], v11 offset:10240
s_waitcnt vmcnt(5)
buffer_load_dwordx4 v15, s[8:11], s46 offen offset:2048 nt lds
v_exp_f32 v92, v92
v_mfma_f32_32x32x16_bf16 a[176:191], a[236:239], v[96:99], a[176:191]
ds_read_b64_tr_b16 a[236:237], v12 offset:8192
ds_read_b64_tr_b16 a[238:239], v12 offset:10240
v_add_f32 v18, v18, v91
v_cvt_pk_bf16_f32 v109, v90, v91
v_mfma_f32_32x32x16_bf16 a[128:143], a[240:243], v[100:103], a[128:143]
ds_read_b64_tr_b16 a[240:241], v9 offset:12288
ds_read_b64_tr_b16 a[242:243], v9 offset:14336
v_exp_f32 v93, v93
v_add_f32 v18, v18, v92
v_mfma_f32_32x32x16_bf16 a[144:159], a[244:247], v[100:103], a[144:159]
ds_read_b64_tr_b16 a[244:245], v10 offset:12288
ds_read_b64_tr_b16 a[246:247], v10 offset:14336
v_exp_f32 v94, v94
v_add_f32 v18, v18, v93
v_mfma_f32_32x32x16_bf16 a[160:175], a[248:251], v[100:103], a[160:175]
ds_read_b64_tr_b16 a[248:249], v11 offset:12288
ds_read_b64_tr_b16 a[250:251], v11 offset:14336
v_cvt_pk_bf16_f32 v110, v92, v93
v_exp_f32 v95, v95
v_mfma_f32_32x32x16_bf16 a[176:191], a[252:255], v[100:103], a[176:191]
ds_read_b64_tr_b16 a[252:253], v12 offset:12288
ds_read_b64_tr_b16 a[254:255], v12 offset:14336
v_add_f32 v18, v18, v94
v_add_f32 v18, v18, v95
v_cvt_pk_bf16_f32 v111, v94, v95
v_mfma_f32_32x32x16_bf16 v[80:95], a[192:195], v[224:227], v[144:159]
ds_read_b128 a[192:195], v1 offset:16384
s_add_u32 m0, s28, 0
v_exp_f32 v64, v64
v_mfma_f32_32x32x16_bf16 v[80:95], a[196:199], v[228:231], v[80:95]
ds_read_b128 a[196:199], v2 offset:16384
s_waitcnt vmcnt(5)
buffer_load_dwordx4 v16, s[8:11], s46 offen offset:3072 nt lds
s_add_u32 s54, s54, 8192
s_and_b32 s54, s54, 0x1ffff
v_mfma_f32_32x32x16_bf16 v[80:95], a[200:203], v[232:235], v[80:95]
ds_read_b128 a[200:203], v3 offset:16384
v_exp_f32 v65, v65
v_add_f32 v19, v19, v64
v_exp_f32 v66, v66
v_mfma_f32_32x32x16_bf16 v[80:95], a[204:207], v[236:239], v[80:95]
ds_read_b128 a[204:207], v4 offset:16384
v_add_f32 v19, v19, v65
v_cvt_pk_bf16_f32 v96, v64, v65
v_exp_f32 v67, v67
v_mfma_f32_32x32x16_bf16 v[80:95], a[208:211], v[240:243], v[80:95]
ds_read_b128 a[208:211], v5 offset:16384
v_add_f32 v19, v19, v66
v_exp_f32 v68, v68
v_mfma_f32_32x32x16_bf16 v[80:95], a[212:215], v[244:247], v[80:95]
ds_read_b128 a[212:215], v6 offset:16384
v_add_f32 v19, v19, v67
v_cvt_pk_bf16_f32 v97, v66, v67
v_exp_f32 v69, v69
v_mfma_f32_32x32x16_bf16 v[80:95], a[216:219], v[248:251], v[80:95]
ds_read_b128 a[216:219], v7 offset:16384
s_add_u32 m0, s28, 57344
s_add_u32 s47, s29, s55
v_add_f32 v19, v19, v68
v_mfma_f32_32x32x16_bf16 v[80:95], a[220:223], v[252:255], v[80:95]
ds_read_b128 a[220:223], v8 offset:16384
s_waitcnt vmcnt(5)
buffer_load_dwordx4 v17, s[12:15], s47 offen offset:0 nt lds
v_exp_f32 v70, v70
s_waitcnt lgkmcnt(8)
v_mfma_f32_32x32x16_bf16 a[0:15], a[224:227], v[104:107], a[0:15]
v_add_f32 v19, v19, v69
v_cvt_pk_bf16_f32 v98, v68, v69
v_exp_f32 v71, v71
v_add_f32 v19, v19, v70
v_mfma_f32_32x32x16_bf16 a[16:31], a[228:231], v[104:107], a[16:31]
v_exp_f32 v72, v72
v_add_f32 v19, v19, v71
v_cvt_pk_bf16_f32 v99, v70, v71
v_mfma_f32_32x32x16_bf16 a[32:47], a[232:235], v[104:107], a[32:47]
v_exp_f32 v73, v73
v_add_f32 v19, v19, v72
v_exp_f32 v74, v74
v_mfma_f32_32x32x16_bf16 a[48:63], a[236:239], v[104:107], a[48:63]
v_add_f32 v19, v19, v73
v_cvt_pk_bf16_f32 v100, v72, v73
v_exp_f32 v75, v75
v_add_f32 v19, v19, v74
v_mfma_f32_32x32x16_bf16 a[0:15], a[240:243], v[108:111], a[0:15]
v_exp_f32 v76, v76
v_add_f32 v19, v19, v75
v_cvt_pk_bf16_f32 v101, v74, v75
v_mfma_f32_32x32x16_bf16 a[16:31], a[244:247], v[108:111], a[16:31]
s_add_u32 m0, s28, 57344
v_exp_f32 v77, v77
v_add_f32 v19, v19, v76
v_exp_f32 v78, v78
v_mfma_f32_32x32x16_bf16 a[32:47], a[248:251], v[108:111], a[32:47]
s_waitcnt vmcnt(5)
buffer_load_dwordx4 v17, s[12:15], s47 offen offset:1024 nt lds
v_add_f32 v19, v19, v77
v_cvt_pk_bf16_f32 v102, v76, v77
v_mfma_f32_32x32x16_bf16 a[48:63], a[252:255], v[108:111], a[48:63]
v_exp_f32 v79, v79
v_add_f32 v19, v19, v78
v_add_f32 v19, v19, v79
v_cvt_pk_bf16_f32 v103, v78, v79
s_waitcnt lgkmcnt(0)
v_mfma_f32_32x32x16_bf16 v[64:79], a[192:195], v[160:163], v[112:127]
v_exp_f32 v80, v80
v_exp_f32 v81, v81
v_mfma_f32_32x32x16_bf16 v[64:79], a[196:199], v[164:167], v[64:79]
v_add_f32 v20, v20, v80
v_exp_f32 v82, v82
v_add_f32 v20, v20, v81
v_mfma_f32_32x32x16_bf16 v[64:79], a[200:203], v[168:171], v[64:79]
v_cvt_pk_bf16_f32 v104, v80, v81
v_exp_f32 v83, v83
v_add_f32 v20, v20, v82
v_mfma_f32_32x32x16_bf16 v[64:79], a[204:207], v[172:175], v[64:79]
s_add_u32 m0, s28, 57344
v_exp_f32 v84, v84
v_add_f32 v20, v20, v83
v_mfma_f32_32x32x16_bf16 v[64:79], a[208:211], v[176:179], v[64:79]
s_waitcnt vmcnt(5)
buffer_load_dwordx4 v17, s[12:15], s47 offen offset:2048 nt lds
v_cvt_pk_bf16_f32 v105, v82, v83
v_exp_f32 v85, v85
v_mfma_f32_32x32x16_bf16 v[64:79], a[212:215], v[180:183], v[64:79]
v_add_f32 v20, v20, v84
v_exp_f32 v86, v86
v_mfma_f32_32x32x16_bf16 v[64:79], a[216:219], v[184:187], v[64:79]
v_add_f32 v20, v20, v85
v_cvt_pk_bf16_f32 v106, v84, v85
v_exp_f32 v87, v87
v_mfma_f32_32x32x16_bf16 v[64:79], a[220:223], v[188:191], v[64:79]
v_add_f32 v20, v20, v86
v_exp_f32 v88, v88
v_add_f32 v20, v20, v87
v_mfma_f32_32x32x16_bf16 a[64:79], a[224:227], v[96:99], a[64:79]
v_cvt_pk_bf16_f32 v107, v86, v87
v_exp_f32 v89, v89
v_add_f32 v20, v20, v88
v_mfma_f32_32x32x16_bf16 a[80:95], a[228:231], v[96:99], a[80:95]
v_exp_f32 v90, v90
v_add_f32 v20, v20, v89
v_cvt_pk_bf16_f32 v108, v88, v89
v_mfma_f32_32x32x16_bf16 a[96:111], a[232:235], v[96:99], a[96:111]
s_add_u32 m0, s28, 57344
v_exp_f32 v91, v91
v_add_f32 v20, v20, v90
v_mfma_f32_32x32x16_bf16 a[112:127], a[236:239], v[96:99], a[112:127]
s_waitcnt vmcnt(5)
buffer_load_dwordx4 v17, s[12:15], s47 offen offset:3072 nt lds
s_add_u32 s55, s55, 8192
s_and_b32 s55, s55, 0x1ffff
v_mfma_f32_32x32x16_bf16 a[64:79], a[240:243], v[100:103], a[64:79]
v_exp_f32 v92, v92
v_add_f32 v20, v20, v91
v_cvt_pk_bf16_f32 v109, v90, v91
v_mfma_f32_32x32x16_bf16 a[80:95], a[244:247], v[100:103], a[80:95]
v_exp_f32 v93, v93
v_add_f32 v20, v20, v92
v_exp_f32 v94, v94
v_mfma_f32_32x32x16_bf16 a[96:111], a[248:251], v[100:103], a[96:111]
v_add_f32 v20, v20, v93
v_cvt_pk_bf16_f32 v110, v92, v93
v_exp_f32 v95, v95
v_mfma_f32_32x32x16_bf16 a[112:127], a[252:255], v[100:103], a[112:127]
v_add_f32 v20, v20, v94
v_add_f32 v20, v20, v95
v_cvt_pk_bf16_f32 v111, v94, v95
v_mfma_f32_32x32x16_bf16 v[80:95], a[192:195], v[192:195], v[128:143]
s_barrier
v_exp_f32 v64, v64
v_exp_f32 v65, v65
v_mfma_f32_32x32x16_bf16 v[80:95], a[196:199], v[196:199], v[80:95]
s_add_u32 m0, s28, 8192
s_add_u32 s46, s29, s54
v_add_f32 v18, v18, v64
v_exp_f32 v66, v66
v_mfma_f32_32x32x16_bf16 v[80:95], a[200:203], v[200:203], v[80:95]
s_waitcnt vmcnt(5)
buffer_load_dwordx4 v13, s[8:11], s46 offen offset:0 nt lds
v_add_f32 v18, v18, v65
v_cvt_pk_bf16_f32 v96, v64, v65
v_mfma_f32_32x32x16_bf16 v[80:95], a[204:207], v[204:207], v[80:95]
v_exp_f32 v67, v67
v_add_f32 v18, v18, v66
v_exp_f32 v68, v68
v_add_f32 v18, v18, v67
v_mfma_f32_32x32x16_bf16 v[80:95], a[208:211], v[208:211], v[80:95]
v_cvt_pk_bf16_f32 v97, v66, v67
v_exp_f32 v69, v69
v_add_f32 v18, v18, v68
v_exp_f32 v70, v70
v_mfma_f32_32x32x16_bf16 v[80:95], a[212:215], v[212:215], v[80:95]
v_add_f32 v18, v18, v69
v_cvt_pk_bf16_f32 v98, v68, v69
v_exp_f32 v71, v71
v_add_f32 v18, v18, v70
v_mfma_f32_32x32x16_bf16 v[80:95], a[216:219], v[216:219], v[80:95]
v_exp_f32 v72, v72
v_add_f32 v18, v18, v71
v_cvt_pk_bf16_f32 v99, v70, v71
v_mfma_f32_32x32x16_bf16 v[80:95], a[220:223], v[220:223], v[80:95]
s_add_u32 m0, s28, 8192
v_exp_f32 v73, v73
v_add_f32 v18, v18, v72
v_exp_f32 v74, v74
v_mfma_f32_32x32x16_bf16 a[128:143], a[224:227], v[104:107], a[128:143]
ds_read_b64_tr_b16 a[224:225], v9 offset:16384
ds_read_b64_tr_b16 a[226:227], v9 offset:18432
s_waitcnt vmcnt(5)
buffer_load_dwordx4 v14, s[8:11], s46 offen offset:1024 nt lds
v_add_f32 v18, v18, v73
v_mfma_f32_32x32x16_bf16 a[144:159], a[228:231], v[104:107], a[144:159]
ds_read_b64_tr_b16 a[228:229], v10 offset:16384
ds_read_b64_tr_b16 a[230:231], v10 offset:18432
v_cvt_pk_bf16_f32 v100, v72, v73
v_exp_f32 v75, v75
v_add_f32 v18, v18, v74
v_mfma_f32_32x32x16_bf16 a[160:175], a[232:235], v[104:107], a[160:175]
ds_read_b64_tr_b16 a[232:233], v11 offset:16384
ds_read_b64_tr_b16 a[234:235], v11 offset:18432
v_exp_f32 v76, v76
v_add_f32 v18, v18, v75
v_mfma_f32_32x32x16_bf16 a[176:191], a[236:239], v[104:107], a[176:191]
ds_read_b64_tr_b16 a[236:237], v12 offset:16384
ds_read_b64_tr_b16 a[238:239], v12 offset:18432
v_cvt_pk_bf16_f32 v101, v74, v75
v_exp_f32 v77, v77
v_mfma_f32_32x32x16_bf16 a[128:143], a[240:243], v[108:111], a[128:143]
ds_read_b64_tr_b16 a[240:241], v9 offset:20480
ds_read_b64_tr_b16 a[242:243], v9 offset:22528
v_add_f32 v18, v18, v76
v_exp_f32 v78, v78
v_mfma_f32_32x32x16_bf16 a[144:159], a[244:247], v[108:111], a[144:159]
ds_read_b64_tr_b16 a[244:245], v10 offset:20480
ds_read_b64_tr_b16 a[246:247], v10 offset:22528
v_add_f32 v18, v18, v77
v_cvt_pk_bf16_f32 v102, v76, v77
v_exp_f32 v79, v79
v_mfma_f32_32x32x16_bf16 a[160:175], a[248:251], v[108:111], a[160:175]
ds_read_b64_tr_b16 a[248:249], v11 offset:20480
ds_read_b64_tr_b16 a[250:251], v11 offset:22528
s_add_u32 m0, s28, 8192
v_add_f32 v18, v18, v78
v_add_f32 v18, v18, v79
v_mfma_f32_32x32x16_bf16 a[176:191], a[252:255], v[108:111], a[176:191]
ds_read_b64_tr_b16 a[252:253], v12 offset:20480
ds_read_b64_tr_b16 a[254:255], v12 offset:22528
s_waitcnt vmcnt(5)
buffer_load_dwordx4 v15, s[8:11], s46 offen offset:2048 nt lds
v_cvt_pk_bf16_f32 v103, v78, v79
v_mfma_f32_32x32x16_bf16 v[64:79], a[192:195], v[224:227], v[144:159]
ds_read_b128 a[192:195], v1 offset:24576
v_exp_f32 v80, v80
v_exp_f32 v81, v81
v_mfma_f32_32x32x16_bf16 v[64:79], a[196:199], v[228:231], v[64:79]
ds_read_b128 a[196:199], v2 offset:24576
v_add_f32 v19, v19, v80
v_exp_f32 v82, v82
v_mfma_f32_32x32x16_bf16 v[64:79], a[200:203], v[232:235], v[64:79]
ds_read_b128 a[200:203], v3 offset:24576
v_add_f32 v19, v19, v81
v_cvt_pk_bf16_f32 v104, v80, v81
v_exp_f32 v83, v83
v_mfma_f32_32x32x16_bf16 v[64:79], a[204:207], v[236:239], v[64:79]
ds_read_b128 a[204:207], v4 offset:24576
v_add_f32 v19, v19, v82
v_exp_f32 v84, v84
v_mfma_f32_32x32x16_bf16 v[64:79], a[208:211], v[240:243], v[64:79]
ds_read_b128 a[208:211], v5 offset:24576
v_add_f32 v19, v19, v83
v_cvt_pk_bf16_f32 v105, v82, v83
v_exp_f32 v85, v85
v_mfma_f32_32x32x16_bf16 v[64:79], a[212:215], v[244:247], v[64:79]
ds_read_b128 a[212:215], v6 offset:24576
s_add_u32 m0, s28, 8192
v_add_f32 v19, v19, v84
v_exp_f32 v86, v86
v_mfma_f32_32x32x16_bf16 v[64:79], a[216:219], v[248:251], v[64:79]
ds_read_b128 a[216:219], v7 offset:24576
s_waitcnt vmcnt(5)
buffer_load_dwordx4 v16, s[8:11], s46 offen offset:3072 nt lds
s_add_u32 s54, s54, 8192
s_and_b32 s54, s54, 0x1ffff
v_mfma_f32_32x32x16_bf16 v[64:79], a[220:223], v[252:255], v[64:79]
ds_read_b128 a[220:223], v8 offset:24576
v_add_f32 v19, v19, v85
v_cvt_pk_bf16_f32 v106, v84, v85
s_waitcnt lgkmcnt(8)
v_mfma_f32_32x32x16_bf16 a[0:15], a[224:227], v[96:99], a[0:15]
v_exp_f32 v87, v87
v_add_f32 v19, v19, v86
v_exp_f32 v88, v88
v_mfma_f32_32x32x16_bf16 a[16:31], a[228:231], v[96:99], a[16:31]
v_add_f32 v19, v19, v87
v_cvt_pk_bf16_f32 v107, v86, v87
v_exp_f32 v89, v89
v_add_f32 v19, v19, v88
v_mfma_f32_32x32x16_bf16 a[32:47], a[232:235], v[96:99], a[32:47]
v_exp_f32 v90, v90
v_add_f32 v19, v19, v89
v_cvt_pk_bf16_f32 v108, v88, v89
v_mfma_f32_32x32x16_bf16 a[48:63], a[236:239], v[96:99], a[48:63]
s_add_u32 m0, s28, 32768
s_add_u32 s47, s29, s55
v_exp_f32 v91, v91
v_add_f32 v19, v19, v90
v_mfma_f32_32x32x16_bf16 a[0:15], a[240:243], v[100:103], a[0:15]
s_waitcnt vmcnt(5)
buffer_load_dwordx4 v17, s[12:15], s47 offen offset:0 nt lds
v_exp_f32 v92, v92
v_mfma_f32_32x32x16_bf16 a[16:31], a[244:247], v[100:103], a[16:31]
v_add_f32 v19, v19, v91
v_cvt_pk_bf16_f32 v109, v90, v91
v_exp_f32 v93, v93
v_add_f32 v19, v19, v92
v_mfma_f32_32x32x16_bf16 a[32:47], a[248:251], v[100:103], a[32:47]
v_exp_f32 v94, v94
v_add_f32 v19, v19, v93
v_cvt_pk_bf16_f32 v110, v92, v93
v_mfma_f32_32x32x16_bf16 a[48:63], a[252:255], v[100:103], a[48:63]
v_exp_f32 v95, v95
v_add_f32 v19, v19, v94
v_add_f32 v19, v19, v95
v_cvt_pk_bf16_f32 v111, v94, v95
s_waitcnt lgkmcnt(0)
v_mfma_f32_32x32x16_bf16 v[80:95], a[192:195], v[160:163], v[112:127]
v_exp_f32 v64, v64
v_exp_f32 v65, v65
v_mfma_f32_32x32x16_bf16 v[80:95], a[196:199], v[164:167], v[80:95]
v_add_f32 v20, v20, v64
v_exp_f32 v66, v66
v_add_f32 v20, v20, v65
v_mfma_f32_32x32x16_bf16 v[80:95], a[200:203], v[168:171], v[80:95]
s_add_u32 m0, s28, 32768
v_cvt_pk_bf16_f32 v96, v64, v65
v_exp_f32 v67, v67
v_mfma_f32_32x32x16_bf16 v[80:95], a[204:207], v[172:175], v[80:95]
s_waitcnt vmcnt(5)
buffer_load_dwordx4 v17, s[12:15], s47 offen offset:1024 nt lds
v_add_f32 v20, v20, v66
v_mfma_f32_32x32x16_bf16 v[80:95], a[208:211], v[176:179], v[80:95]
v_exp_f32 v68, v68
v_add_f32 v20, v20, v67
v_cvt_pk_bf16_f32 v97, v66, v67
v_mfma_f32_32x32x16_bf16 v[80:95], a[212:215], v[180:183], v[80:95]
v_exp_f32 v69, v69
v_add_f32 v20, v20, v68
v_exp_f32 v70, v70
v_mfma_f32_32x32x16_bf16 v[80:95], a[216:219], v[184:187], v[80:95]
v_add_f32 v20, v20, v69
v_cvt_pk_bf16_f32 v98, v68, v69
v_exp_f32 v71, v71
v_mfma_f32_32x32x16_bf16 v[80:95], a[220:223], v[188:191], v[80:95]
v_add_f32 v20, v20, v70
v_exp_f32 v72, v72
v_mfma_f32_32x32x16_bf16 a[64:79], a[224:227], v[104:107], a[64:79]
v_add_f32 v20, v20, v71
v_cvt_pk_bf16_f32 v99, v70, v71
v_exp_f32 v73, v73
v_mfma_f32_32x32x16_bf16 a[80:95], a[228:231], v[104:107], a[80:95]
s_add_u32 m0, s28, 32768
v_add_f32 v20, v20, v72
v_exp_f32 v74, v74
v_mfma_f32_32x32x16_bf16 a[96:111], a[232:235], v[104:107], a[96:111]
s_waitcnt vmcnt(5)
buffer_load_dwordx4 v17, s[12:15], s47 offen offset:2048 nt lds
v_add_f32 v20, v20, v73
v_cvt_pk_bf16_f32 v100, v72, v73
v_mfma_f32_32x32x16_bf16 a[112:127], a[236:239], v[104:107], a[112:127]
v_exp_f32 v75, v75
v_add_f32 v20, v20, v74
v_mfma_f32_32x32x16_bf16 a[64:79], a[240:243], v[108:111], a[64:79]
v_exp_f32 v76, v76
v_add_f32 v20, v20, v75
v_cvt_pk_bf16_f32 v101, v74, v75
v_mfma_f32_32x32x16_bf16 a[80:95], a[244:247], v[108:111], a[80:95]
v_exp_f32 v77, v77
v_add_f32 v20, v20, v76
v_exp_f32 v78, v78
v_mfma_f32_32x32x16_bf16 a[96:111], a[248:251], v[108:111], a[96:111]
v_add_f32 v20, v20, v77
v_cvt_pk_bf16_f32 v102, v76, v77
v_exp_f32 v79, v79
v_mfma_f32_32x32x16_bf16 a[112:127], a[252:255], v[108:111], a[112:127]
v_add_f32 v20, v20, v78
v_add_f32 v20, v20, v79
v_cvt_pk_bf16_f32 v103, v78, v79
v_mfma_f32_32x32x16_bf16 v[64:79], a[192:195], v[192:195], v[128:143]
s_barrier
s_add_u32 m0, s28, 32768
v_exp_f32 v80, v80
v_mfma_f32_32x32x16_bf16 v[64:79], a[196:199], v[196:199], v[64:79]
s_waitcnt vmcnt(5)
buffer_load_dwordx4 v17, s[12:15], s47 offen offset:3072 nt lds
s_add_u32 s55, s55, 8192
s_and_b32 s55, s55, 0x1ffff
v_exp_f32 v81, v81
v_mfma_f32_32x32x16_bf16 v[64:79], a[200:203], v[200:203], v[64:79]
v_add_f32 v18, v18, v80
v_exp_f32 v82, v82
v_add_f32 v18, v18, v81
v_cvt_pk_bf16_f32 v104, v80, v81
v_mfma_f32_32x32x16_bf16 v[64:79], a[204:207], v[204:207], v[64:79]
v_exp_f32 v83, v83
v_add_f32 v18, v18, v82
v_exp_f32 v84, v84
v_add_f32 v18, v18, v83
v_mfma_f32_32x32x16_bf16 v[64:79], a[208:211], v[208:211], v[64:79]
v_cvt_pk_bf16_f32 v105, v82, v83
v_exp_f32 v85, v85
v_add_f32 v18, v18, v84
v_mfma_f32_32x32x16_bf16 v[64:79], a[212:215], v[212:215], v[64:79]
v_exp_f32 v86, v86
v_add_f32 v18, v18, v85
v_cvt_pk_bf16_f32 v106, v84, v85
v_exp_f32 v87, v87
v_mfma_f32_32x32x16_bf16 v[64:79], a[216:219], v[216:219], v[64:79]
s_add_u32 m0, s28, 16384
s_add_u32 s46, s29, s54
v_add_f32 v18, v18, v86
v_exp_f32 v88, v88
v_add_f32 v18, v18, v87
v_mfma_f32_32x32x16_bf16 v[64:79], a[220:223], v[220:223], v[64:79]
s_waitcnt vmcnt(5)
buffer_load_dwordx4 v13, s[8:11], s46 offen offset:0 nt lds
v_cvt_pk_bf16_f32 v107, v86, v87
v_exp_f32 v89, v89
v_mfma_f32_32x32x16_bf16 a[128:143], a[224:227], v[96:99], a[128:143]
ds_read_b64_tr_b16 a[224:225], v9 offset:24576
ds_read_b64_tr_b16 a[226:227], v9 offset:26624
v_add_f32 v18, v18, v88
v_exp_f32 v90, v90
v_mfma_f32_32x32x16_bf16 a[144:159], a[228:231], v[96:99], a[144:159]
ds_read_b64_tr_b16 a[228:229], v10 offset:24576
ds_read_b64_tr_b16 a[230:231], v10 offset:26624
v_add_f32 v18, v18, v89
v_cvt_pk_bf16_f32 v108, v88, v89
v_exp_f32 v91, v91
v_mfma_f32_32x32x16_bf16 a[160:175], a[232:235], v[96:99], a[160:175]
ds_read_b64_tr_b16 a[232:233], v11 offset:24576
ds_read_b64_tr_b16 a[234:235], v11 offset:26624
v_add_f32 v18, v18, v90
v_exp_f32 v92, v92
v_mfma_f32_32x32x16_bf16 a[176:191], a[236:239], v[96:99], a[176:191]
ds_read_b64_tr_b16 a[236:237], v12 offset:24576
ds_read_b64_tr_b16 a[238:239], v12 offset:26624
v_add_f32 v18, v18, v91
v_cvt_pk_bf16_f32 v109, v90, v91
v_exp_f32 v93, v93
v_mfma_f32_32x32x16_bf16 a[128:143], a[240:243], v[100:103], a[128:143]
ds_read_b64_tr_b16 a[240:241], v9 offset:28672
ds_read_b64_tr_b16 a[242:243], v9 offset:30720
v_add_f32 v18, v18, v92
v_exp_f32 v94, v94
v_mfma_f32_32x32x16_bf16 a[144:159], a[244:247], v[100:103], a[144:159]
ds_read_b64_tr_b16 a[244:245], v10 offset:28672
ds_read_b64_tr_b16 a[246:247], v10 offset:30720
s_add_u32 m0, s28, 16384
v_add_f32 v18, v18, v93
v_cvt_pk_bf16_f32 v110, v92, v93
v_mfma_f32_32x32x16_bf16 a[160:175], a[248:251], v[100:103], a[160:175]
ds_read_b64_tr_b16 a[248:249], v11 offset:28672
ds_read_b64_tr_b16 a[250:251], v11 offset:30720
s_waitcnt vmcnt(5)
buffer_load_dwordx4 v14, s[8:11], s46 offen offset:1024 nt lds
v_exp_f32 v95, v95
v_mfma_f32_32x32x16_bf16 a[176:191], a[252:255], v[100:103], a[176:191]
ds_read_b64_tr_b16 a[252:253], v12 offset:28672
ds_read_b64_tr_b16 a[254:255], v12 offset:30720
v_add_f32 v18, v18, v94
v_add_f32 v18, v18, v95
v_cvt_pk_bf16_f32 v111, v94, v95
v_mfma_f32_32x32x16_bf16 v[80:95], a[192:195], v[224:227], v[144:159]
ds_read_b128 a[192:195], v1 offset:0
v_exp_f32 v64, v64
v_exp_f32 v65, v65
v_mfma_f32_32x32x16_bf16 v[80:95], a[196:199], v[228:231], v[80:95]
ds_read_b128 a[196:199], v2 offset:0
v_add_f32 v19, v19, v64
v_exp_f32 v66, v66
v_mfma_f32_32x32x16_bf16 v[80:95], a[200:203], v[232:235], v[80:95]
ds_read_b128 a[200:203], v3 offset:0
v_add_f32 v19, v19, v65
v_cvt_pk_bf16_f32 v96, v64, v65
v_exp_f32 v67, v67
v_mfma_f32_32x32x16_bf16 v[80:95], a[204:207], v[236:239], v[80:95]
ds_read_b128 a[204:207], v4 offset:0
s_add_u32 m0, s28, 16384
v_add_f32 v19, v19, v66
v_exp_f32 v68, v68
v_mfma_f32_32x32x16_bf16 v[80:95], a[208:211], v[240:243], v[80:95]
ds_read_b128 a[208:211], v5 offset:0
s_waitcnt vmcnt(5)
buffer_load_dwordx4 v15, s[8:11], s46 offen offset:2048 nt lds
v_add_f32 v19, v19, v67
v_mfma_f32_32x32x16_bf16 v[80:95], a[212:215], v[244:247], v[80:95]
ds_read_b128 a[212:215], v6 offset:0
v_cvt_pk_bf16_f32 v97, v66, v67
v_exp_f32 v69, v69
v_mfma_f32_32x32x16_bf16 v[80:95], a[216:219], v[248:251], v[80:95]
ds_read_b128 a[216:219], v7 offset:0
v_add_f32 v19, v19, v68
v_exp_f32 v70, v70
v_add_f32 v19, v19, v69
v_mfma_f32_32x32x16_bf16 v[80:95], a[220:223], v[252:255], v[80:95]
ds_read_b128 a[220:223], v8 offset:0
v_cvt_pk_bf16_f32 v98, v68, v69
v_exp_f32 v71, v71
s_waitcnt lgkmcnt(8)
v_mfma_f32_32x32x16_bf16 a[0:15], a[224:227], v[104:107], a[0:15]
v_add_f32 v19, v19, v70
v_exp_f32 v72, v72
v_add_f32 v19, v19, v71
v_cvt_pk_bf16_f32 v99, v70, v71
v_mfma_f32_32x32x16_bf16 a[16:31], a[228:231], v[104:107], a[16:31]
v_exp_f32 v73, v73
v_add_f32 v19, v19, v72
v_exp_f32 v74, v74
v_mfma_f32_32x32x16_bf16 a[32:47], a[232:235], v[104:107], a[32:47]
s_add_u32 m0, s28, 16384
v_add_f32 v19, v19, v73
v_cvt_pk_bf16_f32 v100, v72, v73
v_mfma_f32_32x32x16_bf16 a[48:63], a[236:239], v[104:107], a[48:63]
s_waitcnt vmcnt(5)
buffer_load_dwordx4 v16, s[8:11], s46 offen offset:3072 nt lds
s_add_u32 s54, s54, 8192
s_and_b32 s54, s54, 0x1ffff
v_exp_f32 v75, v75
v_mfma_f32_32x32x16_bf16 a[0:15], a[240:243], v[108:111], a[0:15]
v_add_f32 v19, v19, v74
v_exp_f32 v76, v76
v_add_f32 v19, v19, v75
v_mfma_f32_32x32x16_bf16 a[16:31], a[244:247], v[108:111], a[16:31]
v_cvt_pk_bf16_f32 v101, v74, v75
v_exp_f32 v77, v77
v_add_f32 v19, v19, v76
v_mfma_f32_32x32x16_bf16 a[32:47], a[248:251], v[108:111], a[32:47]
v_exp_f32 v78, v78
v_add_f32 v19, v19, v77
v_cvt_pk_bf16_f32 v102, v76, v77
v_mfma_f32_32x32x16_bf16 a[48:63], a[252:255], v[108:111], a[48:63]
v_exp_f32 v79, v79
v_add_f32 v19, v19, v78
v_add_f32 v19, v19, v79
v_cvt_pk_bf16_f32 v103, v78, v79
s_waitcnt lgkmcnt(0)
v_mfma_f32_32x32x16_bf16 v[64:79], a[192:195], v[160:163], v[112:127]
v_exp_f32 v80, v80
v_exp_f32 v81, v81
v_mfma_f32_32x32x16_bf16 v[64:79], a[196:199], v[164:167], v[64:79]
s_add_u32 m0, s28, 40960
s_add_u32 s47, s29, s55
v_add_f32 v20, v20, v80
v_exp_f32 v82, v82
v_mfma_f32_32x32x16_bf16 v[64:79], a[200:203], v[168:171], v[64:79]
s_waitcnt vmcnt(5)
buffer_load_dwordx4 v17, s[12:15], s47 offen offset:0 nt lds
v_add_f32 v20, v20, v81
v_mfma_f32_32x32x16_bf16 v[64:79], a[204:207], v[172:175], v[64:79]
v_cvt_pk_bf16_f32 v104, v80, v81
v_exp_f32 v83, v83
v_add_f32 v20, v20, v82
v_mfma_f32_32x32x16_bf16 v[64:79], a[208:211], v[176:179], v[64:79]
v_exp_f32 v84, v84
v_add_f32 v20, v20, v83
v_cvt_pk_bf16_f32 v105, v82, v83
v_mfma_f32_32x32x16_bf16 v[64:79], a[212:215], v[180:183], v[64:79]
v_exp_f32 v85, v85
v_add_f32 v20, v20, v84
v_exp_f32 v86, v86
v_mfma_f32_32x32x16_bf16 v[64:79], a[216:219], v[184:187], v[64:79]
v_add_f32 v20, v20, v85
v_cvt_pk_bf16_f32 v106, v84, v85
v_exp_f32 v87, v87
v_mfma_f32_32x32x16_bf16 v[64:79], a[220:223], v[188:191], v[64:79]
s_add_u32 m0, s28, 40960
v_add_f32 v20, v20, v86
v_exp_f32 v88, v88
v_mfma_f32_32x32x16_bf16 a[64:79], a[224:227], v[96:99], a[64:79]
s_waitcnt vmcnt(5)
buffer_load_dwordx4 v17, s[12:15], s47 offen offset:1024 nt lds
v_add_f32 v20, v20, v87
v_cvt_pk_bf16_f32 v107, v86, v87
v_mfma_f32_32x32x16_bf16 a[80:95], a[228:231], v[96:99], a[80:95]
v_exp_f32 v89, v89
v_add_f32 v20, v20, v88
v_exp_f32 v90, v90
v_mfma_f32_32x32x16_bf16 a[96:111], a[232:235], v[96:99], a[96:111]
v_add_f32 v20, v20, v89
v_cvt_pk_bf16_f32 v108, v88, v89
v_exp_f32 v91, v91
v_mfma_f32_32x32x16_bf16 a[112:127], a[236:239], v[96:99], a[112:127]
v_add_f32 v20, v20, v90
v_exp_f32 v92, v92
v_add_f32 v20, v20, v91
v_mfma_f32_32x32x16_bf16 a[64:79], a[240:243], v[100:103], a[64:79]
v_cvt_pk_bf16_f32 v109, v90, v91
v_exp_f32 v93, v93
v_add_f32 v20, v20, v92
v_mfma_f32_32x32x16_bf16 a[80:95], a[244:247], v[100:103], a[80:95]
v_exp_f32 v94, v94
v_add_f32 v20, v20, v93
v_cvt_pk_bf16_f32 v110, v92, v93
v_mfma_f32_32x32x16_bf16 a[96:111], a[248:251], v[100:103], a[96:111]
s_add_u32 m0, s28, 40960
v_exp_f32 v95, v95
v_add_f32 v20, v20, v94
v_mfma_f32_32x32x16_bf16 a[112:127], a[252:255], v[100:103], a[112:127]
s_waitcnt vmcnt(5)
buffer_load_dwordx4 v17, s[12:15], s47 offen offset:2048 nt lds
v_add_f32 v20, v20, v95
v_cvt_pk_bf16_f32 v111, v94, v95
v_lshlrev_b32 v55, 4, v0
v_mfma_f32_32x32x16_bf16 v[80:95], a[192:195], v[192:195], v[128:143]
s_barrier
v_exp_f32 v64, v64
v_exp_f32 v65, v65
v_mfma_f32_32x32x16_bf16 v[80:95], a[196:199], v[196:199], v[80:95]
v_add_f32 v18, v18, v64
v_exp_f32 v66, v66
v_add_f32 v18, v18, v65
v_mfma_f32_32x32x16_bf16 v[80:95], a[200:203], v[200:203], v[80:95]
v_cvt_pk_bf16_f32 v96, v64, v65
v_exp_f32 v67, v67
v_add_f32 v18, v18, v66
v_exp_f32 v68, v68
v_mfma_f32_32x32x16_bf16 v[80:95], a[204:207], v[204:207], v[80:95]
v_add_f32 v18, v18, v67
v_cvt_pk_bf16_f32 v97, v66, v67
v_exp_f32 v69, v69
v_add_f32 v18, v18, v68
v_mfma_f32_32x32x16_bf16 v[80:95], a[208:211], v[208:211], v[80:95]
v_exp_f32 v70, v70
v_add_f32 v18, v18, v69
v_cvt_pk_bf16_f32 v98, v68, v69
v_mfma_f32_32x32x16_bf16 v[80:95], a[212:215], v[212:215], v[80:95]
s_add_u32 m0, s28, 40960
v_exp_f32 v71, v71
v_add_f32 v18, v18, v70
v_exp_f32 v72, v72
v_mfma_f32_32x32x16_bf16 v[80:95], a[216:219], v[216:219], v[80:95]
s_waitcnt vmcnt(5)
buffer_load_dwordx4 v17, s[12:15], s47 offen offset:3072 nt lds
s_add_u32 s55, s55, 8192
s_and_b32 s55, s55, 0x1ffff
v_add_f32 v18, v18, v71
v_mfma_f32_32x32x16_bf16 v[80:95], a[220:223], v[220:223], v[80:95]
v_cvt_pk_bf16_f32 v99, v70, v71
v_exp_f32 v73, v73
v_add_f32 v18, v18, v72
v_exp_f32 v74, v74
v_mfma_f32_32x32x16_bf16 a[128:143], a[224:227], v[104:107], a[128:143]
ds_read_b64_tr_b16 a[224:225], v9 offset:0
ds_read_b64_tr_b16 a[226:227], v9 offset:2048
v_add_f32 v18, v18, v73
v_cvt_pk_bf16_f32 v100, v72, v73
v_mfma_f32_32x32x16_bf16 a[144:159], a[228:231], v[104:107], a[144:159]
ds_read_b64_tr_b16 a[228:229], v10 offset:0
ds_read_b64_tr_b16 a[230:231], v10 offset:2048
v_exp_f32 v75, v75
v_add_f32 v18, v18, v74
v_mfma_f32_32x32x16_bf16 a[160:175], a[232:235], v[104:107], a[160:175]
ds_read_b64_tr_b16 a[232:233], v11 offset:0
ds_read_b64_tr_b16 a[234:235], v11 offset:2048
v_exp_f32 v76, v76
v_add_f32 v18, v18, v75
v_cvt_pk_bf16_f32 v101, v74, v75
v_mfma_f32_32x32x16_bf16 a[176:191], a[236:239], v[104:107], a[176:191]
ds_read_b64_tr_b16 a[236:237], v12 offset:0
ds_read_b64_tr_b16 a[238:239], v12 offset:2048
s_add_u32 m0, s28, 24576
s_add_u32 s46, s29, s54
v_exp_f32 v77, v77
v_mfma_f32_32x32x16_bf16 a[128:143], a[240:243], v[108:111], a[128:143]
ds_read_b64_tr_b16 a[240:241], v9 offset:4096
ds_read_b64_tr_b16 a[242:243], v9 offset:6144
s_waitcnt vmcnt(5)
buffer_load_dwordx4 v13, s[8:11], s46 offen offset:0 nt lds
v_mfma_f32_32x32x16_bf16 a[144:159], a[244:247], v[108:111], a[144:159]
ds_read_b64_tr_b16 a[244:245], v10 offset:4096
ds_read_b64_tr_b16 a[246:247], v10 offset:6144
v_add_f32 v18, v18, v76
v_exp_f32 v78, v78
v_add_f32 v18, v18, v77
v_mfma_f32_32x32x16_bf16 a[160:175], a[248:251], v[108:111], a[160:175]
ds_read_b64_tr_b16 a[248:249], v11 offset:4096
ds_read_b64_tr_b16 a[250:251], v11 offset:6144
v_cvt_pk_bf16_f32 v102, v76, v77
v_exp_f32 v79, v79
v_mfma_f32_32x32x16_bf16 a[176:191], a[252:255], v[108:111], a[176:191]
ds_read_b64_tr_b16 a[252:253], v12 offset:4096
ds_read_b64_tr_b16 a[254:255], v12 offset:6144
v_add_f32 v18, v18, v78
v_add_f32 v18, v18, v79
v_cvt_pk_bf16_f32 v103, v78, v79
v_mfma_f32_32x32x16_bf16 v[64:79], a[192:195], v[224:227], v[144:159]
ds_read_b128 a[192:195], v1 offset:8192
v_exp_f32 v80, v80
v_exp_f32 v81, v81
v_mfma_f32_32x32x16_bf16 v[64:79], a[196:199], v[228:231], v[64:79]
ds_read_b128 a[196:199], v2 offset:8192
v_add_f32 v19, v19, v80
v_exp_f32 v82, v82
v_mfma_f32_32x32x16_bf16 v[64:79], a[200:203], v[232:235], v[64:79]
ds_read_b128 a[200:203], v3 offset:8192
s_add_u32 m0, s28, 24576
v_add_f32 v19, v19, v81
v_cvt_pk_bf16_f32 v104, v80, v81
v_mfma_f32_32x32x16_bf16 v[64:79], a[204:207], v[236:239], v[64:79]
ds_read_b128 a[204:207], v4 offset:8192
s_waitcnt vmcnt(5)
buffer_load_dwordx4 v14, s[8:11], s46 offen offset:1024 nt lds
v_exp_f32 v83, v83
v_mfma_f32_32x32x16_bf16 v[64:79], a[208:211], v[240:243], v[64:79]
ds_read_b128 a[208:211], v5 offset:8192
v_add_f32 v19, v19, v82
v_exp_f32 v84, v84
v_mfma_f32_32x32x16_bf16 v[64:79], a[212:215], v[244:247], v[64:79]
ds_read_b128 a[212:215], v6 offset:8192
v_add_f32 v19, v19, v83
v_cvt_pk_bf16_f32 v105, v82, v83
v_exp_f32 v85, v85
v_mfma_f32_32x32x16_bf16 v[64:79], a[216:219], v[248:251], v[64:79]
ds_read_b128 a[216:219], v7 offset:8192
v_add_f32 v19, v19, v84
v_exp_f32 v86, v86
v_mfma_f32_32x32x16_bf16 v[64:79], a[220:223], v[252:255], v[64:79]
ds_read_b128 a[220:223], v8 offset:8192
v_add_f32 v19, v19, v85
v_cvt_pk_bf16_f32 v106, v84, v85
v_exp_f32 v87, v87
s_waitcnt lgkmcnt(8)
v_mfma_f32_32x32x16_bf16 a[0:15], a[224:227], v[96:99], a[0:15]
v_add_f32 v19, v19, v86
v_exp_f32 v88, v88
v_mfma_f32_32x32x16_bf16 a[16:31], a[228:231], v[96:99], a[16:31]
s_add_u32 m0, s28, 24576
v_add_f32 v19, v19, v87
v_cvt_pk_bf16_f32 v107, v86, v87
v_exp_f32 v89, v89
v_mfma_f32_32x32x16_bf16 a[32:47], a[232:235], v[96:99], a[32:47]
s_waitcnt vmcnt(5)
buffer_load_dwordx4 v15, s[8:11], s46 offen offset:2048 nt lds
v_add_f32 v19, v19, v88
v_exp_f32 v90, v90
v_mfma_f32_32x32x16_bf16 a[48:63], a[236:239], v[96:99], a[48:63]
v_add_f32 v19, v19, v89
v_cvt_pk_bf16_f32 v108, v88, v89
v_exp_f32 v91, v91
v_mfma_f32_32x32x16_bf16 a[0:15], a[240:243], v[100:103], a[0:15]
v_add_f32 v19, v19, v90
v_exp_f32 v92, v92
v_add_f32 v19, v19, v91
v_mfma_f32_32x32x16_bf16 a[16:31], a[244:247], v[100:103], a[16:31]
v_cvt_pk_bf16_f32 v109, v90, v91
v_exp_f32 v93, v93
v_add_f32 v19, v19, v92
v_mfma_f32_32x32x16_bf16 a[32:47], a[248:251], v[100:103], a[32:47]
v_exp_f32 v94, v94
v_add_f32 v19, v19, v93
v_cvt_pk_bf16_f32 v110, v92, v93
v_mfma_f32_32x32x16_bf16 a[48:63], a[252:255], v[100:103], a[48:63]
v_exp_f32 v95, v95
v_add_f32 v19, v19, v94
v_add_f32 v19, v19, v95
v_cvt_pk_bf16_f32 v111, v94, v95
s_waitcnt lgkmcnt(0)
v_mfma_f32_32x32x16_bf16 v[80:95], a[192:195], v[160:163], v[112:127]
s_add_u32 m0, s28, 24576
v_exp_f32 v64, v64
v_exp_f32 v65, v65
v_mfma_f32_32x32x16_bf16 v[80:95], a[196:199], v[164:167], v[80:95]
s_waitcnt vmcnt(5)
buffer_load_dwordx4 v16, s[8:11], s46 offen offset:3072 nt lds
s_add_u32 s54, s54, 8192
s_and_b32 s54, s54, 0x1ffff
v_mfma_f32_32x32x16_bf16 v[80:95], a[200:203], v[168:171], v[80:95]
v_add_f32 v20, v20, v64
v_exp_f32 v66, v66
v_add_f32 v20, v20, v65
v_mfma_f32_32x32x16_bf16 v[80:95], a[204:207], v[172:175], v[80:95]
v_cvt_pk_bf16_f32 v96, v64, v65
v_exp_f32 v67, v67
v_add_f32 v20, v20, v66
v_mfma_f32_32x32x16_bf16 v[80:95], a[208:211], v[176:179], v[80:95]
v_exp_f32 v68, v68
v_add_f32 v20, v20, v67
v_cvt_pk_bf16_f32 v97, v66, v67
v_mfma_f32_32x32x16_bf16 v[80:95], a[212:215], v[180:183], v[80:95]
v_exp_f32 v69, v69
v_add_f32 v20, v20, v68
v_exp_f32 v70, v70
v_mfma_f32_32x32x16_bf16 v[80:95], a[216:219], v[184:187], v[80:95]
s_add_u32 m0, s28, 49152
s_add_u32 s47, s29, s55
v_add_f32 v20, v20, v69
v_cvt_pk_bf16_f32 v98, v68, v69
v_mfma_f32_32x32x16_bf16 v[80:95], a[220:223], v[188:191], v[80:95]
s_waitcnt vmcnt(5)
buffer_load_dwordx4 v17, s[12:15], s47 offen offset:0 nt lds
v_exp_f32 v71, v71
v_mfma_f32_32x32x16_bf16 a[64:79], a[224:227], v[104:107], a[64:79]
v_add_f32 v20, v20, v70
v_exp_f32 v72, v72
v_add_f32 v20, v20, v71
v_mfma_f32_32x32x16_bf16 a[80:95], a[228:231], v[104:107], a[80:95]
v_cvt_pk_bf16_f32 v99, v70, v71
v_exp_f32 v73, v73
v_add_f32 v20, v20, v72
v_mfma_f32_32x32x16_bf16 a[96:111], a[232:235], v[104:107], a[96:111]
v_exp_f32 v74, v74
v_add_f32 v20, v20, v73
v_cvt_pk_bf16_f32 v100, v72, v73
v_mfma_f32_32x32x16_bf16 a[112:127], a[236:239], v[104:107], a[112:127]
v_exp_f32 v75, v75
v_add_f32 v20, v20, v74
v_exp_f32 v76, v76
v_mfma_f32_32x32x16_bf16 a[64:79], a[240:243], v[108:111], a[64:79]
v_add_f32 v20, v20, v75
v_cvt_pk_bf16_f32 v101, v74, v75
v_exp_f32 v77, v77
v_mfma_f32_32x32x16_bf16 a[80:95], a[244:247], v[108:111], a[80:95]
s_add_u32 m0, s28, 49152
v_add_f32 v20, v20, v76
v_exp_f32 v78, v78
v_add_f32 v20, v20, v77
v_mfma_f32_32x32x16_bf16 a[96:111], a[248:251], v[108:111], a[96:111]
s_waitcnt vmcnt(5)
buffer_load_dwordx4 v17, s[12:15], s47 offen offset:1024 nt lds
v_cvt_pk_bf16_f32 v102, v76, v77
v_mfma_f32_32x32x16_bf16 a[112:127], a[252:255], v[108:111], a[112:127]
v_exp_f32 v79, v79
v_add_f32 v20, v20, v78
v_add_f32 v20, v20, v79
v_cvt_pk_bf16_f32 v103, v78, v79
v_mfma_f32_32x32x16_bf16 v[64:79], a[192:195], v[192:195], v[128:143]
s_barrier
v_exp_f32 v80, v80
v_exp_f32 v81, v81
v_mfma_f32_32x32x16_bf16 v[64:79], a[196:199], v[196:199], v[64:79]
v_add_f32 v18, v18, v80
v_exp_f32 v82, v82
v_add_f32 v18, v18, v81
v_mfma_f32_32x32x16_bf16 v[64:79], a[200:203], v[200:203], v[64:79]
v_cvt_pk_bf16_f32 v104, v80, v81
v_exp_f32 v83, v83
v_add_f32 v18, v18, v82
v_exp_f32 v84, v84
v_mfma_f32_32x32x16_bf16 v[64:79], a[204:207], v[204:207], v[64:79]
s_add_u32 m0, s28, 49152
v_add_f32 v18, v18, v83
v_cvt_pk_bf16_f32 v105, v82, v83
v_exp_f32 v85, v85
v_mfma_f32_32x32x16_bf16 v[64:79], a[208:211], v[208:211], v[64:79]
s_waitcnt vmcnt(5)
buffer_load_dwordx4 v17, s[12:15], s47 offen offset:2048 nt lds
v_add_f32 v18, v18, v84
v_exp_f32 v86, v86
v_mfma_f32_32x32x16_bf16 v[64:79], a[212:215], v[212:215], v[64:79]
v_add_f32 v18, v18, v85
v_cvt_pk_bf16_f32 v106, v84, v85
v_exp_f32 v87, v87
v_add_f32 v18, v18, v86
v_mfma_f32_32x32x16_bf16 v[64:79], a[216:219], v[216:219], v[64:79]
v_exp_f32 v88, v88
v_add_f32 v18, v18, v87
v_cvt_pk_bf16_f32 v107, v86, v87
v_mfma_f32_32x32x16_bf16 v[64:79], a[220:223], v[220:223], v[64:79]
v_exp_f32 v89, v89
v_add_f32 v18, v18, v88
v_exp_f32 v90, v90
v_add_f32 v18, v18, v89
v_mfma_f32_32x32x16_bf16 a[128:143], a[224:227], v[96:99], a[128:143]
ds_read_b64_tr_b16 a[224:225], v9 offset:8192
ds_read_b64_tr_b16 a[226:227], v9 offset:10240
v_cvt_pk_bf16_f32 v108, v88, v89
v_exp_f32 v91, v91
v_mfma_f32_32x32x16_bf16 a[144:159], a[228:231], v[96:99], a[144:159]
ds_read_b64_tr_b16 a[228:229], v10 offset:8192
ds_read_b64_tr_b16 a[230:231], v10 offset:10240
v_add_f32 v18, v18, v90
v_exp_f32 v92, v92
v_mfma_f32_32x32x16_bf16 a[160:175], a[232:235], v[96:99], a[160:175]
ds_read_b64_tr_b16 a[232:233], v11 offset:8192
ds_read_b64_tr_b16 a[234:235], v11 offset:10240
s_add_u32 m0, s28, 49152
v_add_f32 v18, v18, v91
v_cvt_pk_bf16_f32 v109, v90, v91
v_mfma_f32_32x32x16_bf16 a[176:191], a[236:239], v[96:99], a[176:191]
ds_read_b64_tr_b16 a[236:237], v12 offset:8192
ds_read_b64_tr_b16 a[238:239], v12 offset:10240
s_waitcnt vmcnt(5)
buffer_load_dwordx4 v17, s[12:15], s47 offen offset:3072 nt lds
s_add_u32 s55, s55, 8192
s_and_b32 s55, s55, 0x1ffff
v_mfma_f32_32x32x16_bf16 a[128:143], a[240:243], v[100:103], a[128:143]
ds_read_b64_tr_b16 a[240:241], v9 offset:12288
ds_read_b64_tr_b16 a[242:243], v9 offset:14336
v_exp_f32 v93, v93
v_add_f32 v18, v18, v92
v_mfma_f32_32x32x16_bf16 a[144:159], a[244:247], v[100:103], a[144:159]
ds_read_b64_tr_b16 a[244:245], v10 offset:12288
ds_read_b64_tr_b16 a[246:247], v10 offset:14336
v_exp_f32 v94, v94
v_add_f32 v18, v18, v93
v_mfma_f32_32x32x16_bf16 a[160:175], a[248:251], v[100:103], a[160:175]
ds_read_b64_tr_b16 a[248:249], v11 offset:12288
ds_read_b64_tr_b16 a[250:251], v11 offset:14336
v_cvt_pk_bf16_f32 v110, v92, v93
v_exp_f32 v95, v95
v_mfma_f32_32x32x16_bf16 a[176:191], a[252:255], v[100:103], a[176:191]
ds_read_b64_tr_b16 a[252:253], v12 offset:12288
ds_read_b64_tr_b16 a[254:255], v12 offset:14336
v_add_f32 v18, v18, v94
v_add_f32 v18, v18, v95
v_cvt_pk_bf16_f32 v111, v94, v95
v_mfma_f32_32x32x16_bf16 v[80:95], a[192:195], v[224:227], v[144:159]
ds_read_b128 a[192:195], v1 offset:16384
v_exp_f32 v64, v64
v_exp_f32 v65, v65
v_mfma_f32_32x32x16_bf16 v[80:95], a[196:199], v[228:231], v[80:95]
ds_read_b128 a[196:199], v2 offset:16384
s_add_u32 m0, s28, 57344
s_add_u32 s47, s29, s55
v_add_f32 v19, v19, v64
v_mfma_f32_32x32x16_bf16 v[80:95], a[200:203], v[232:235], v[80:95]
ds_read_b128 a[200:203], v3 offset:16384
s_waitcnt vmcnt(5)
buffer_load_dwordx4 v17, s[12:15], s47 offen offset:0 nt lds
v_exp_f32 v66, v66
v_mfma_f32_32x32x16_bf16 v[80:95], a[204:207], v[236:239], v[80:95]
ds_read_b128 a[204:207], v4 offset:16384
v_add_f32 v19, v19, v65
v_cvt_pk_bf16_f32 v96, v64, v65
v_exp_f32 v67, v67
v_mfma_f32_32x32x16_bf16 v[80:95], a[208:211], v[240:243], v[80:95]
ds_read_b128 a[208:211], v5 offset:16384
v_add_f32 v19, v19, v66
v_exp_f32 v68, v68
v_mfma_f32_32x32x16_bf16 v[80:95], a[212:215], v[244:247], v[80:95]
ds_read_b128 a[212:215], v6 offset:16384
v_add_f32 v19, v19, v67
v_cvt_pk_bf16_f32 v97, v66, v67
v_exp_f32 v69, v69
v_mfma_f32_32x32x16_bf16 v[80:95], a[216:219], v[248:251], v[80:95]
ds_read_b128 a[216:219], v7 offset:16384
v_add_f32 v19, v19, v68
v_exp_f32 v70, v70
v_mfma_f32_32x32x16_bf16 v[80:95], a[220:223], v[252:255], v[80:95]
ds_read_b128 a[220:223], v8 offset:16384
s_add_u32 m0, s28, 57344
v_add_f32 v19, v19, v69
v_cvt_pk_bf16_f32 v98, v68, v69
v_exp_f32 v71, v71
s_waitcnt lgkmcnt(8)
v_mfma_f32_32x32x16_bf16 a[0:15], a[224:227], v[104:107], a[0:15]
s_waitcnt vmcnt(5)
buffer_load_dwordx4 v17, s[12:15], s47 offen offset:1024 nt lds
v_add_f32 v19, v19, v70
v_mfma_f32_32x32x16_bf16 a[16:31], a[228:231], v[104:107], a[16:31]
v_exp_f32 v72, v72
v_add_f32 v19, v19, v71
v_cvt_pk_bf16_f32 v99, v70, v71
v_exp_f32 v73, v73
v_mfma_f32_32x32x16_bf16 a[32:47], a[232:235], v[104:107], a[32:47]
v_add_f32 v19, v19, v72
v_exp_f32 v74, v74
v_add_f32 v19, v19, v73
v_mfma_f32_32x32x16_bf16 a[48:63], a[236:239], v[104:107], a[48:63]
v_cvt_pk_bf16_f32 v100, v72, v73
v_exp_f32 v75, v75
v_add_f32 v19, v19, v74
v_mfma_f32_32x32x16_bf16 a[0:15], a[240:243], v[108:111], a[0:15]
v_exp_f32 v76, v76
v_add_f32 v19, v19, v75
v_cvt_pk_bf16_f32 v101, v74, v75
v_exp_f32 v77, v77
v_mfma_f32_32x32x16_bf16 a[16:31], a[244:247], v[108:111], a[16:31]
v_add_f32 v19, v19, v76
v_exp_f32 v78, v78
v_add_f32 v19, v19, v77
v_mfma_f32_32x32x16_bf16 a[32:47], a[248:251], v[108:111], a[32:47]
s_add_u32 m0, s28, 57344
v_cvt_pk_bf16_f32 v102, v76, v77
v_exp_f32 v79, v79
v_mfma_f32_32x32x16_bf16 a[48:63], a[252:255], v[108:111], a[48:63]
s_waitcnt vmcnt(5)
buffer_load_dwordx4 v17, s[12:15], s47 offen offset:2048 nt lds
v_add_f32 v19, v19, v78
v_add_f32 v19, v19, v79
v_cvt_pk_bf16_f32 v103, v78, v79
s_waitcnt lgkmcnt(0)
v_mfma_f32_32x32x16_bf16 v[64:79], a[192:195], v[160:163], v[112:127]
v_exp_f32 v80, v80
v_exp_f32 v81, v81
v_mfma_f32_32x32x16_bf16 v[64:79], a[196:199], v[164:167], v[64:79]
v_add_f32 v20, v20, v80
v_exp_f32 v82, v82
v_add_f32 v20, v20, v81
v_mfma_f32_32x32x16_bf16 v[64:79], a[200:203], v[168:171], v[64:79]
v_cvt_pk_bf16_f32 v104, v80, v81
v_exp_f32 v83, v83
v_mfma_f32_32x32x16_bf16 v[64:79], a[204:207], v[172:175], v[64:79]
v_add_f32 v20, v20, v82
v_exp_f32 v84, v84
v_add_f32 v20, v20, v83
v_mfma_f32_32x32x16_bf16 v[64:79], a[208:211], v[176:179], v[64:79]
v_cvt_pk_bf16_f32 v105, v82, v83
v_exp_f32 v85, v85
v_add_f32 v20, v20, v84
v_mfma_f32_32x32x16_bf16 v[64:79], a[212:215], v[180:183], v[64:79]
s_add_u32 m0, s28, 57344
v_exp_f32 v86, v86
v_add_f32 v20, v20, v85
v_mfma_f32_32x32x16_bf16 v[64:79], a[216:219], v[184:187], v[64:79]
s_waitcnt vmcnt(5)
buffer_load_dwordx4 v17, s[12:15], s47 offen offset:3072 nt lds
s_add_u32 s55, s55, 8192
s_and_b32 s55, s55, 0x1ffff
v_mfma_f32_32x32x16_bf16 v[64:79], a[220:223], v[188:191], v[64:79]
v_cvt_pk_bf16_f32 v106, v84, v85
v_exp_f32 v87, v87
v_add_f32 v20, v20, v86
v_mfma_f32_32x32x16_bf16 a[64:79], a[224:227], v[96:99], a[64:79]
v_exp_f32 v88, v88
v_add_f32 v20, v20, v87
v_mfma_f32_32x32x16_bf16 a[80:95], a[228:231], v[96:99], a[80:95]
v_cvt_pk_bf16_f32 v107, v86, v87
v_exp_f32 v89, v89
v_add_f32 v20, v20, v88
v_mfma_f32_32x32x16_bf16 a[96:111], a[232:235], v[96:99], a[96:111]
v_exp_f32 v90, v90
v_add_f32 v20, v20, v89
v_cvt_pk_bf16_f32 v108, v88, v89
v_mfma_f32_32x32x16_bf16 a[112:127], a[236:239], v[96:99], a[112:127]
v_exp_f32 v91, v91
v_add_f32 v20, v20, v90
v_mfma_f32_32x32x16_bf16 a[64:79], a[240:243], v[100:103], a[64:79]
v_exp_f32 v92, v92
v_add_f32 v20, v20, v91
v_cvt_pk_bf16_f32 v109, v90, v91
v_mfma_f32_32x32x16_bf16 a[80:95], a[244:247], v[100:103], a[80:95]
v_exp_f32 v93, v93
v_add_f32 v20, v20, v92
v_exp_f32 v94, v94
v_mfma_f32_32x32x16_bf16 a[96:111], a[248:251], v[100:103], a[96:111]
v_add_f32 v20, v20, v93
v_cvt_pk_bf16_f32 v110, v92, v93
v_exp_f32 v95, v95
v_mfma_f32_32x32x16_bf16 a[112:127], a[252:255], v[100:103], a[112:127]
v_add_f32 v20, v20, v94
v_add_f32 v20, v20, v95
v_cvt_pk_bf16_f32 v111, v94, v95
v_mfma_f32_32x32x16_bf16 v[80:95], a[192:195], v[192:195], v[128:143]
s_waitcnt vmcnt(4)
s_barrier
v_exp_f32 v64, v64
v_exp_f32 v65, v65
v_mfma_f32_32x32x16_bf16 v[80:95], a[196:199], v[196:199], v[80:95]
v_lshlrev_b32 v47, 7, v0
v_min_u32 v48, 7, v0
v_add_f32 v18, v18, v64
v_exp_f32 v66, v66
v_mfma_f32_32x32x16_bf16 v[80:95], a[200:203], v[200:203], v[80:95]
buffer_load_dword v63, v47, s[56:59], s86 offen
v_lshlrev_b32 v48, 7, v48
v_add_u32 v48, 8192, v48
v_add_f32 v18, v18, v65
v_mfma_f32_32x32x16_bf16 v[80:95], a[204:207], v[204:207], v[80:95]
v_cvt_pk_bf16_f32 v96, v64, v65
v_exp_f32 v67, v67
v_add_f32 v18, v18, v66
v_exp_f32 v68, v68
v_mfma_f32_32x32x16_bf16 v[80:95], a[208:211], v[208:211], v[80:95]
v_add_f32 v18, v18, v67
v_cvt_pk_bf16_f32 v97, v66, v67
v_exp_f32 v69, v69
v_mfma_f32_32x32x16_bf16 v[80:95], a[212:215], v[212:215], v[80:95]
buffer_load_dword v63, v48, s[56:59], s86 offen
v_add_f32 v18, v18, v68
v_exp_f32 v70, v70
v_add_f32 v18, v18, v69
v_mfma_f32_32x32x16_bf16 v[80:95], a[216:219], v[216:219], v[80:95]
v_cvt_pk_bf16_f32 v98, v68, v69
v_exp_f32 v71, v71
v_add_f32 v18, v18, v70
v_exp_f32 v72, v72
v_mfma_f32_32x32x16_bf16 v[80:95], a[220:223], v[220:223], v[80:95]
v_add_f32 v18, v18, v71
v_cvt_pk_bf16_f32 v99, v70, v71
v_exp_f32 v73, v73
v_mfma_f32_32x32x16_bf16 a[128:143], a[224:227], v[104:107], a[128:143]
ds_read_b64_tr_b16 a[224:225], v9 offset:16384
ds_read_b64_tr_b16 a[226:227], v9 offset:18432
v_add_f32 v18, v18, v72
v_exp_f32 v74, v74
v_mfma_f32_32x32x16_bf16 a[144:159], a[228:231], v[104:107], a[144:159]
ds_read_b64_tr_b16 a[228:229], v10 offset:16384
ds_read_b64_tr_b16 a[230:231], v10 offset:18432
v_add_f32 v18, v18, v73
v_cvt_pk_bf16_f32 v100, v72, v73
v_exp_f32 v75, v75
v_mfma_f32_32x32x16_bf16 a[160:175], a[232:235], v[104:107], a[160:175]
ds_read_b64_tr_b16 a[232:233], v11 offset:16384
ds_read_b64_tr_b16 a[234:235], v11 offset:18432
v_add_f32 v18, v18, v74
v_exp_f32 v76, v76
v_mfma_f32_32x32x16_bf16 a[176:191], a[236:239], v[104:107], a[176:191]
ds_read_b64_tr_b16 a[236:237], v12 offset:16384
ds_read_b64_tr_b16 a[238:239], v12 offset:18432
v_add_f32 v18, v18, v75
v_cvt_pk_bf16_f32 v101, v74, v75
v_mfma_f32_32x32x16_bf16 a[128:143], a[240:243], v[108:111], a[128:143]
ds_read_b64_tr_b16 a[240:241], v9 offset:20480
ds_read_b64_tr_b16 a[242:243], v9 offset:22528
v_exp_f32 v77, v77
v_add_f32 v18, v18, v76
v_mfma_f32_32x32x16_bf16 a[144:159], a[244:247], v[108:111], a[144:159]
ds_read_b64_tr_b16 a[244:245], v10 offset:20480
ds_read_b64_tr_b16 a[246:247], v10 offset:22528
v_exp_f32 v78, v78
v_add_f32 v18, v18, v77
v_mfma_f32_32x32x16_bf16 a[160:175], a[248:251], v[108:111], a[160:175]
ds_read_b64_tr_b16 a[248:249], v11 offset:20480
ds_read_b64_tr_b16 a[250:251], v11 offset:22528
v_cvt_pk_bf16_f32 v102, v76, v77
v_exp_f32 v79, v79
v_mfma_f32_32x32x16_bf16 a[176:191], a[252:255], v[108:111], a[176:191]
ds_read_b64_tr_b16 a[252:253], v12 offset:20480
ds_read_b64_tr_b16 a[254:255], v12 offset:22528
v_add_f32 v18, v18, v78
v_add_f32 v18, v18, v79
v_cvt_pk_bf16_f32 v103, v78, v79
v_mfma_f32_32x32x16_bf16 v[64:79], a[192:195], v[224:227], v[144:159]
ds_read_b128 a[192:195], v1 offset:24576
v_exp_f32 v80, v80
v_exp_f32 v81, v81
v_mfma_f32_32x32x16_bf16 v[64:79], a[196:199], v[228:231], v[64:79]
ds_read_b128 a[196:199], v2 offset:24576
v_add_f32 v19, v19, v80
v_exp_f32 v82, v82
v_mfma_f32_32x32x16_bf16 v[64:79], a[200:203], v[232:235], v[64:79]
ds_read_b128 a[200:203], v3 offset:24576
v_add_f32 v19, v19, v81
v_cvt_pk_bf16_f32 v104, v80, v81
v_mfma_f32_32x32x16_bf16 v[64:79], a[204:207], v[236:239], v[64:79]
ds_read_b128 a[204:207], v4 offset:24576
v_exp_f32 v83, v83
v_add_f32 v19, v19, v82
v_mfma_f32_32x32x16_bf16 v[64:79], a[208:211], v[240:243], v[64:79]
ds_read_b128 a[208:211], v5 offset:24576
v_exp_f32 v84, v84
v_add_f32 v19, v19, v83
v_mfma_f32_32x32x16_bf16 v[64:79], a[212:215], v[244:247], v[64:79]
ds_read_b128 a[212:215], v6 offset:24576
v_cvt_pk_bf16_f32 v105, v82, v83
v_exp_f32 v85, v85
v_mfma_f32_32x32x16_bf16 v[64:79], a[216:219], v[248:251], v[64:79]
ds_read_b128 a[216:219], v7 offset:24576
v_add_f32 v19, v19, v84
v_exp_f32 v86, v86
v_mfma_f32_32x32x16_bf16 v[64:79], a[220:223], v[252:255], v[64:79]
ds_read_b128 a[220:223], v8 offset:24576
v_add_f32 v19, v19, v85
v_cvt_pk_bf16_f32 v106, v84, v85
v_exp_f32 v87, v87
s_waitcnt lgkmcnt(8)
v_mfma_f32_32x32x16_bf16 a[0:15], a[224:227], v[96:99], a[0:15]
v_add_f32 v19, v19, v86
v_exp_f32 v88, v88
v_mfma_f32_32x32x16_bf16 a[16:31], a[228:231], v[96:99], a[16:31]
v_add_f32 v19, v19, v87
v_cvt_pk_bf16_f32 v107, v86, v87
v_exp_f32 v89, v89
v_mfma_f32_32x32x16_bf16 a[32:47], a[232:235], v[96:99], a[32:47]
v_add_f32 v19, v19, v88
v_exp_f32 v90, v90
v_add_f32 v19, v19, v89
v_mfma_f32_32x32x16_bf16 a[48:63], a[236:239], v[96:99], a[48:63]
v_cvt_pk_bf16_f32 v108, v88, v89
v_exp_f32 v91, v91
v_add_f32 v19, v19, v90
v_mfma_f32_32x32x16_bf16 a[0:15], a[240:243], v[100:103], a[0:15]
v_exp_f32 v92, v92
v_add_f32 v19, v19, v91
v_cvt_pk_bf16_f32 v109, v90, v91
v_mfma_f32_32x32x16_bf16 a[16:31], a[244:247], v[100:103], a[16:31]
v_exp_f32 v93, v93
v_add_f32 v19, v19, v92
v_exp_f32 v94, v94
v_mfma_f32_32x32x16_bf16 a[32:47], a[248:251], v[100:103], a[32:47]
v_add_f32 v19, v19, v93
v_cvt_pk_bf16_f32 v110, v92, v93
v_exp_f32 v95, v95
v_mfma_f32_32x32x16_bf16 a[48:63], a[252:255], v[100:103], a[48:63]
v_add_f32 v19, v19, v94
v_add_f32 v19, v19, v95
v_cvt_pk_bf16_f32 v111, v94, v95
s_waitcnt lgkmcnt(0)
v_mfma_f32_32x32x16_bf16 v[80:95], a[192:195], v[160:163], v[112:127]
v_exp_f32 v64, v64
v_exp_f32 v65, v65
v_mfma_f32_32x32x16_bf16 v[80:95], a[196:199], v[164:167], v[80:95]
v_add_f32 v20, v20, v64
v_exp_f32 v66, v66
v_mfma_f32_32x32x16_bf16 v[80:95], a[200:203], v[168:171], v[80:95]
v_add_f32 v20, v20, v65
v_cvt_pk_bf16_f32 v96, v64, v65
v_exp_f32 v67, v67
v_mfma_f32_32x32x16_bf16 v[80:95], a[204:207], v[172:175], v[80:95]
v_add_f32 v20, v20, v66
v_exp_f32 v68, v68
v_mfma_f32_32x32x16_bf16 v[80:95], a[208:211], v[176:179], v[80:95]
v_add_f32 v20, v20, v67
v_cvt_pk_bf16_f32 v97, v66, v67
v_exp_f32 v69, v69
v_mfma_f32_32x32x16_bf16 v[80:95], a[212:215], v[180:183], v[80:95]
v_add_f32 v20, v20, v68
v_exp_f32 v70, v70
v_mfma_f32_32x32x16_bf16 v[80:95], a[216:219], v[184:187], v[80:95]
v_add_f32 v20, v20, v69
v_cvt_pk_bf16_f32 v98, v68, v69
v_exp_f32 v71, v71
v_mfma_f32_32x32x16_bf16 v[80:95], a[220:223], v[188:191], v[80:95]
v_add_f32 v20, v20, v70
v_exp_f32 v72, v72
v_mfma_f32_32x32x16_bf16 a[64:79], a[224:227], v[104:107], a[64:79]
v_add_f32 v20, v20, v71
v_cvt_pk_bf16_f32 v99, v70, v71
v_exp_f32 v73, v73
v_mfma_f32_32x32x16_bf16 a[80:95], a[228:231], v[104:107], a[80:95]
v_add_f32 v20, v20, v72
v_exp_f32 v74, v74
v_mfma_f32_32x32x16_bf16 a[96:111], a[232:235], v[104:107], a[96:111]
v_add_f32 v20, v20, v73
v_cvt_pk_bf16_f32 v100, v72, v73
v_exp_f32 v75, v75
v_mfma_f32_32x32x16_bf16 a[112:127], a[236:239], v[104:107], a[112:127]
v_add_f32 v20, v20, v74
v_exp_f32 v76, v76
v_mfma_f32_32x32x16_bf16 a[64:79], a[240:243], v[108:111], a[64:79]
v_add_f32 v20, v20, v75
v_cvt_pk_bf16_f32 v101, v74, v75
v_exp_f32 v77, v77
v_mfma_f32_32x32x16_bf16 a[80:95], a[244:247], v[108:111], a[80:95]
v_add_f32 v20, v20, v76
v_exp_f32 v78, v78
v_mfma_f32_32x32x16_bf16 a[96:111], a[248:251], v[108:111], a[96:111]
v_add_f32 v20, v20, v77
v_cvt_pk_bf16_f32 v102, v76, v77
v_exp_f32 v79, v79
v_mfma_f32_32x32x16_bf16 a[112:127], a[252:255], v[108:111], a[112:127]
v_add_f32 v20, v20, v78
v_add_f32 v20, v20, v79
v_cvt_pk_bf16_f32 v103, v78, v79
v_mfma_f32_32x32x16_bf16 v[64:79], a[192:195], v[192:195], v[128:143]
s_waitcnt vmcnt(2)
s_barrier
v_exp_f32 v80, v80
v_mfma_f32_32x32x16_bf16 v[64:79], a[196:199], v[196:199], v[64:79]
v_exp_f32 v81, v81
v_add_f32 v18, v18, v80
v_exp_f32 v82, v82
v_mfma_f32_32x32x16_bf16 v[64:79], a[200:203], v[200:203], v[64:79]
v_add_f32 v18, v18, v81
v_cvt_pk_bf16_f32 v104, v80, v81
v_exp_f32 v83, v83
v_add_f32 v18, v18, v82
v_mfma_f32_32x32x16_bf16 v[64:79], a[204:207], v[204:207], v[64:79]
v_exp_f32 v84, v84
v_add_f32 v18, v18, v83
v_cvt_pk_bf16_f32 v105, v82, v83
v_mfma_f32_32x32x16_bf16 v[64:79], a[208:211], v[208:211], v[64:79]
v_exp_f32 v85, v85
v_add_f32 v18, v18, v84
v_exp_f32 v86, v86
v_mfma_f32_32x32x16_bf16 v[64:79], a[212:215], v[212:215], v[64:79]
v_add_f32 v18, v18, v85
v_cvt_pk_bf16_f32 v106, v84, v85
v_exp_f32 v87, v87
v_add_f32 v18, v18, v86
v_mfma_f32_32x32x16_bf16 v[64:79], a[216:219], v[216:219], v[64:79]
v_exp_f32 v88, v88
v_add_f32 v18, v18, v87
v_cvt_pk_bf16_f32 v107, v86, v87
v_mfma_f32_32x32x16_bf16 v[64:79], a[220:223], v[220:223], v[64:79]
v_exp_f32 v89, v89
v_add_f32 v18, v18, v88
v_exp_f32 v90, v90
v_mfma_f32_32x32x16_bf16 a[128:143], a[224:227], v[96:99], a[128:143]
ds_read_b64_tr_b16 a[224:225], v9 offset:24576
ds_read_b64_tr_b16 a[226:227], v9 offset:26624
v_add_f32 v18, v18, v89
v_cvt_pk_bf16_f32 v108, v88, v89
v_mfma_f32_32x32x16_bf16 a[144:159], a[228:231], v[96:99], a[144:159]
ds_read_b64_tr_b16 a[228:229], v10 offset:24576
ds_read_b64_tr_b16 a[230:231], v10 offset:26624
v_exp_f32 v91, v91
v_add_f32 v18, v18, v90
v_mfma_f32_32x32x16_bf16 a[160:175], a[232:235], v[96:99], a[160:175]
ds_read_b64_tr_b16 a[232:233], v11 offset:24576
ds_read_b64_tr_b16 a[234:235], v11 offset:26624
v_exp_f32 v92, v92
v_add_f32 v18, v18, v91
v_mfma_f32_32x32x16_bf16 a[176:191], a[236:239], v[96:99], a[176:191]
ds_read_b64_tr_b16 a[236:237], v12 offset:24576
ds_read_b64_tr_b16 a[238:239], v12 offset:26624
v_cvt_pk_bf16_f32 v109, v90, v91
v_exp_f32 v93, v93
v_mfma_f32_32x32x16_bf16 a[128:143], a[240:243], v[100:103], a[128:143]
ds_read_b64_tr_b16 a[240:241], v9 offset:28672
ds_read_b64_tr_b16 a[242:243], v9 offset:30720
v_add_f32 v18, v18, v92
v_exp_f32 v94, v94
v_mfma_f32_32x32x16_bf16 a[144:159], a[244:247], v[100:103], a[144:159]
ds_read_b64_tr_b16 a[244:245], v10 offset:28672
ds_read_b64_tr_b16 a[246:247], v10 offset:30720
v_add_f32 v18, v18, v93
v_cvt_pk_bf16_f32 v110, v92, v93
v_mfma_f32_32x32x16_bf16 a[160:175], a[248:251], v[100:103], a[160:175]
ds_read_b64_tr_b16 a[248:249], v11 offset:28672
ds_read_b64_tr_b16 a[250:251], v11 offset:30720
v_exp_f32 v95, v95
v_mfma_f32_32x32x16_bf16 a[176:191], a[252:255], v[100:103], a[176:191]
ds_read_b64_tr_b16 a[252:253], v12 offset:28672
ds_read_b64_tr_b16 a[254:255], v12 offset:30720
v_add_f32 v18, v18, v94
v_add_f32 v18, v18, v95
v_cvt_pk_bf16_f32 v111, v94, v95
v_mfma_f32_32x32x16_bf16 v[80:95], a[192:195], v[224:227], v[144:159]
v_exp_f32 v64, v64
v_exp_f32 v65, v65
v_mfma_f32_32x32x16_bf16 v[80:95], a[196:199], v[228:231], v[80:95]
v_add_f32 v19, v19, v64
v_exp_f32 v66, v66
v_mfma_f32_32x32x16_bf16 v[80:95], a[200:203], v[232:235], v[80:95]
v_add_f32 v19, v19, v65
v_cvt_pk_bf16_f32 v96, v64, v65
v_exp_f32 v67, v67
v_mfma_f32_32x32x16_bf16 v[80:95], a[204:207], v[236:239], v[80:95]
v_add_f32 v19, v19, v66
v_exp_f32 v68, v68
v_mfma_f32_32x32x16_bf16 v[80:95], a[208:211], v[240:243], v[80:95]
v_add_f32 v19, v19, v67
v_cvt_pk_bf16_f32 v97, v66, v67
v_exp_f32 v69, v69
v_mfma_f32_32x32x16_bf16 v[80:95], a[212:215], v[244:247], v[80:95]
v_add_f32 v19, v19, v68
v_exp_f32 v70, v70
v_mfma_f32_32x32x16_bf16 v[80:95], a[216:219], v[248:251], v[80:95]
v_add_f32 v19, v19, v69
v_cvt_pk_bf16_f32 v98, v68, v69
v_exp_f32 v71, v71
v_mfma_f32_32x32x16_bf16 v[80:95], a[220:223], v[252:255], v[80:95]
v_add_f32 v19, v19, v70
v_exp_f32 v72, v72
s_waitcnt lgkmcnt(0)
v_mfma_f32_32x32x16_bf16 a[0:15], a[224:227], v[104:107], a[0:15]
v_add_f32 v19, v19, v71
v_cvt_pk_bf16_f32 v99, v70, v71
v_exp_f32 v73, v73
v_mfma_f32_32x32x16_bf16 a[16:31], a[228:231], v[104:107], a[16:31]
v_add_f32 v19, v19, v72
v_exp_f32 v74, v74
v_mfma_f32_32x32x16_bf16 a[32:47], a[232:235], v[104:107], a[32:47]
v_add_f32 v19, v19, v73
v_cvt_pk_bf16_f32 v100, v72, v73
v_exp_f32 v75, v75
v_mfma_f32_32x32x16_bf16 a[48:63], a[236:239], v[104:107], a[48:63]
v_add_f32 v19, v19, v74
v_exp_f32 v76, v76
v_mfma_f32_32x32x16_bf16 a[0:15], a[240:243], v[108:111], a[0:15]
v_add_f32 v19, v19, v75
v_cvt_pk_bf16_f32 v101, v74, v75
v_exp_f32 v77, v77
v_mfma_f32_32x32x16_bf16 a[16:31], a[244:247], v[108:111], a[16:31]
v_add_f32 v19, v19, v76
v_exp_f32 v78, v78
v_mfma_f32_32x32x16_bf16 a[32:47], a[248:251], v[108:111], a[32:47]
v_add_f32 v19, v19, v77
v_cvt_pk_bf16_f32 v102, v76, v77
v_exp_f32 v79, v79
v_mfma_f32_32x32x16_bf16 a[48:63], a[252:255], v[108:111], a[48:63]
v_add_f32 v19, v19, v78
v_add_f32 v19, v19, v79
v_cvt_pk_bf16_f32 v103, v78, v79
v_mfma_f32_32x32x16_bf16 a[64:79], a[224:227], v[96:99], a[64:79]
v_exp_f32 v80, v80
v_exp_f32 v81, v81
v_add_f32 v20, v20, v80
v_exp_f32 v82, v82
v_mfma_f32_32x32x16_bf16 a[80:95], a[228:231], v[96:99], a[80:95]
v_add_f32 v20, v20, v81
v_cvt_pk_bf16_f32 v104, v80, v81
v_exp_f32 v83, v83
v_add_f32 v20, v20, v82
v_exp_f32 v84, v84
v_mfma_f32_32x32x16_bf16 a[96:111], a[232:235], v[96:99], a[96:111]
v_add_f32 v20, v20, v83
v_cvt_pk_bf16_f32 v105, v82, v83
v_exp_f32 v85, v85
v_add_f32 v20, v20, v84
v_exp_f32 v86, v86
v_mfma_f32_32x32x16_bf16 a[112:127], a[236:239], v[96:99], a[112:127]
v_add_f32 v20, v20, v85
v_cvt_pk_bf16_f32 v106, v84, v85
v_exp_f32 v87, v87
v_add_f32 v20, v20, v86
v_exp_f32 v88, v88
v_mfma_f32_32x32x16_bf16 a[64:79], a[240:243], v[100:103], a[64:79]
v_add_f32 v20, v20, v87
v_cvt_pk_bf16_f32 v107, v86, v87
v_exp_f32 v89, v89
v_add_f32 v20, v20, v88
v_exp_f32 v90, v90
v_mfma_f32_32x32x16_bf16 a[80:95], a[244:247], v[100:103], a[80:95]
v_add_f32 v20, v20, v89
v_cvt_pk_bf16_f32 v108, v88, v89
v_exp_f32 v91, v91
v_add_f32 v20, v20, v90
v_exp_f32 v92, v92
v_mfma_f32_32x32x16_bf16 a[96:111], a[248:251], v[100:103], a[96:111]
v_add_f32 v20, v20, v91
v_cvt_pk_bf16_f32 v109, v90, v91
v_exp_f32 v93, v93
v_add_f32 v20, v20, v92
v_exp_f32 v94, v94
v_mfma_f32_32x32x16_bf16 a[112:127], a[252:255], v[100:103], a[112:127]
v_add_f32 v20, v20, v93
v_cvt_pk_bf16_f32 v110, v92, v93
v_exp_f32 v95, v95
v_add_f32 v20, v20, v94
v_add_f32 v20, v20, v95
v_cvt_pk_bf16_f32 v111, v94, v95
s_nop 1
v_mfma_f32_32x32x16_bf16 a[128:143], a[224:227], v[104:107], a[128:143]
v_mfma_f32_32x32x16_bf16 a[144:159], a[228:231], v[104:107], a[144:159]
v_mfma_f32_32x32x16_bf16 a[160:175], a[232:235], v[104:107], a[160:175]
v_mfma_f32_32x32x16_bf16 a[176:191], a[236:239], v[104:107], a[176:191]
v_mfma_f32_32x32x16_bf16 a[128:143], a[240:243], v[108:111], a[128:143]
v_mfma_f32_32x32x16_bf16 a[144:159], a[244:247], v[108:111], a[144:159]
v_mfma_f32_32x32x16_bf16 a[160:175], a[248:251], v[108:111], a[160:175]
v_mfma_f32_32x32x16_bf16 a[176:191], a[252:255], v[108:111], a[176:191]
v_mov_b32 v47, v18
v_mov_b32 v48, v19
v_mov_b32 v49, v20
s_nop 1
v_permlane32_swap_b32 v47, v18
v_permlane32_swap_b32 v48, v19
v_permlane32_swap_b32 v49, v20
s_nop 1
v_add_f32 v18, v18, v47
v_add_f32 v19, v19, v48
v_add_f32 v20, v20, v49
s_nop 7
v_rcp_f32 v49, v18
v_rcp_f32 v51, v19
v_rcp_f32 v53, v20
v_lshlrev_b32 v55, 4, v0
v_accvgpr_read_b32 v64, a0
v_accvgpr_read_b32 v65, a1
v_accvgpr_read_b32 v66, a2
v_accvgpr_read_b32 v67, a3
v_accvgpr_read_b32 v68, a4
v_accvgpr_read_b32 v69, a5
v_accvgpr_read_b32 v70, a6
v_accvgpr_read_b32 v71, a7
v_accvgpr_read_b32 v72, a8
v_accvgpr_read_b32 v73, a9
v_accvgpr_read_b32 v74, a10
v_accvgpr_read_b32 v75, a11
v_accvgpr_read_b32 v76, a12
v_accvgpr_read_b32 v77, a13
v_accvgpr_read_b32 v78, a14
v_accvgpr_read_b32 v79, a15
v_mul_f32 v64, v64, v49
v_mul_f32 v65, v65, v49
v_mul_f32 v66, v66, v49
v_mul_f32 v67, v67, v49
v_mul_f32 v68, v68, v49
v_mul_f32 v69, v69, v49
v_mul_f32 v70, v70, v49
v_mul_f32 v71, v71, v49
v_mul_f32 v72, v72, v49
v_mul_f32 v73, v73, v49
v_mul_f32 v74, v74, v49
v_mul_f32 v75, v75, v49
v_mul_f32 v76, v76, v49
v_mul_f32 v77, v77, v49
v_mul_f32 v78, v78, v49
v_mul_f32 v79, v79, v49
v_cvt_pk_bf16_f32 v80, v64, v65
v_cvt_pk_bf16_f32 v81, v66, v67
v_cvt_pk_bf16_f32 v82, v68, v69
v_cvt_pk_bf16_f32 v83, v70, v71
v_cvt_pk_bf16_f32 v84, v72, v73
v_cvt_pk_bf16_f32 v85, v74, v75
v_cvt_pk_bf16_f32 v86, v76, v77
v_cvt_pk_bf16_f32 v87, v78, v79
s_add_u32 s44, s30, 0
buffer_store_dwordx4 v[80:83], v55, s[24:27], s44 offen offset:0 sc1
buffer_store_dwordx4 v[84:87], v55, s[24:27], s44 offen offset:1024 sc1
v_accvgpr_read_b32 v96, a16
v_accvgpr_read_b32 v97, a17
v_accvgpr_read_b32 v98, a18
v_accvgpr_read_b32 v99, a19
v_accvgpr_read_b32 v100, a20
v_accvgpr_read_b32 v101, a21
v_accvgpr_read_b32 v102, a22
v_accvgpr_read_b32 v103, a23
v_accvgpr_read_b32 v104, a24
v_accvgpr_read_b32 v105, a25
v_accvgpr_read_b32 v106, a26
v_accvgpr_read_b32 v107, a27
v_accvgpr_read_b32 v108, a28
v_accvgpr_read_b32 v109, a29
v_accvgpr_read_b32 v110, a30
v_accvgpr_read_b32 v111, a31
v_mul_f32 v96, v96, v49
v_mul_f32 v97, v97, v49
v_mul_f32 v98, v98, v49
v_mul_f32 v99, v99, v49
v_mul_f32 v100, v100, v49
v_mul_f32 v101, v101, v49
v_mul_f32 v102, v102, v49
v_mul_f32 v103, v103, v49
v_mul_f32 v104, v104, v49
v_mul_f32 v105, v105, v49
v_mul_f32 v106, v106, v49
v_mul_f32 v107, v107, v49
v_mul_f32 v108, v108, v49
v_mul_f32 v109, v109, v49
v_mul_f32 v110, v110, v49
v_mul_f32 v111, v111, v49
v_cvt_pk_bf16_f32 v112, v96, v97
v_cvt_pk_bf16_f32 v113, v98, v99
v_cvt_pk_bf16_f32 v114, v100, v101
v_cvt_pk_bf16_f32 v115, v102, v103
v_cvt_pk_bf16_f32 v116, v104, v105
v_cvt_pk_bf16_f32 v117, v106, v107
v_cvt_pk_bf16_f32 v118, v108, v109
v_cvt_pk_bf16_f32 v119, v110, v111
s_add_u32 s44, s30, 0
buffer_store_dwordx4 v[112:115], v55, s[24:27], s44 offen offset:2048 sc1
buffer_store_dwordx4 v[116:119], v55, s[24:27], s44 offen offset:3072 sc1
v_accvgpr_read_b32 v64, a32
v_accvgpr_read_b32 v65, a33
v_accvgpr_read_b32 v66, a34
v_accvgpr_read_b32 v67, a35
v_accvgpr_read_b32 v68, a36
v_accvgpr_read_b32 v69, a37
v_accvgpr_read_b32 v70, a38
v_accvgpr_read_b32 v71, a39
v_accvgpr_read_b32 v72, a40
v_accvgpr_read_b32 v73, a41
v_accvgpr_read_b32 v74, a42
v_accvgpr_read_b32 v75, a43
v_accvgpr_read_b32 v76, a44
v_accvgpr_read_b32 v77, a45
v_accvgpr_read_b32 v78, a46
v_accvgpr_read_b32 v79, a47
v_mul_f32 v64, v64, v49
v_mul_f32 v65, v65, v49
v_mul_f32 v66, v66, v49
v_mul_f32 v67, v67, v49
v_mul_f32 v68, v68, v49
v_mul_f32 v69, v69, v49
v_mul_f32 v70, v70, v49
v_mul_f32 v71, v71, v49
v_mul_f32 v72, v72, v49
v_mul_f32 v73, v73, v49
v_mul_f32 v74, v74, v49
v_mul_f32 v75, v75, v49
v_mul_f32 v76, v76, v49
v_mul_f32 v77, v77, v49
v_mul_f32 v78, v78, v49
v_mul_f32 v79, v79, v49
v_cvt_pk_bf16_f32 v80, v64, v65
v_cvt_pk_bf16_f32 v81, v66, v67
v_cvt_pk_bf16_f32 v82, v68, v69
v_cvt_pk_bf16_f32 v83, v70, v71
v_cvt_pk_bf16_f32 v84, v72, v73
v_cvt_pk_bf16_f32 v85, v74, v75
v_cvt_pk_bf16_f32 v86, v76, v77
v_cvt_pk_bf16_f32 v87, v78, v79
s_add_u32 s44, s30, 4096
buffer_store_dwordx4 v[80:83], v55, s[24:27], s44 offen offset:0 sc1
buffer_store_dwordx4 v[84:87], v55, s[24:27], s44 offen offset:1024 sc1
v_accvgpr_read_b32 v96, a48
v_accvgpr_read_b32 v97, a49
v_accvgpr_read_b32 v98, a50
v_accvgpr_read_b32 v99, a51
v_accvgpr_read_b32 v100, a52
v_accvgpr_read_b32 v101, a53
v_accvgpr_read_b32 v102, a54
v_accvgpr_read_b32 v103, a55
v_accvgpr_read_b32 v104, a56
v_accvgpr_read_b32 v105, a57
v_accvgpr_read_b32 v106, a58
v_accvgpr_read_b32 v107, a59
v_accvgpr_read_b32 v108, a60
v_accvgpr_read_b32 v109, a61
v_accvgpr_read_b32 v110, a62
v_accvgpr_read_b32 v111, a63
v_mul_f32 v96, v96, v49
v_mul_f32 v97, v97, v49
v_mul_f32 v98, v98, v49
v_mul_f32 v99, v99, v49
v_mul_f32 v100, v100, v49
v_mul_f32 v101, v101, v49
v_mul_f32 v102, v102, v49
v_mul_f32 v103, v103, v49
v_mul_f32 v104, v104, v49
v_mul_f32 v105, v105, v49
v_mul_f32 v106, v106, v49
v_mul_f32 v107, v107, v49
v_mul_f32 v108, v108, v49
v_mul_f32 v109, v109, v49
v_mul_f32 v110, v110, v49
v_mul_f32 v111, v111, v49
v_cvt_pk_bf16_f32 v112, v96, v97
v_cvt_pk_bf16_f32 v113, v98, v99
v_cvt_pk_bf16_f32 v114, v100, v101
v_cvt_pk_bf16_f32 v115, v102, v103
v_cvt_pk_bf16_f32 v116, v104, v105
v_cvt_pk_bf16_f32 v117, v106, v107
v_cvt_pk_bf16_f32 v118, v108, v109
v_cvt_pk_bf16_f32 v119, v110, v111
s_add_u32 s44, s30, 4096
buffer_store_dwordx4 v[112:115], v55, s[24:27], s44 offen offset:2048 sc1
buffer_store_dwordx4 v[116:119], v55, s[24:27], s44 offen offset:3072 sc1
v_accvgpr_read_b32 v64, a64
v_accvgpr_read_b32 v65, a65
v_accvgpr_read_b32 v66, a66
v_accvgpr_read_b32 v67, a67
v_accvgpr_read_b32 v68, a68
v_accvgpr_read_b32 v69, a69
v_accvgpr_read_b32 v70, a70
v_accvgpr_read_b32 v71, a71
v_accvgpr_read_b32 v72, a72
v_accvgpr_read_b32 v73, a73
v_accvgpr_read_b32 v74, a74
v_accvgpr_read_b32 v75, a75
v_accvgpr_read_b32 v76, a76
v_accvgpr_read_b32 v77, a77
v_accvgpr_read_b32 v78, a78
v_accvgpr_read_b32 v79, a79
v_mul_f32 v64, v64, v51
v_mul_f32 v65, v65, v51
v_mul_f32 v66, v66, v51
v_mul_f32 v67, v67, v51
v_mul_f32 v68, v68, v51
v_mul_f32 v69, v69, v51
v_mul_f32 v70, v70, v51
v_mul_f32 v71, v71, v51
v_mul_f32 v72, v72, v51
v_mul_f32 v73, v73, v51
v_mul_f32 v74, v74, v51
v_mul_f32 v75, v75, v51
v_mul_f32 v76, v76, v51
v_mul_f32 v77, v77, v51
v_mul_f32 v78, v78, v51
v_mul_f32 v79, v79, v51
v_cvt_pk_bf16_f32 v80, v64, v65
v_cvt_pk_bf16_f32 v81, v66, v67
v_cvt_pk_bf16_f32 v82, v68, v69
v_cvt_pk_bf16_f32 v83, v70, v71
v_cvt_pk_bf16_f32 v84, v72, v73
v_cvt_pk_bf16_f32 v85, v74, v75
v_cvt_pk_bf16_f32 v86, v76, v77
v_cvt_pk_bf16_f32 v87, v78, v79
s_add_u32 s44, s30, 262144
buffer_store_dwordx4 v[80:83], v55, s[24:27], s44 offen offset:0 sc1
buffer_store_dwordx4 v[84:87], v55, s[24:27], s44 offen offset:1024 sc1
v_accvgpr_read_b32 v96, a80
v_accvgpr_read_b32 v97, a81
v_accvgpr_read_b32 v98, a82
v_accvgpr_read_b32 v99, a83
v_accvgpr_read_b32 v100, a84
v_accvgpr_read_b32 v101, a85
v_accvgpr_read_b32 v102, a86
v_accvgpr_read_b32 v103, a87
v_accvgpr_read_b32 v104, a88
v_accvgpr_read_b32 v105, a89
v_accvgpr_read_b32 v106, a90
v_accvgpr_read_b32 v107, a91
v_accvgpr_read_b32 v108, a92
v_accvgpr_read_b32 v109, a93
v_accvgpr_read_b32 v110, a94
v_accvgpr_read_b32 v111, a95
v_mul_f32 v96, v96, v51
v_mul_f32 v97, v97, v51
v_mul_f32 v98, v98, v51
v_mul_f32 v99, v99, v51
v_mul_f32 v100, v100, v51
v_mul_f32 v101, v101, v51
v_mul_f32 v102, v102, v51
v_mul_f32 v103, v103, v51
v_mul_f32 v104, v104, v51
v_mul_f32 v105, v105, v51
v_mul_f32 v106, v106, v51
v_mul_f32 v107, v107, v51
v_mul_f32 v108, v108, v51
v_mul_f32 v109, v109, v51
v_mul_f32 v110, v110, v51
v_mul_f32 v111, v111, v51
v_cvt_pk_bf16_f32 v112, v96, v97
v_cvt_pk_bf16_f32 v113, v98, v99
v_cvt_pk_bf16_f32 v114, v100, v101
v_cvt_pk_bf16_f32 v115, v102, v103
v_cvt_pk_bf16_f32 v116, v104, v105
v_cvt_pk_bf16_f32 v117, v106, v107
v_cvt_pk_bf16_f32 v118, v108, v109
v_cvt_pk_bf16_f32 v119, v110, v111
s_add_u32 s44, s30, 262144
buffer_store_dwordx4 v[112:115], v55, s[24:27], s44 offen offset:2048 sc1
buffer_store_dwordx4 v[116:119], v55, s[24:27], s44 offen offset:3072 sc1
v_accvgpr_read_b32 v64, a96
v_accvgpr_read_b32 v65, a97
v_accvgpr_read_b32 v66, a98
v_accvgpr_read_b32 v67, a99
v_accvgpr_read_b32 v68, a100
v_accvgpr_read_b32 v69, a101
v_accvgpr_read_b32 v70, a102
v_accvgpr_read_b32 v71, a103
v_accvgpr_read_b32 v72, a104
v_accvgpr_read_b32 v73, a105
v_accvgpr_read_b32 v74, a106
v_accvgpr_read_b32 v75, a107
v_accvgpr_read_b32 v76, a108
v_accvgpr_read_b32 v77, a109
v_accvgpr_read_b32 v78, a110
v_accvgpr_read_b32 v79, a111
v_mul_f32 v64, v64, v51
v_mul_f32 v65, v65, v51
v_mul_f32 v66, v66, v51
v_mul_f32 v67, v67, v51
v_mul_f32 v68, v68, v51
v_mul_f32 v69, v69, v51
v_mul_f32 v70, v70, v51
v_mul_f32 v71, v71, v51
v_mul_f32 v72, v72, v51
v_mul_f32 v73, v73, v51
v_mul_f32 v74, v74, v51
v_mul_f32 v75, v75, v51
v_mul_f32 v76, v76, v51
v_mul_f32 v77, v77, v51
v_mul_f32 v78, v78, v51
v_mul_f32 v79, v79, v51
v_cvt_pk_bf16_f32 v80, v64, v65
v_cvt_pk_bf16_f32 v81, v66, v67
v_cvt_pk_bf16_f32 v82, v68, v69
v_cvt_pk_bf16_f32 v83, v70, v71
v_cvt_pk_bf16_f32 v84, v72, v73
v_cvt_pk_bf16_f32 v85, v74, v75
v_cvt_pk_bf16_f32 v86, v76, v77
v_cvt_pk_bf16_f32 v87, v78, v79
s_add_u32 s44, s30, 266240
buffer_store_dwordx4 v[80:83], v55, s[24:27], s44 offen offset:0 sc1
buffer_store_dwordx4 v[84:87], v55, s[24:27], s44 offen offset:1024 sc1
v_accvgpr_read_b32 v96, a112
v_accvgpr_read_b32 v97, a113
v_accvgpr_read_b32 v98, a114
v_accvgpr_read_b32 v99, a115
v_accvgpr_read_b32 v100, a116
v_accvgpr_read_b32 v101, a117
v_accvgpr_read_b32 v102, a118
v_accvgpr_read_b32 v103, a119
v_accvgpr_read_b32 v104, a120
v_accvgpr_read_b32 v105, a121
v_accvgpr_read_b32 v106, a122
v_accvgpr_read_b32 v107, a123
v_accvgpr_read_b32 v108, a124
v_accvgpr_read_b32 v109, a125
v_accvgpr_read_b32 v110, a126
v_accvgpr_read_b32 v111, a127
v_mul_f32 v96, v96, v51
v_mul_f32 v97, v97, v51
v_mul_f32 v98, v98, v51
v_mul_f32 v99, v99, v51
v_mul_f32 v100, v100, v51
v_mul_f32 v101, v101, v51
v_mul_f32 v102, v102, v51
v_mul_f32 v103, v103, v51
v_mul_f32 v104, v104, v51
v_mul_f32 v105, v105, v51
v_mul_f32 v106, v106, v51
v_mul_f32 v107, v107, v51
v_mul_f32 v108, v108, v51
v_mul_f32 v109, v109, v51
v_mul_f32 v110, v110, v51
v_mul_f32 v111, v111, v51
v_cvt_pk_bf16_f32 v112, v96, v97
v_cvt_pk_bf16_f32 v113, v98, v99
v_cvt_pk_bf16_f32 v114, v100, v101
v_cvt_pk_bf16_f32 v115, v102, v103
v_cvt_pk_bf16_f32 v116, v104, v105
v_cvt_pk_bf16_f32 v117, v106, v107
v_cvt_pk_bf16_f32 v118, v108, v109
v_cvt_pk_bf16_f32 v119, v110, v111
s_add_u32 s44, s30, 266240
buffer_store_dwordx4 v[112:115], v55, s[24:27], s44 offen offset:2048 sc1
buffer_store_dwordx4 v[116:119], v55, s[24:27], s44 offen offset:3072 sc1
v_accvgpr_read_b32 v64, a128
v_accvgpr_read_b32 v65, a129
v_accvgpr_read_b32 v66, a130
v_accvgpr_read_b32 v67, a131
v_accvgpr_read_b32 v68, a132
v_accvgpr_read_b32 v69, a133
v_accvgpr_read_b32 v70, a134
v_accvgpr_read_b32 v71, a135
v_accvgpr_read_b32 v72, a136
v_accvgpr_read_b32 v73, a137
v_accvgpr_read_b32 v74, a138
v_accvgpr_read_b32 v75, a139
v_accvgpr_read_b32 v76, a140
v_accvgpr_read_b32 v77, a141
v_accvgpr_read_b32 v78, a142
v_accvgpr_read_b32 v79, a143
v_mul_f32 v64, v64, v53
v_mul_f32 v65, v65, v53
v_mul_f32 v66, v66, v53
v_mul_f32 v67, v67, v53
v_mul_f32 v68, v68, v53
v_mul_f32 v69, v69, v53
v_mul_f32 v70, v70, v53
v_mul_f32 v71, v71, v53
v_mul_f32 v72, v72, v53
v_mul_f32 v73, v73, v53
v_mul_f32 v74, v74, v53
v_mul_f32 v75, v75, v53
v_mul_f32 v76, v76, v53
v_mul_f32 v77, v77, v53
v_mul_f32 v78, v78, v53
v_mul_f32 v79, v79, v53
v_cvt_pk_bf16_f32 v80, v64, v65
v_cvt_pk_bf16_f32 v81, v66, v67
v_cvt_pk_bf16_f32 v82, v68, v69
v_cvt_pk_bf16_f32 v83, v70, v71
v_cvt_pk_bf16_f32 v84, v72, v73
v_cvt_pk_bf16_f32 v85, v74, v75
v_cvt_pk_bf16_f32 v86, v76, v77
v_cvt_pk_bf16_f32 v87, v78, v79
s_add_u32 s44, s30, 524288
buffer_store_dwordx4 v[80:83], v55, s[24:27], s44 offen offset:0 sc1
buffer_store_dwordx4 v[84:87], v55, s[24:27], s44 offen offset:1024 sc1
v_accvgpr_read_b32 v96, a144
v_accvgpr_read_b32 v97, a145
v_accvgpr_read_b32 v98, a146
v_accvgpr_read_b32 v99, a147
v_accvgpr_read_b32 v100, a148
v_accvgpr_read_b32 v101, a149
v_accvgpr_read_b32 v102, a150
v_accvgpr_read_b32 v103, a151
v_accvgpr_read_b32 v104, a152
v_accvgpr_read_b32 v105, a153
v_accvgpr_read_b32 v106, a154
v_accvgpr_read_b32 v107, a155
v_accvgpr_read_b32 v108, a156
v_accvgpr_read_b32 v109, a157
v_accvgpr_read_b32 v110, a158
v_accvgpr_read_b32 v111, a159
v_mul_f32 v96, v96, v53
v_mul_f32 v97, v97, v53
v_mul_f32 v98, v98, v53
v_mul_f32 v99, v99, v53
v_mul_f32 v100, v100, v53
v_mul_f32 v101, v101, v53
v_mul_f32 v102, v102, v53
v_mul_f32 v103, v103, v53
v_mul_f32 v104, v104, v53
v_mul_f32 v105, v105, v53
v_mul_f32 v106, v106, v53
v_mul_f32 v107, v107, v53
v_mul_f32 v108, v108, v53
v_mul_f32 v109, v109, v53
v_mul_f32 v110, v110, v53
v_mul_f32 v111, v111, v53
v_cvt_pk_bf16_f32 v112, v96, v97
v_cvt_pk_bf16_f32 v113, v98, v99
v_cvt_pk_bf16_f32 v114, v100, v101
v_cvt_pk_bf16_f32 v115, v102, v103
v_cvt_pk_bf16_f32 v116, v104, v105
v_cvt_pk_bf16_f32 v117, v106, v107
v_cvt_pk_bf16_f32 v118, v108, v109
v_cvt_pk_bf16_f32 v119, v110, v111
s_add_u32 s44, s30, 524288
buffer_store_dwordx4 v[112:115], v55, s[24:27], s44 offen offset:2048 sc1
buffer_store_dwordx4 v[116:119], v55, s[24:27], s44 offen offset:3072 sc1
v_accvgpr_read_b32 v64, a160
v_accvgpr_read_b32 v65, a161
v_accvgpr_read_b32 v66, a162
v_accvgpr_read_b32 v67, a163
v_accvgpr_read_b32 v68, a164
v_accvgpr_read_b32 v69, a165
v_accvgpr_read_b32 v70, a166
v_accvgpr_read_b32 v71, a167
v_accvgpr_read_b32 v72, a168
v_accvgpr_read_b32 v73, a169
v_accvgpr_read_b32 v74, a170
v_accvgpr_read_b32 v75, a171
v_accvgpr_read_b32 v76, a172
v_accvgpr_read_b32 v77, a173
v_accvgpr_read_b32 v78, a174
v_accvgpr_read_b32 v79, a175
v_mul_f32 v64, v64, v53
v_mul_f32 v65, v65, v53
v_mul_f32 v66, v66, v53
v_mul_f32 v67, v67, v53
v_mul_f32 v68, v68, v53
v_mul_f32 v69, v69, v53
v_mul_f32 v70, v70, v53
v_mul_f32 v71, v71, v53
v_mul_f32 v72, v72, v53
v_mul_f32 v73, v73, v53
v_mul_f32 v74, v74, v53
v_mul_f32 v75, v75, v53
v_mul_f32 v76, v76, v53
v_mul_f32 v77, v77, v53
v_mul_f32 v78, v78, v53
v_mul_f32 v79, v79, v53
v_cvt_pk_bf16_f32 v80, v64, v65
v_cvt_pk_bf16_f32 v81, v66, v67
v_cvt_pk_bf16_f32 v82, v68, v69
v_cvt_pk_bf16_f32 v83, v70, v71
v_cvt_pk_bf16_f32 v84, v72, v73
v_cvt_pk_bf16_f32 v85, v74, v75
v_cvt_pk_bf16_f32 v86, v76, v77
v_cvt_pk_bf16_f32 v87, v78, v79
s_add_u32 s44, s30, 528384
buffer_store_dwordx4 v[80:83], v55, s[24:27], s44 offen offset:0 sc1
buffer_store_dwordx4 v[84:87], v55, s[24:27], s44 offen offset:1024 sc1
v_accvgpr_read_b32 v96, a176
v_accvgpr_read_b32 v97, a177
v_accvgpr_read_b32 v98, a178
v_accvgpr_read_b32 v99, a179
v_accvgpr_read_b32 v100, a180
v_accvgpr_read_b32 v101, a181
v_accvgpr_read_b32 v102, a182
v_accvgpr_read_b32 v103, a183
v_accvgpr_read_b32 v104, a184
v_accvgpr_read_b32 v105, a185
v_accvgpr_read_b32 v106, a186
v_accvgpr_read_b32 v107, a187
v_accvgpr_read_b32 v108, a188
v_accvgpr_read_b32 v109, a189
v_accvgpr_read_b32 v110, a190
v_accvgpr_read_b32 v111, a191
v_mul_f32 v96, v96, v53
v_mul_f32 v97, v97, v53
v_mul_f32 v98, v98, v53
v_mul_f32 v99, v99, v53
v_mul_f32 v100, v100, v53
v_mul_f32 v101, v101, v53
v_mul_f32 v102, v102, v53
v_mul_f32 v103, v103, v53
v_mul_f32 v104, v104, v53
v_mul_f32 v105, v105, v53
v_mul_f32 v106, v106, v53
v_mul_f32 v107, v107, v53
v_mul_f32 v108, v108, v53
v_mul_f32 v109, v109, v53
v_mul_f32 v110, v110, v53
v_mul_f32 v111, v111, v53
v_cvt_pk_bf16_f32 v112, v96, v97
v_cvt_pk_bf16_f32 v113, v98, v99
v_cvt_pk_bf16_f32 v114, v100, v101
v_cvt_pk_bf16_f32 v115, v102, v103
v_cvt_pk_bf16_f32 v116, v104, v105
v_cvt_pk_bf16_f32 v117, v106, v107
v_cvt_pk_bf16_f32 v118, v108, v109
v_cvt_pk_bf16_f32 v119, v110, v111
s_add_u32 s44, s30, 528384
buffer_store_dwordx4 v[112:115], v55, s[24:27], s44 offen offset:2048 sc1
buffer_store_dwordx4 v[116:119], v55, s[24:27], s44 offen offset:3072 sc1
s_cmp_lg_u32 s31, 0
s_cbranch_scc1 L_checked
v_mov_b32 v50, 0x49800000
s_mov_b64 s[4:5], 0
v_cmp_nlt_f32 vcc, v18, v50
s_nop 1
s_or_b64 s[4:5], s[4:5], vcc
v_cmp_nlt_f32 vcc, v19, v50
s_nop 1
s_or_b64 s[4:5], s[4:5], vcc
v_cmp_nlt_f32 vcc, v20, v50
s_nop 1
s_or_b64 s[4:5], s[4:5], vcc
s_cmp_lg_u64 s[4:5], 0
s_cselect_b32 s3, 1, 0
s_lshl_b32 s6, s35, 2
s_add_u32 s6, s6, 131072
v_mov_b32 v51, s3
v_mov_b32 v52, s6
ds_write_b32 v52, v51
v_mov_b32 v52, 131072
s_waitcnt lgkmcnt(0)
s_barrier
ds_read_b128 v[56:59], v52
s_waitcnt lgkmcnt(0)
v_or3_b32 v51, v56, v57, v58
v_or_b32 v51, v51, v59
s_nop 0
v_readfirstlane_b32 s3, v51
s_nop 3
s_cmp_lg_u32 s3, 0
s_cbranch_scc1 L_fallback
L_checked:
s_barrier
s_lshl_b32 s5, s85, 10
s_lshl_b32 s3, s35, 5
s_add_u32 s5, s5, s3
s_mul_i32 s5, s5, 1152
s_mul_i32 s3, s84, 288
s_add_u32 s92, s5, s3
s_add_u32 s91, s92, 1179648
s_mul_i32 s3, s84, 294912
s_add_u32 s90, s92, s3
s_mul_i32 s89, s35, 9216
v_lshrrev_b32 v35, 4, v0
v_and_b32 v36, 15, v0
v_mul_u32_u24 v32, 1152, v35
v_or_b32 v31, 0, v35
v_lshlrev_b32 v31, 1, v31
v_xor_b32 v31, v36, v31
v_lshlrev_b32 v31, 4, v31
v_add_u32 v31, v31, v32
v_add_u32 v22, 0, v31
v_add_u32 v23, 3584, v31
v_add_u32 v26, 18432, v31
v_add_u32 v27, 22016, v31
v_or_b32 v31, 4, v35
v_lshlrev_b32 v31, 1, v31
v_xor_b32 v31, v36, v31
v_lshlrev_b32 v31, 4, v31
v_add_u32 v31, v31, v32
v_add_u32 v24, 7168, v31
v_add_u32 v25, 10752, v31
v_add_u32 v28, 25600, v31
v_add_u32 v29, 29184, v31
v_lshrrev_b32 v31, 1, v0
v_and_b32 v32, 0x13, v31
v_and_b32 v33, 4, v31
v_lshlrev_b32 v33, 1, v33
v_or_b32 v32, v32, v33
v_and_b32 v33, 8, v31
v_lshrrev_b32 v33, 1, v33
v_or_b32 v32, v32, v33
v_mul_u32_u24 v32, 1152, v32
v_and_b32 v33, 1, v0
v_lshlrev_b32 v33, 4, v33
v_add_u32 v32, v32, v33
v_add_u32 v30, 256, v32
s_add_u32 m0, s89, 0
s_mov_b32 s16, s90
buffer_load_dwordx4 v22, s[56:59], s16 offen offset:0 lds
buffer_load_dwordx4 v23, s[56:59], s16 offen offset:1024 lds
buffer_load_dwordx4 v24, s[56:59], s16 offen offset:2048 lds
buffer_load_dwordx4 v25, s[56:59], s16 offen offset:3072 lds
s_add_u32 m0, s89, 4096
s_nop 0
buffer_load_dwordx4 v26, s[56:59], s16 offen offset:0 lds
buffer_load_dwordx4 v27, s[56:59], s16 offen offset:1024 lds
buffer_load_dwordx4 v28, s[56:59], s16 offen offset:2048 lds
buffer_load_dwordx4 v29, s[56:59], s16 offen offset:3072 lds
s_add_u32 m0, s89, 8192
s_add_u32 s90, s90, 147456
buffer_load_dwordx4 v30, s[56:59], s16 offen lds
s_cmp_eq_u32 s90, s91
s_cselect_b32 s90, s92, s90
s_add_u32 m0, s89, 36864
s_mov_b32 s16, s90
buffer_load_dwordx4 v22, s[56:59], s16 offen offset:0 lds
buffer_load_dwordx4 v23, s[56:59], s16 offen offset:1024 lds
buffer_load_dwordx4 v24, s[56:59], s16 offen offset:2048 lds
buffer_load_dwordx4 v25, s[56:59], s16 offen offset:3072 lds
s_add_u32 m0, s89, 40960
s_nop 0
buffer_load_dwordx4 v26, s[56:59], s16 offen offset:0 lds
buffer_load_dwordx4 v27, s[56:59], s16 offen offset:1024 lds
buffer_load_dwordx4 v28, s[56:59], s16 offen offset:2048 lds
buffer_load_dwordx4 v29, s[56:59], s16 offen offset:3072 lds
s_add_u32 m0, s89, 45056
s_add_u32 s90, s90, 147456
buffer_load_dwordx4 v30, s[56:59], s16 offen lds
s_cmp_eq_u32 s90, s91
s_cselect_b32 s90, s92, s90
s_add_u32 m0, s89, 73728
s_mov_b32 s16, s90
buffer_load_dwordx4 v22, s[56:59], s16 offen offset:0 lds
buffer_load_dwordx4 v23, s[56:59], s16 offen offset:1024 lds
buffer_load_dwordx4 v24, s[56:59], s16 offen offset:2048 lds
buffer_load_dwordx4 v25, s[56:59], s16 offen offset:3072 lds
s_add_u32 m0, s89, 77824
s_nop 0
buffer_load_dwordx4 v26, s[56:59], s16 offen offset:0 lds
buffer_load_dwordx4 v27, s[56:59], s16 offen offset:1024 lds
buffer_load_dwordx4 v28, s[56:59], s16 offen offset:2048 lds
buffer_load_dwordx4 v29, s[56:59], s16 offen offset:3072 lds
s_add_u32 m0, s89, 81920
s_add_u32 s90, s90, 147456
buffer_load_dwordx4 v30, s[56:59], s16 offen lds
s_cmp_eq_u32 s90, s91
s_cselect_b32 s90, s92, s90
v_lshrrev_b32 v37, 4, v0
v_and_b32 v38, 15, v0
s_lshl_b32 s5, s38, 3
s_add_u32 s5, s5, s39
s_mul_i32 s5, s5, 1572864
s_lshl_b32 s3, s85, 16
s_add_u32 s93, s5, s3
s_lshl_b32 s94, s84, 14
s_lshl_b32 s5, s38, 2
s_add_u32 s5, s5, s85
s_lshl_b32 s5, s5, 3
s_add_u32 s5, s5, s39
s_lshl_b32 s5, s5, 2
s_add_u32 s5, s5, s84
s_mul_i32 s5, s5, 55296
s_mul_i32 s3, s35, 13824
s_add_u32 s5, s5, s3
s_add_u32 s95, s5, 33554432
v_lshrrev_b32 v33, 1, v37
v_lshlrev_b32 v33, 10, v33
v_and_b32 v34, 1, v37
v_lshlrev_b32 v34, 9, v34
v_add_u32 v33, v33, v34
v_lshlrev_b32 v34, 4, v38
v_add_u32 v33, v33, v34
s_mul_i32 s4, s35, 3
s_add_u32 s5, s4, 0
s_lshr_b32 s3, s5, 1
s_lshl_b32 s3, s3, 18
s_and_b32 s5, s5, 1
s_lshl_b32 s5, s5, 8
s_add_u32 s3, s3, s5
v_add_u32 v10, s3, v33
s_add_u32 s5, s4, 1
s_lshr_b32 s3, s5, 1
s_lshl_b32 s3, s3, 18
s_and_b32 s5, s5, 1
s_lshl_b32 s5, s5, 8
s_add_u32 s3, s3, s5
v_add_u32 v11, s3, v33
s_add_u32 s5, s4, 2
s_lshr_b32 s3, s5, 1
s_lshl_b32 s3, s3, 18
s_and_b32 s5, s5, 1
s_lshl_b32 s5, s5, 8
s_add_u32 s3, s3, s5
v_add_u32 v12, s3, v33
v_lshrrev_b32 v33, 2, v38
v_and_b32 v34, 3, v0
v_lshlrev_b32 v35, 3, v37
v_add_u32 v35, v35, v33
v_lshlrev_b32 v35, 8, v35
v_and_b32 v36, 1, v37
v_lshlrev_b32 v36, 2, v36
v_or_b32 v36, v36, v33
v_lshlrev_b32 v21, 5, v36
v_add_u32 v35, v35, v21
v_lshlrev_b32 v34, 3, v34
v_add_u32 v35, v35, v34
v_xor_b32 v13, 0, v35
v_xor_b32 v14, 32, v35
v_xor_b32 v15, 64, v35
v_xor_b32 v16, 96, v35
v_xor_b32 v17, 128, v35
v_xor_b32 v18, 160, v35
v_xor_b32 v19, 192, v35
v_xor_b32 v20, 224, v35
v_lshrrev_b32 v35, 1, v37
v_lshlrev_b32 v35, 9, v35
v_add3_u32 v21, v21, v35, v34
v_add_u32 v21, 8192, v21
v_lshlrev_b32 v43, 4, v0
v_lshlrev_b32 v44, 3, v0
s_lshl_b32 s87, s38, 3
s_add_u32 s87, s87, s39
s_lshl_b32 s87, s87, 2
s_add_u32 s87, s87, s84
s_lshl_b32 s88, s38, 2
s_add_u32 s88, s88, s85
s_lshl_b32 s88, s88, 3
s_add_u32 s88, s88, s39
s_waitcnt vmcnt(27)
s_barrier
s_cmp_lg_u32 s35, 0
s_cbranch_scc1 L_sig_skip_A
v_mov_b32 v31, 0x1
s_lshl_b32 s3, s88, 2
v_mov_b32 v32, s3
s_mov_b64 exec, 1
buffer_atomic_add v31, v32, s[76:79], 0 offen sc1
s_mov_b64 exec, -1
L_sig_skip_A:
s_add_u32 s17, s93, s94
buffer_load_dwordx4 a[0:3], v10, s[24:27], s17 offen offset:0 sc1
buffer_load_dwordx4 a[4:7], v11, s[24:27], s17 offen offset:0 sc1
buffer_load_dwordx4 a[8:11], v12, s[24:27], s17 offen offset:0 sc1
buffer_load_dwordx4 a[12:15], v10, s[24:27], s17 offen offset:2048 sc1
buffer_load_dwordx4 a[16:19], v11, s[24:27], s17 offen offset:2048 sc1
buffer_load_dwordx4 a[20:23], v12, s[24:27], s17 offen offset:2048 sc1
s_add_u32 s17, s17, 4096
s_add_u32 s94, s94, 8192
s_and_b32 s94, s94, 0xffff
buffer_load_dwordx4 a[24:27], v10, s[24:27], s17 offen offset:0 sc1
buffer_load_dwordx4 a[28:31], v11, s[24:27], s17 offen offset:0 sc1
buffer_load_dwordx4 a[32:35], v12, s[24:27], s17 offen offset:0 sc1
buffer_load_dwordx4 a[36:39], v10, s[24:27], s17 offen offset:2048 sc1
buffer_load_dwordx4 a[40:43], v11, s[24:27], s17 offen offset:2048 sc1
buffer_load_dwordx4 a[44:47], v12, s[24:27], s17 offen offset:2048 sc1
s_add_u32 s17, s93, s94
buffer_load_dwordx4 a[48:51], v10, s[24:27], s17 offen offset:0 sc1
buffer_load_dwordx4 a[52:55], v11, s[24:27], s17 offen offset:0 sc1
buffer_load_dwordx4 a[56:59], v12, s[24:27], s17 offen offset:0 sc1
s_waitcnt vmcnt(33)
s_barrier
ds_read_b64_tr_b16 v[64:65], v13 offset:0
ds_read_b64_tr_b16 v[66:67], v13 offset:1024
ds_read_b64_tr_b16 v[68:69], v14 offset:0
ds_read_b64_tr_b16 v[70:71], v14 offset:1024
ds_read_b64_tr_b16 v[72:73], v15 offset:0
ds_read_b64_tr_b16 v[74:75], v15 offset:1024
ds_read_b64_tr_b16 v[76:77], v16 offset:0
ds_read_b64_tr_b16 v[78:79], v16 offset:1024
s_waitcnt vmcnt(12) lgkmcnt(6)
v_mfma_f32_16x16x32_bf16 v[88:91], v[64:67], a[0:3], 0
ds_read_b64_tr_b16 v[80:81], v17 offset:0
v_mfma_f32_16x16x32_bf16 v[92:95], v[64:67], a[4:7], 0
ds_read_b64_tr_b16 v[82:83], v17 offset:1024
v_mfma_f32_16x16x32_bf16 v[96:99], v[64:67], a[8:11], 0
buffer_load_dwordx4 a[60:63], v10, s[24:27], s17 offen offset:2048 sc1
s_waitcnt lgkmcnt(6)
v_mfma_f32_16x16x32_bf16 v[100:103], v[68:71], a[0:3], 0
ds_read_b64_tr_b16 v[84:85], v18 offset:0
v_mfma_f32_16x16x32_bf16 v[104:107], v[68:71], a[4:7], 0
ds_read_b64_tr_b16 v[86:87], v18 offset:1024
v_mfma_f32_16x16x32_bf16 v[108:111], v[68:71], a[8:11], 0
buffer_load_dwordx4 a[64:67], v11, s[24:27], s17 offen offset:2048 sc1
s_waitcnt lgkmcnt(6)
v_mfma_f32_16x16x32_bf16 v[112:115], v[72:75], a[0:3], 0
ds_read_b64_tr_b16 v[64:65], v19 offset:0
v_mfma_f32_16x16x32_bf16 v[116:119], v[72:75], a[4:7], 0
ds_read_b64_tr_b16 v[66:67], v19 offset:1024
v_mfma_f32_16x16x32_bf16 v[120:123], v[72:75], a[8:11], 0
buffer_load_dwordx4 a[68:71], v12, s[24:27], s17 offen offset:2048 sc1
s_waitcnt lgkmcnt(6)
v_mfma_f32_16x16x32_bf16 v[124:127], v[76:79], a[0:3], 0
ds_read_b64_tr_b16 v[68:69], v20 offset:0
v_mfma_f32_16x16x32_bf16 v[128:131], v[76:79], a[4:7], 0
ds_read_b64_tr_b16 v[70:71], v20 offset:1024
v_mfma_f32_16x16x32_bf16 v[132:135], v[76:79], a[8:11], 0
s_add_u32 s17, s17, 4096
s_add_u32 s94, s94, 8192
s_and_b32 s94, s94, 0xffff
s_waitcnt lgkmcnt(6)
v_mfma_f32_16x16x32_bf16 v[136:139], v[80:83], a[0:3], 0
ds_read_b64_tr_b16 v[72:73], v21 offset:0
v_mfma_f32_16x16x32_bf16 v[140:143], v[80:83], a[4:7], 0
ds_read_b64_tr_b16 v[74:75], v21 offset:256
v_mfma_f32_16x16x32_bf16 v[144:147], v[80:83], a[8:11], 0
buffer_load_dwordx4 a[72:75], v10, s[24:27], s17 offen offset:0 sc1
s_waitcnt lgkmcnt(6)
v_mfma_f32_16x16x32_bf16 v[148:151], v[84:87], a[0:3], 0
ds_read_b64_tr_b16 v[76:77], v13 offset:9216
v_mfma_f32_16x16x32_bf16 v[152:155], v[84:87], a[4:7], 0
ds_read_b64_tr_b16 v[78:79], v13 offset:10240
v_mfma_f32_16x16x32_bf16 v[156:159], v[84:87], a[8:11], 0
buffer_load_dwordx4 a[76:79], v11, s[24:27], s17 offen offset:0 sc1
s_waitcnt lgkmcnt(6)
v_mfma_f32_16x16x32_bf16 v[160:163], v[64:67], a[0:3], 0
ds_read_b64_tr_b16 v[80:81], v14 offset:9216
v_mfma_f32_16x16x32_bf16 v[164:167], v[64:67], a[4:7], 0
ds_read_b64_tr_b16 v[82:83], v14 offset:10240
v_mfma_f32_16x16x32_bf16 v[168:171], v[64:67], a[8:11], 0
buffer_load_dwordx4 a[80:83], v12, s[24:27], s17 offen offset:0 sc1
s_waitcnt lgkmcnt(6)
v_mfma_f32_16x16x32_bf16 v[172:175], v[68:71], a[0:3], 0
ds_read_b64_tr_b16 v[84:85], v15 offset:9216
v_mfma_f32_16x16x32_bf16 v[176:179], v[68:71], a[4:7], 0
ds_read_b64_tr_b16 v[86:87], v15 offset:10240
v_mfma_f32_16x16x32_bf16 v[180:183], v[68:71], a[8:11], 0
buffer_load_dwordx4 a[84:87], v10, s[24:27], s17 offen offset:2048 sc1
s_waitcnt lgkmcnt(6)
v_mfma_f32_16x16x32_bf16 v[184:187], v[72:75], a[0:3], 0
ds_read_b64_tr_b16 v[64:65], v16 offset:9216
v_mfma_f32_16x16x32_bf16 v[188:191], v[72:75], a[4:7], 0
ds_read_b64_tr_b16 v[66:67], v16 offset:10240
v_mfma_f32_16x16x32_bf16 v[192:195], v[72:75], a[8:11], 0
buffer_load_dwordx4 a[88:91], v11, s[24:27], s17 offen offset:2048 sc1
s_waitcnt vmcnt(17) lgkmcnt(6)
v_mfma_f32_16x16x32_bf16 v[88:91], v[76:79], a[12:15], v[88:91]
ds_read_b64_tr_b16 v[68:69], v17 offset:9216
v_mfma_f32_16x16x32_bf16 v[92:95], v[76:79], a[16:19], v[92:95]
ds_read_b64_tr_b16 v[70:71], v17 offset:10240
v_mfma_f32_16x16x32_bf16 v[96:99], v[76:79], a[20:23], v[96:99]
buffer_load_dwordx4 a[92:95], v12, s[24:27], s17 offen offset:2048 sc1
s_waitcnt lgkmcnt(6)
v_mfma_f32_16x16x32_bf16 v[100:103], v[80:83], a[12:15], v[100:103]
ds_read_b64_tr_b16 v[72:73], v18 offset:9216
v_mfma_f32_16x16x32_bf16 v[104:107], v[80:83], a[16:19], v[104:107]
ds_read_b64_tr_b16 v[74:75], v18 offset:10240
v_mfma_f32_16x16x32_bf16 v[108:111], v[80:83], a[20:23], v[108:111]
s_waitcnt lgkmcnt(6)
v_mfma_f32_16x16x32_bf16 v[112:115], v[84:87], a[12:15], v[112:115]
ds_read_b64_tr_b16 v[76:77], v19 offset:9216
v_mfma_f32_16x16x32_bf16 v[116:119], v[84:87], a[16:19], v[116:119]
ds_read_b64_tr_b16 v[78:79], v19 offset:10240
v_mfma_f32_16x16x32_bf16 v[120:123], v[84:87], a[20:23], v[120:123]
s_waitcnt lgkmcnt(6)
v_mfma_f32_16x16x32_bf16 v[124:127], v[64:67], a[12:15], v[124:127]
ds_read_b64_tr_b16 v[80:81], v20 offset:9216
v_mfma_f32_16x16x32_bf16 v[128:131], v[64:67], a[16:19], v[128:131]
ds_read_b64_tr_b16 v[82:83], v20 offset:10240
v_mfma_f32_16x16x32_bf16 v[132:135], v[64:67], a[20:23], v[132:135]
s_waitcnt lgkmcnt(6)
v_mfma_f32_16x16x32_bf16 v[136:139], v[68:71], a[12:15], v[136:139]
ds_read_b64_tr_b16 v[84:85], v21 offset:9216
v_mfma_f32_16x16x32_bf16 v[140:143], v[68:71], a[16:19], v[140:143]
ds_read_b64_tr_b16 v[86:87], v21 offset:9472
v_mfma_f32_16x16x32_bf16 v[144:147], v[68:71], a[20:23], v[144:147]
s_waitcnt lgkmcnt(6)
v_mfma_f32_16x16x32_bf16 v[148:151], v[72:75], a[12:15], v[148:151]
ds_read_b64_tr_b16 v[64:65], v13 offset:18432
v_mfma_f32_16x16x32_bf16 v[152:155], v[72:75], a[16:19], v[152:155]
ds_read_b64_tr_b16 v[66:67], v13 offset:19456
v_mfma_f32_16x16x32_bf16 v[156:159], v[72:75], a[20:23], v[156:159]
s_waitcnt lgkmcnt(6)
v_mfma_f32_16x16x32_bf16 v[160:163], v[76:79], a[12:15], v[160:163]
ds_read_b64_tr_b16 v[68:69], v14 offset:18432
v_mfma_f32_16x16x32_bf16 v[164:167], v[76:79], a[16:19], v[164:167]
ds_read_b64_tr_b16 v[70:71], v14 offset:19456
v_mfma_f32_16x16x32_bf16 v[168:171], v[76:79], a[20:23], v[168:171]
s_waitcnt lgkmcnt(6)
v_mfma_f32_16x16x32_bf16 v[172:175], v[80:83], a[12:15], v[172:175]
ds_read_b64_tr_b16 v[72:73], v15 offset:18432
v_mfma_f32_16x16x32_bf16 v[176:179], v[80:83], a[16:19], v[176:179]
ds_read_b64_tr_b16 v[74:75], v15 offset:19456
v_mfma_f32_16x16x32_bf16 v[180:183], v[80:83], a[20:23], v[180:183]
s_waitcnt lgkmcnt(6)
v_mfma_f32_16x16x32_bf16 v[184:187], v[84:87], a[12:15], v[184:187]
ds_read_b64_tr_b16 v[76:77], v16 offset:18432
v_mfma_f32_16x16x32_bf16 v[188:191], v[84:87], a[16:19], v[188:191]
ds_read_b64_tr_b16 v[78:79], v16 offset:19456
v_mfma_f32_16x16x32_bf16 v[192:195], v[84:87], a[20:23], v[192:195]
s_waitcnt vmcnt(15) lgkmcnt(6)
v_mfma_f32_16x16x32_bf16 v[88:91], v[64:67], a[24:27], v[88:91]
ds_read_b64_tr_b16 v[80:81], v17 offset:18432
v_mfma_f32_16x16x32_bf16 v[92:95], v[64:67], a[28:31], v[92:95]
ds_read_b64_tr_b16 v[82:83], v17 offset:19456
v_mfma_f32_16x16x32_bf16 v[96:99], v[64:67], a[32:35], v[96:99]
s_waitcnt lgkmcnt(6)
v_mfma_f32_16x16x32_bf16 v[100:103], v[68:71], a[24:27], v[100:103]
ds_read_b64_tr_b16 v[84:85], v18 offset:18432
v_mfma_f32_16x16x32_bf16 v[104:107], v[68:71], a[28:31], v[104:107]
ds_read_b64_tr_b16 v[86:87], v18 offset:19456
v_mfma_f32_16x16x32_bf16 v[108:111], v[68:71], a[32:35], v[108:111]
s_waitcnt lgkmcnt(6)
v_mfma_f32_16x16x32_bf16 v[112:115], v[72:75], a[24:27], v[112:115]
ds_read_b64_tr_b16 v[64:65], v19 offset:18432
v_mfma_f32_16x16x32_bf16 v[116:119], v[72:75], a[28:31], v[116:119]
ds_read_b64_tr_b16 v[66:67], v19 offset:19456
v_mfma_f32_16x16x32_bf16 v[120:123], v[72:75], a[32:35], v[120:123]
s_waitcnt lgkmcnt(6)
v_mfma_f32_16x16x32_bf16 v[124:127], v[76:79], a[24:27], v[124:127]
ds_read_b64_tr_b16 v[68:69], v20 offset:18432
v_mfma_f32_16x16x32_bf16 v[128:131], v[76:79], a[28:31], v[128:131]
ds_read_b64_tr_b16 v[70:71], v20 offset:19456
v_mfma_f32_16x16x32_bf16 v[132:135], v[76:79], a[32:35], v[132:135]
s_waitcnt lgkmcnt(6)
v_mfma_f32_16x16x32_bf16 v[136:139], v[80:83], a[24:27], v[136:139]
ds_read_b64_tr_b16 v[72:73], v21 offset:18432
v_mfma_f32_16x16x32_bf16 v[140:143], v[80:83], a[28:31], v[140:143]
ds_read_b64_tr_b16 v[74:75], v21 offset:18688
v_mfma_f32_16x16x32_bf16 v[144:147], v[80:83], a[32:35], v[144:147]
s_waitcnt lgkmcnt(6)
v_mfma_f32_16x16x32_bf16 v[148:151], v[84:87], a[24:27], v[148:151]
ds_read_b64_tr_b16 v[76:77], v13 offset:27648
v_mfma_f32_16x16x32_bf16 v[152:155], v[84:87], a[28:31], v[152:155]
ds_read_b64_tr_b16 v[78:79], v13 offset:28672
v_mfma_f32_16x16x32_bf16 v[156:159], v[84:87], a[32:35], v[156:159]
s_waitcnt lgkmcnt(6)
v_mfma_f32_16x16x32_bf16 v[160:163], v[64:67], a[24:27], v[160:163]
ds_read_b64_tr_b16 v[80:81], v14 offset:27648
v_mfma_f32_16x16x32_bf16 v[164:167], v[64:67], a[28:31], v[164:167]
ds_read_b64_tr_b16 v[82:83], v14 offset:28672
v_mfma_f32_16x16x32_bf16 v[168:171], v[64:67], a[32:35], v[168:171]
s_waitcnt lgkmcnt(6)
v_mfma_f32_16x16x32_bf16 v[172:175], v[68:71], a[24:27], v[172:175]
ds_read_b64_tr_b16 v[84:85], v15 offset:27648
v_mfma_f32_16x16x32_bf16 v[176:179], v[68:71], a[28:31], v[176:179]
ds_read_b64_tr_b16 v[86:87], v15 offset:28672
v_mfma_f32_16x16x32_bf16 v[180:183], v[68:71], a[32:35], v[180:183]
s_waitcnt lgkmcnt(6)
v_mfma_f32_16x16x32_bf16 v[184:187], v[72:75], a[24:27], v[184:187]
ds_read_b64_tr_b16 v[64:65], v16 offset:27648
v_mfma_f32_16x16x32_bf16 v[188:191], v[72:75], a[28:31], v[188:191]
ds_read_b64_tr_b16 v[66:67], v16 offset:28672
v_mfma_f32_16x16x32_bf16 v[192:195], v[72:75], a[32:35], v[192:195]
s_waitcnt vmcnt(12) lgkmcnt(6)
v_mfma_f32_16x16x32_bf16 v[88:91], v[76:79], a[36:39], v[88:91]
ds_read_b64_tr_b16 v[68:69], v17 offset:27648
v_mfma_f32_16x16x32_bf16 v[92:95], v[76:79], a[40:43], v[92:95]
ds_read_b64_tr_b16 v[70:71], v17 offset:28672
v_mfma_f32_16x16x32_bf16 v[96:99], v[76:79], a[44:47], v[96:99]
s_waitcnt lgkmcnt(6)
v_mfma_f32_16x16x32_bf16 v[100:103], v[80:83], a[36:39], v[100:103]
ds_read_b64_tr_b16 v[72:73], v18 offset:27648
v_mfma_f32_16x16x32_bf16 v[104:107], v[80:83], a[40:43], v[104:107]
ds_read_b64_tr_b16 v[74:75], v18 offset:28672
v_mfma_f32_16x16x32_bf16 v[108:111], v[80:83], a[44:47], v[108:111]
s_waitcnt lgkmcnt(6)
v_mfma_f32_16x16x32_bf16 v[112:115], v[84:87], a[36:39], v[112:115]
ds_read_b64_tr_b16 v[76:77], v19 offset:27648
v_mfma_f32_16x16x32_bf16 v[116:119], v[84:87], a[40:43], v[116:119]
ds_read_b64_tr_b16 v[78:79], v19 offset:28672
v_mfma_f32_16x16x32_bf16 v[120:123], v[84:87], a[44:47], v[120:123]
s_waitcnt lgkmcnt(6)
v_mfma_f32_16x16x32_bf16 v[124:127], v[64:67], a[36:39], v[124:127]
ds_read_b64_tr_b16 v[80:81], v20 offset:27648
v_mfma_f32_16x16x32_bf16 v[128:131], v[64:67], a[40:43], v[128:131]
ds_read_b64_tr_b16 v[82:83], v20 offset:28672
v_mfma_f32_16x16x32_bf16 v[132:135], v[64:67], a[44:47], v[132:135]
s_waitcnt lgkmcnt(6)
v_mfma_f32_16x16x32_bf16 v[136:139], v[68:71], a[36:39], v[136:139]
ds_read_b64_tr_b16 v[84:85], v21 offset:27648
v_mfma_f32_16x16x32_bf16 v[140:143], v[68:71], a[40:43], v[140:143]
ds_read_b64_tr_b16 v[86:87], v21 offset:27904
v_mfma_f32_16x16x32_bf16 v[144:147], v[68:71], a[44:47], v[144:147]
s_waitcnt lgkmcnt(6)
v_mfma_f32_16x16x32_bf16 v[148:151], v[72:75], a[36:39], v[148:151]
s_barrier
v_add_u32 v13, 0x9000, v13
v_add_u32 v14, 0x9000, v14
v_add_u32 v15, 0x9000, v15
v_add_u32 v16, 0x9000, v16
v_add_u32 v17, 0x9000, v17
v_add_u32 v18, 0x9000, v18
v_add_u32 v19, 0x9000, v19
v_add_u32 v20, 0x9000, v20
v_add_u32 v21, 0x9000, v21
ds_read_b64_tr_b16 v[64:65], v13 offset:0
v_mfma_f32_16x16x32_bf16 v[152:155], v[72:75], a[40:43], v[152:155]
ds_read_b64_tr_b16 v[66:67], v13 offset:1024
v_mfma_f32_16x16x32_bf16 v[156:159], v[72:75], a[44:47], v[156:159]
s_add_u32 m0, s89, 110592
s_mov_b32 s16, s90
s_waitcnt lgkmcnt(6)
v_mfma_f32_16x16x32_bf16 v[160:163], v[76:79], a[36:39], v[160:163]
ds_read_b64_tr_b16 v[68:69], v14 offset:0
v_mfma_f32_16x16x32_bf16 v[164:167], v[76:79], a[40:43], v[164:167]
ds_read_b64_tr_b16 v[70:71], v14 offset:1024
v_mfma_f32_16x16x32_bf16 v[168:171], v[76:79], a[44:47], v[168:171]
buffer_load_dwordx4 v22, s[56:59], s16 offen offset:0 lds
s_waitcnt lgkmcnt(6)
v_mfma_f32_16x16x32_bf16 v[172:175], v[80:83], a[36:39], v[172:175]
ds_read_b64_tr_b16 v[72:73], v15 offset:0
v_mfma_f32_16x16x32_bf16 v[176:179], v[80:83], a[40:43], v[176:179]
ds_read_b64_tr_b16 v[74:75], v15 offset:1024
v_mfma_f32_16x16x32_bf16 v[180:183], v[80:83], a[44:47], v[180:183]
buffer_load_dwordx4 v23, s[56:59], s16 offen offset:1024 lds
s_waitcnt lgkmcnt(6)
v_mfma_f32_16x16x32_bf16 v[184:187], v[84:87], a[36:39], v[184:187]
ds_read_b64_tr_b16 v[76:77], v16 offset:0
v_mfma_f32_16x16x32_bf16 v[188:191], v[84:87], a[40:43], v[188:191]
ds_read_b64_tr_b16 v[78:79], v16 offset:1024
v_mfma_f32_16x16x32_bf16 v[192:195], v[84:87], a[44:47], v[192:195]
buffer_load_dwordx4 v24, s[56:59], s16 offen offset:2048 lds
s_waitcnt vmcnt(12) lgkmcnt(6)
v_mfma_f32_16x16x32_bf16 v[88:91], v[64:67], a[48:51], v[88:91]
ds_read_b64_tr_b16 v[80:81], v17 offset:0
v_mfma_f32_16x16x32_bf16 v[92:95], v[64:67], a[52:55], v[92:95]
ds_read_b64_tr_b16 v[82:83], v17 offset:1024
v_mfma_f32_16x16x32_bf16 v[96:99], v[64:67], a[56:59], v[96:99]
buffer_load_dwordx4 v25, s[56:59], s16 offen offset:3072 lds
s_waitcnt lgkmcnt(6)
v_mfma_f32_16x16x32_bf16 v[100:103], v[68:71], a[48:51], v[100:103]
ds_read_b64_tr_b16 v[84:85], v18 offset:0
v_mfma_f32_16x16x32_bf16 v[104:107], v[68:71], a[52:55], v[104:107]
ds_read_b64_tr_b16 v[86:87], v18 offset:1024
v_mfma_f32_16x16x32_bf16 v[108:111], v[68:71], a[56:59], v[108:111]
s_add_u32 m0, s89, 114688
s_nop 0
s_waitcnt lgkmcnt(6)
v_mfma_f32_16x16x32_bf16 v[112:115], v[72:75], a[48:51], v[112:115]
ds_read_b64_tr_b16 v[64:65], v19 offset:0
v_mfma_f32_16x16x32_bf16 v[116:119], v[72:75], a[52:55], v[116:119]
ds_read_b64_tr_b16 v[66:67], v19 offset:1024
v_mfma_f32_16x16x32_bf16 v[120:123], v[72:75], a[56:59], v[120:123]
s_lshl_b32 s3, s88, 2
v_mov_b32 v32, s3
buffer_load_dword v31, v32, s[76:79], 0 offen sc1
buffer_load_dwordx4 v26, s[56:59], s16 offen offset:0 lds
s_waitcnt lgkmcnt(6)
v_mfma_f32_16x16x32_bf16 v[124:127], v[76:79], a[48:51], v[124:127]
ds_read_b64_tr_b16 v[68:69], v20 offset:0
v_mfma_f32_16x16x32_bf16 v[128:131], v[76:79], a[52:55], v[128:131]
ds_read_b64_tr_b16 v[70:71], v20 offset:1024
v_mfma_f32_16x16x32_bf16 v[132:135], v[76:79], a[56:59], v[132:135]
buffer_load_dwordx4 v27, s[56:59], s16 offen offset:1024 lds
s_waitcnt lgkmcnt(6)
v_mfma_f32_16x16x32_bf16 v[136:139], v[80:83], a[48:51], v[136:139]
ds_read_b64_tr_b16 v[72:73], v21 offset:0
v_mfma_f32_16x16x32_bf16 v[140:143], v[80:83], a[52:55], v[140:143]
ds_read_b64_tr_b16 v[74:75], v21 offset:256
v_mfma_f32_16x16x32_bf16 v[144:147], v[80:83], a[56:59], v[144:147]
buffer_load_dwordx4 v28, s[56:59], s16 offen offset:2048 lds
s_waitcnt lgkmcnt(6)
v_mfma_f32_16x16x32_bf16 v[148:151], v[84:87], a[48:51], v[148:151]
ds_read_b64_tr_b16 v[76:77], v13 offset:9216
v_mfma_f32_16x16x32_bf16 v[152:155], v[84:87], a[52:55], v[152:155]
ds_read_b64_tr_b16 v[78:79], v13 offset:10240
v_mfma_f32_16x16x32_bf16 v[156:159], v[84:87], a[56:59], v[156:159]
buffer_load_dwordx4 v29, s[56:59], s16 offen offset:3072 lds
s_waitcnt lgkmcnt(6)
v_mfma_f32_16x16x32_bf16 v[160:163], v[64:67], a[48:51], v[160:163]
ds_read_b64_tr_b16 v[80:81], v14 offset:9216
v_mfma_f32_16x16x32_bf16 v[164:167], v[64:67], a[52:55], v[164:167]
ds_read_b64_tr_b16 v[82:83], v14 offset:10240
v_mfma_f32_16x16x32_bf16 v[168:171], v[64:67], a[56:59], v[168:171]
s_add_u32 m0, s89, 118784
s_waitcnt lgkmcnt(6)
v_mfma_f32_16x16x32_bf16 v[172:175], v[68:71], a[48:51], v[172:175]
ds_read_b64_tr_b16 v[84:85], v15 offset:9216
v_mfma_f32_16x16x32_bf16 v[176:179], v[68:71], a[52:55], v[176:179]
ds_read_b64_tr_b16 v[86:87], v15 offset:10240
v_mfma_f32_16x16x32_bf16 v[180:183], v[68:71], a[56:59], v[180:183]
s_add_u32 s90, s90, 147456
buffer_load_dwordx4 v30, s[56:59], s16 offen lds
s_cmp_eq_u32 s90, s91
s_cselect_b32 s90, s92, s90
s_waitcnt lgkmcnt(6)
v_mfma_f32_16x16x32_bf16 v[184:187], v[72:75], a[48:51], v[184:187]
ds_read_b64_tr_b16 v[64:65], v16 offset:9216
v_mfma_f32_16x16x32_bf16 v[188:191], v[72:75], a[52:55], v[188:191]
ds_read_b64_tr_b16 v[66:67], v16 offset:10240
v_mfma_f32_16x16x32_bf16 v[192:195], v[72:75], a[56:59], v[192:195]
s_waitcnt vmcnt(16) lgkmcnt(6)
v_mfma_f32_16x16x32_bf16 v[88:91], v[76:79], a[60:63], v[88:91]
ds_read_b64_tr_b16 v[68:69], v17 offset:9216
v_mfma_f32_16x16x32_bf16 v[92:95], v[76:79], a[64:67], v[92:95]
ds_read_b64_tr_b16 v[70:71], v17 offset:10240
v_mfma_f32_16x16x32_bf16 v[96:99], v[76:79], a[68:71], v[96:99]
s_waitcnt vmcnt(5)
s_mov_b32 s6, 65536
L_wpoll_A:
v_readfirstlane_b32 s3, v31
s_nop 3
s_lshr_b32 s3, s3, 0
s_and_b32 s3, s3, 0xffff
s_cmp_ge_u32 s3, 4
s_cbranch_scc1 L_wpoll_done_A
buffer_load_dword v31, v32, s[76:79], 0 offen sc1
s_waitcnt vmcnt(0)
s_sub_u32 s6, s6, 1
s_cmp_lg_u32 s6, 0
s_cbranch_scc1 L_wpoll_A
L_wpoll_done_A:
s_waitcnt lgkmcnt(6)
v_mfma_f32_16x16x32_bf16 v[100:103], v[80:83], a[60:63], v[100:103]
ds_read_b64_tr_b16 v[72:73], v18 offset:9216
v_mfma_f32_16x16x32_bf16 v[104:107], v[80:83], a[64:67], v[104:107]
ds_read_b64_tr_b16 v[74:75], v18 offset:10240
s_add_u32 s17, s93, s94
v_mfma_f32_16x16x32_bf16 v[108:111], v[80:83], a[68:71], v[108:111]
buffer_load_dwordx4 a[0:3], v10, s[24:27], s17 offen offset:0 sc1
s_waitcnt lgkmcnt(6)
v_mfma_f32_16x16x32_bf16 v[112:115], v[84:87], a[60:63], v[112:115]
ds_read_b64_tr_b16 v[76:77], v19 offset:9216
v_mfma_f32_16x16x32_bf16 v[116:119], v[84:87], a[64:67], v[116:119]
ds_read_b64_tr_b16 v[78:79], v19 offset:10240
buffer_load_dwordx4 a[4:7], v11, s[24:27], s17 offen offset:0 sc1
v_mfma_f32_16x16x32_bf16 v[120:123], v[84:87], a[68:71], v[120:123]
buffer_load_dwordx4 a[8:11], v12, s[24:27], s17 offen offset:0 sc1
s_waitcnt lgkmcnt(6)
v_mfma_f32_16x16x32_bf16 v[124:127], v[64:67], a[60:63], v[124:127]
ds_read_b64_tr_b16 v[80:81], v20 offset:9216
v_mfma_f32_16x16x32_bf16 v[128:131], v[64:67], a[64:67], v[128:131]
ds_read_b64_tr_b16 v[82:83], v20 offset:10240
buffer_load_dwordx4 a[12:15], v10, s[24:27], s17 offen offset:2048 sc1
v_mfma_f32_16x16x32_bf16 v[132:135], v[64:67], a[68:71], v[132:135]
buffer_load_dwordx4 a[16:19], v11, s[24:27], s17 offen offset:2048 sc1
s_waitcnt lgkmcnt(6)
v_mfma_f32_16x16x32_bf16 v[136:139], v[68:71], a[60:63], v[136:139]
ds_read_b64_tr_b16 v[84:85], v21 offset:9216
v_mfma_f32_16x16x32_bf16 v[140:143], v[68:71], a[64:67], v[140:143]
ds_read_b64_tr_b16 v[86:87], v21 offset:9472
v_mfma_f32_16x16x32_bf16 v[144:147], v[68:71], a[68:71], v[144:147]
buffer_load_dwordx4 a[20:23], v12, s[24:27], s17 offen offset:2048 sc1
s_waitcnt lgkmcnt(6)
v_mfma_f32_16x16x32_bf16 v[148:151], v[72:75], a[60:63], v[148:151]
ds_read_b64_tr_b16 v[64:65], v13 offset:18432
v_mfma_f32_16x16x32_bf16 v[152:155], v[72:75], a[64:67], v[152:155]
ds_read_b64_tr_b16 v[66:67], v13 offset:19456
v_mfma_f32_16x16x32_bf16 v[156:159], v[72:75], a[68:71], v[156:159]
s_add_u32 s17, s17, 4096
s_add_u32 s94, s94, 8192
s_and_b32 s94, s94, 0xffff
s_waitcnt lgkmcnt(6)
v_mfma_f32_16x16x32_bf16 v[160:163], v[76:79], a[60:63], v[160:163]
ds_read_b64_tr_b16 v[68:69], v14 offset:18432
v_mfma_f32_16x16x32_bf16 v[164:167], v[76:79], a[64:67], v[164:167]
ds_read_b64_tr_b16 v[70:71], v14 offset:19456
v_mfma_f32_16x16x32_bf16 v[168:171], v[76:79], a[68:71], v[168:171]
buffer_load_dwordx4 a[24:27], v10, s[24:27], s17 offen offset:0 sc1
s_waitcnt lgkmcnt(6)
v_mfma_f32_16x16x32_bf16 v[172:175], v[80:83], a[60:63], v[172:175]
ds_read_b64_tr_b16 v[72:73], v15 offset:18432
v_mfma_f32_16x16x32_bf16 v[176:179], v[80:83], a[64:67], v[176:179]
ds_read_b64_tr_b16 v[74:75], v15 offset:19456
v_mfma_f32_16x16x32_bf16 v[180:183], v[80:83], a[68:71], v[180:183]
buffer_load_dwordx4 a[28:31], v11, s[24:27], s17 offen offset:0 sc1
s_waitcnt lgkmcnt(6)
v_mfma_f32_16x16x32_bf16 v[184:187], v[84:87], a[60:63], v[184:187]
ds_read_b64_tr_b16 v[76:77], v16 offset:18432
v_mfma_f32_16x16x32_bf16 v[188:191], v[84:87], a[64:67], v[188:191]
ds_read_b64_tr_b16 v[78:79], v16 offset:19456
v_mfma_f32_16x16x32_bf16 v[192:195], v[84:87], a[68:71], v[192:195]
buffer_load_dwordx4 a[32:35], v12, s[24:27], s17 offen offset:0 sc1
s_waitcnt lgkmcnt(6)
v_mfma_f32_16x16x32_bf16 v[88:91], v[64:67], a[72:75], v[88:91]
ds_read_b64_tr_b16 v[80:81], v17 offset:18432
v_mfma_f32_16x16x32_bf16 v[92:95], v[64:67], a[76:79], v[92:95]
ds_read_b64_tr_b16 v[82:83], v17 offset:19456
v_mfma_f32_16x16x32_bf16 v[96:99], v[64:67], a[80:83], v[96:99]
buffer_load_dwordx4 a[36:39], v10, s[24:27], s17 offen offset:2048 sc1
s_waitcnt lgkmcnt(6)
v_mfma_f32_16x16x32_bf16 v[100:103], v[68:71], a[72:75], v[100:103]
ds_read_b64_tr_b16 v[84:85], v18 offset:18432
v_mfma_f32_16x16x32_bf16 v[104:107], v[68:71], a[76:79], v[104:107]
ds_read_b64_tr_b16 v[86:87], v18 offset:19456
v_mfma_f32_16x16x32_bf16 v[108:111], v[68:71], a[80:83], v[108:111]
buffer_load_dwordx4 a[40:43], v11, s[24:27], s17 offen offset:2048 sc1
s_waitcnt lgkmcnt(6)
v_mfma_f32_16x16x32_bf16 v[112:115], v[72:75], a[72:75], v[112:115]
ds_read_b64_tr_b16 v[64:65], v19 offset:18432
v_mfma_f32_16x16x32_bf16 v[116:119], v[72:75], a[76:79], v[116:119]
ds_read_b64_tr_b16 v[66:67], v19 offset:19456
v_mfma_f32_16x16x32_bf16 v[120:123], v[72:75], a[80:83], v[120:123]
buffer_load_dwordx4 a[44:47], v12, s[24:27], s17 offen offset:2048 sc1
s_waitcnt lgkmcnt(6)
v_mfma_f32_16x16x32_bf16 v[124:127], v[76:79], a[72:75], v[124:127]
ds_read_b64_tr_b16 v[68:69], v20 offset:18432
v_mfma_f32_16x16x32_bf16 v[128:131], v[76:79], a[76:79], v[128:131]
ds_read_b64_tr_b16 v[70:71], v20 offset:19456
v_mfma_f32_16x16x32_bf16 v[132:135], v[76:79], a[80:83], v[132:135]
s_add_u32 s17, s93, s94
s_waitcnt lgkmcnt(6)
v_mfma_f32_16x16x32_bf16 v[136:139], v[80:83], a[72:75], v[136:139]
ds_read_b64_tr_b16 v[72:73], v21 offset:18432
v_mfma_f32_16x16x32_bf16 v[140:143], v[80:83], a[76:79], v[140:143]
ds_read_b64_tr_b16 v[74:75], v21 offset:18688
v_mfma_f32_16x16x32_bf16 v[144:147], v[80:83], a[80:83], v[144:147]
buffer_load_dwordx4 a[48:51], v10, s[24:27], s17 offen offset:0 sc1
s_waitcnt lgkmcnt(6)
v_mfma_f32_16x16x32_bf16 v[148:151], v[84:87], a[72:75], v[148:151]
ds_read_b64_tr_b16 v[76:77], v13 offset:27648
v_mfma_f32_16x16x32_bf16 v[152:155], v[84:87], a[76:79], v[152:155]
ds_read_b64_tr_b16 v[78:79], v13 offset:28672
v_mfma_f32_16x16x32_bf16 v[156:159], v[84:87], a[80:83], v[156:159]
buffer_load_dwordx4 a[52:55], v11, s[24:27], s17 offen offset:0 sc1
s_waitcnt lgkmcnt(6)
v_mfma_f32_16x16x32_bf16 v[160:163], v[64:67], a[72:75], v[160:163]
ds_read_b64_tr_b16 v[80:81], v14 offset:27648
v_mfma_f32_16x16x32_bf16 v[164:167], v[64:67], a[76:79], v[164:167]
ds_read_b64_tr_b16 v[82:83], v14 offset:28672
v_mfma_f32_16x16x32_bf16 v[168:171], v[64:67], a[80:83], v[168:171]
buffer_load_dwordx4 a[56:59], v12, s[24:27], s17 offen offset:0 sc1
s_waitcnt lgkmcnt(6)
v_mfma_f32_16x16x32_bf16 v[172:175], v[68:71], a[72:75], v[172:175]
ds_read_b64_tr_b16 v[84:85], v15 offset:27648
v_mfma_f32_16x16x32_bf16 v[176:179], v[68:71], a[76:79], v[176:179]
ds_read_b64_tr_b16 v[86:87], v15 offset:28672
v_mfma_f32_16x16x32_bf16 v[180:183], v[68:71], a[80:83], v[180:183]
buffer_load_dwordx4 a[60:63], v10, s[24:27], s17 offen offset:2048 sc1
s_waitcnt lgkmcnt(6)
v_mfma_f32_16x16x32_bf16 v[184:187], v[72:75], a[72:75], v[184:187]
ds_read_b64_tr_b16 v[64:65], v16 offset:27648
v_mfma_f32_16x16x32_bf16 v[188:191], v[72:75], a[76:79], v[188:191]
ds_read_b64_tr_b16 v[66:67], v16 offset:28672
v_mfma_f32_16x16x32_bf16 v[192:195], v[72:75], a[80:83], v[192:195]
buffer_load_dwordx4 a[64:67], v11, s[24:27], s17 offen offset:2048 sc1
s_waitcnt lgkmcnt(6)
v_mfma_f32_16x16x32_bf16 v[88:91], v[76:79], a[84:87], v[88:91]
ds_read_b64_tr_b16 v[68:69], v17 offset:27648
v_mfma_f32_16x16x32_bf16 v[92:95], v[76:79], a[88:91], v[92:95]
ds_read_b64_tr_b16 v[70:71], v17 offset:28672
v_mfma_f32_16x16x32_bf16 v[96:99], v[76:79], a[92:95], v[96:99]
buffer_load_dwordx4 a[68:71], v12, s[24:27], s17 offen offset:2048 sc1
s_waitcnt lgkmcnt(6)
v_mfma_f32_16x16x32_bf16 v[100:103], v[80:83], a[84:87], v[100:103]
ds_read_b64_tr_b16 v[72:73], v18 offset:27648
v_mfma_f32_16x16x32_bf16 v[104:107], v[80:83], a[88:91], v[104:107]
ds_read_b64_tr_b16 v[74:75], v18 offset:28672
v_mfma_f32_16x16x32_bf16 v[108:111], v[80:83], a[92:95], v[108:111]
s_add_u32 s17, s17, 4096
s_add_u32 s94, s94, 8192
s_and_b32 s94, s94, 0xffff
s_waitcnt lgkmcnt(6)
v_mfma_f32_16x16x32_bf16 v[112:115], v[84:87], a[84:87], v[112:115]
ds_read_b64_tr_b16 v[76:77], v19 offset:27648
v_mfma_f32_16x16x32_bf16 v[116:119], v[84:87], a[88:91], v[116:119]
ds_read_b64_tr_b16 v[78:79], v19 offset:28672
v_mfma_f32_16x16x32_bf16 v[120:123], v[84:87], a[92:95], v[120:123]
buffer_load_dwordx4 a[72:75], v10, s[24:27], s17 offen offset:0 sc1
s_waitcnt lgkmcnt(6)
v_mfma_f32_16x16x32_bf16 v[124:127], v[64:67], a[84:87], v[124:127]
ds_read_b64_tr_b16 v[80:81], v20 offset:27648
v_mfma_f32_16x16x32_bf16 v[128:131], v[64:67], a[88:91], v[128:131]
ds_read_b64_tr_b16 v[82:83], v20 offset:28672
v_mfma_f32_16x16x32_bf16 v[132:135], v[64:67], a[92:95], v[132:135]
buffer_load_dwordx4 a[76:79], v11, s[24:27], s17 offen offset:0 sc1
s_waitcnt lgkmcnt(6)
v_mfma_f32_16x16x32_bf16 v[136:139], v[68:71], a[84:87], v[136:139]
ds_read_b64_tr_b16 v[84:85], v21 offset:27648
v_mfma_f32_16x16x32_bf16 v[140:143], v[68:71], a[88:91], v[140:143]
ds_read_b64_tr_b16 v[86:87], v21 offset:27904
v_mfma_f32_16x16x32_bf16 v[144:147], v[68:71], a[92:95], v[144:147]
buffer_load_dwordx4 a[80:83], v12, s[24:27], s17 offen offset:0 sc1
s_waitcnt lgkmcnt(6)
v_mfma_f32_16x16x32_bf16 v[148:151], v[72:75], a[84:87], v[148:151]
s_barrier
v_add_u32 v13, 0x9000, v13
v_add_u32 v14, 0x9000, v14
v_add_u32 v15, 0x9000, v15
v_add_u32 v16, 0x9000, v16
v_add_u32 v17, 0x9000, v17
v_add_u32 v18, 0x9000, v18
v_add_u32 v19, 0x9000, v19
v_add_u32 v20, 0x9000, v20
v_add_u32 v21, 0x9000, v21
ds_read_b64_tr_b16 v[64:65], v13 offset:0
v_mfma_f32_16x16x32_bf16 v[152:155], v[72:75], a[88:91], v[152:155]
ds_read_b64_tr_b16 v[66:67], v13 offset:1024
v_mfma_f32_16x16x32_bf16 v[156:159], v[72:75], a[92:95], v[156:159]
s_add_u32 m0, s89, 0
s_mov_b32 s16, s90
s_waitcnt lgkmcnt(6)
v_mfma_f32_16x16x32_bf16 v[160:163], v[76:79], a[84:87], v[160:163]
ds_read_b64_tr_b16 v[68:69], v14 offset:0
v_mfma_f32_16x16x32_bf16 v[164:167], v[76:79], a[88:91], v[164:167]
ds_read_b64_tr_b16 v[70:71], v14 offset:1024
v_mfma_f32_16x16x32_bf16 v[168:171], v[76:79], a[92:95], v[168:171]
buffer_load_dwordx4 v22, s[56:59], s16 offen offset:0 lds
s_waitcnt lgkmcnt(6)
v_mfma_f32_16x16x32_bf16 v[172:175], v[80:83], a[84:87], v[172:175]
ds_read_b64_tr_b16 v[72:73], v15 offset:0
v_mfma_f32_16x16x32_bf16 v[176:179], v[80:83], a[88:91], v[176:179]
ds_read_b64_tr_b16 v[74:75], v15 offset:1024
v_mfma_f32_16x16x32_bf16 v[180:183], v[80:83], a[92:95], v[180:183]
buffer_load_dwordx4 v23, s[56:59], s16 offen offset:1024 lds
s_waitcnt lgkmcnt(6)
v_mfma_f32_16x16x32_bf16 v[184:187], v[84:87], a[84:87], v[184:187]
ds_read_b64_tr_b16 v[76:77], v16 offset:0
v_mfma_f32_16x16x32_bf16 v[188:191], v[84:87], a[88:91], v[188:191]
ds_read_b64_tr_b16 v[78:79], v16 offset:1024
v_mfma_f32_16x16x32_bf16 v[192:195], v[84:87], a[92:95], v[192:195]
buffer_load_dwordx4 v24, s[56:59], s16 offen offset:2048 lds
s_waitcnt vmcnt(21) lgkmcnt(6)
v_mfma_f32_16x16x32_bf16 v[88:91], v[64:67], a[0:3], v[88:91]
ds_read_b64_tr_b16 v[80:81], v17 offset:0
v_mfma_f32_16x16x32_bf16 v[92:95], v[64:67], a[4:7], v[92:95]
ds_read_b64_tr_b16 v[82:83], v17 offset:1024
v_mfma_f32_16x16x32_bf16 v[96:99], v[64:67], a[8:11], v[96:99]
buffer_load_dwordx4 v25, s[56:59], s16 offen offset:3072 lds
s_waitcnt lgkmcnt(6)
v_mfma_f32_16x16x32_bf16 v[100:103], v[68:71], a[0:3], v[100:103]
ds_read_b64_tr_b16 v[84:85], v18 offset:0
v_mfma_f32_16x16x32_bf16 v[104:107], v[68:71], a[4:7], v[104:107]
ds_read_b64_tr_b16 v[86:87], v18 offset:1024
v_mfma_f32_16x16x32_bf16 v[108:111], v[68:71], a[8:11], v[108:111]
s_add_u32 m0, s89, 4096
s_nop 0
s_waitcnt lgkmcnt(6)
v_mfma_f32_16x16x32_bf16 v[112:115], v[72:75], a[0:3], v[112:115]
ds_read_b64_tr_b16 v[64:65], v19 offset:0
v_mfma_f32_16x16x32_bf16 v[116:119], v[72:75], a[4:7], v[116:119]
ds_read_b64_tr_b16 v[66:67], v19 offset:1024
v_mfma_f32_16x16x32_bf16 v[120:123], v[72:75], a[8:11], v[120:123]
buffer_load_dwordx4 v26, s[56:59], s16 offen offset:0 lds
s_waitcnt lgkmcnt(6)
v_mfma_f32_16x16x32_bf16 v[124:127], v[76:79], a[0:3], v[124:127]
ds_read_b64_tr_b16 v[68:69], v20 offset:0
v_mfma_f32_16x16x32_bf16 v[128:131], v[76:79], a[4:7], v[128:131]
ds_read_b64_tr_b16 v[70:71], v20 offset:1024
v_mfma_f32_16x16x32_bf16 v[132:135], v[76:79], a[8:11], v[132:135]
buffer_load_dwordx4 v27, s[56:59], s16 offen offset:1024 lds
s_waitcnt lgkmcnt(6)
v_mfma_f32_16x16x32_bf16 v[136:139], v[80:83], a[0:3], v[136:139]
ds_read_b64_tr_b16 v[72:73], v21 offset:0
v_mfma_f32_16x16x32_bf16 v[140:143], v[80:83], a[4:7], v[140:143]
ds_read_b64_tr_b16 v[74:75], v21 offset:256
v_mfma_f32_16x16x32_bf16 v[144:147], v[80:83], a[8:11], v[144:147]
buffer_load_dwordx4 v28, s[56:59], s16 offen offset:2048 lds
s_waitcnt lgkmcnt(6)
v_mfma_f32_16x16x32_bf16 v[148:151], v[84:87], a[0:3], v[148:151]
ds_read_b64_tr_b16 v[76:77], v13 offset:9216
v_mfma_f32_16x16x32_bf16 v[152:155], v[84:87], a[4:7], v[152:155]
ds_read_b64_tr_b16 v[78:79], v13 offset:10240
v_mfma_f32_16x16x32_bf16 v[156:159], v[84:87], a[8:11], v[156:159]
buffer_load_dwordx4 v29, s[56:59], s16 offen offset:3072 lds
s_waitcnt lgkmcnt(6)
v_mfma_f32_16x16x32_bf16 v[160:163], v[64:67], a[0:3], v[160:163]
ds_read_b64_tr_b16 v[80:81], v14 offset:9216
v_mfma_f32_16x16x32_bf16 v[164:167], v[64:67], a[4:7], v[164:167]
ds_read_b64_tr_b16 v[82:83], v14 offset:10240
v_mfma_f32_16x16x32_bf16 v[168:171], v[64:67], a[8:11], v[168:171]
s_add_u32 m0, s89, 8192
s_waitcnt lgkmcnt(6)
v_mfma_f32_16x16x32_bf16 v[172:175], v[68:71], a[0:3], v[172:175]
ds_read_b64_tr_b16 v[84:85], v15 offset:9216
v_mfma_f32_16x16x32_bf16 v[176:179], v[68:71], a[4:7], v[176:179]
ds_read_b64_tr_b16 v[86:87], v15 offset:10240
v_mfma_f32_16x16x32_bf16 v[180:183], v[68:71], a[8:11], v[180:183]
s_add_u32 s90, s90, 147456
buffer_load_dwordx4 v30, s[56:59], s16 offen lds
s_cmp_eq_u32 s90, s91
s_cselect_b32 s90, s92, s90
s_waitcnt lgkmcnt(6)
v_mfma_f32_16x16x32_bf16 v[184:187], v[72:75], a[0:3], v[184:187]
ds_read_b64_tr_b16 v[64:65], v16 offset:9216
v_mfma_f32_16x16x32_bf16 v[188:191], v[72:75], a[4:7], v[188:191]
ds_read_b64_tr_b16 v[66:67], v16 offset:10240
v_mfma_f32_16x16x32_bf16 v[192:195], v[72:75], a[8:11], v[192:195]
buffer_load_dwordx4 a[84:87], v10, s[24:27], s17 offen offset:2048 sc1
s_waitcnt vmcnt(25) lgkmcnt(6)
v_mfma_f32_16x16x32_bf16 v[88:91], v[76:79], a[12:15], v[88:91]
ds_read_b64_tr_b16 v[68:69], v17 offset:9216
v_mfma_f32_16x16x32_bf16 v[92:95], v[76:79], a[16:19], v[92:95]
ds_read_b64_tr_b16 v[70:71], v17 offset:10240
v_mfma_f32_16x16x32_bf16 v[96:99], v[76:79], a[20:23], v[96:99]
buffer_load_dwordx4 a[88:91], v11, s[24:27], s17 offen offset:2048 sc1
s_waitcnt lgkmcnt(6)
v_mfma_f32_16x16x32_bf16 v[100:103], v[80:83], a[12:15], v[100:103]
ds_read_b64_tr_b16 v[72:73], v18 offset:9216
v_mfma_f32_16x16x32_bf16 v[104:107], v[80:83], a[16:19], v[104:107]
ds_read_b64_tr_b16 v[74:75], v18 offset:10240
v_mfma_f32_16x16x32_bf16 v[108:111], v[80:83], a[20:23], v[108:111]
buffer_load_dwordx4 a[92:95], v12, s[24:27], s17 offen offset:2048 sc1
s_waitcnt lgkmcnt(6)
v_mfma_f32_16x16x32_bf16 v[112:115], v[84:87], a[12:15], v[112:115]
ds_read_b64_tr_b16 v[76:77], v19 offset:9216
v_mfma_f32_16x16x32_bf16 v[116:119], v[84:87], a[16:19], v[116:119]
ds_read_b64_tr_b16 v[78:79], v19 offset:10240
v_mfma_f32_16x16x32_bf16 v[120:123], v[84:87], a[20:23], v[120:123]
s_add_u32 s17, s93, s94
s_waitcnt lgkmcnt(6)
v_mfma_f32_16x16x32_bf16 v[124:127], v[64:67], a[12:15], v[124:127]
ds_read_b64_tr_b16 v[80:81], v20 offset:9216
v_mfma_f32_16x16x32_bf16 v[128:131], v[64:67], a[16:19], v[128:131]
ds_read_b64_tr_b16 v[82:83], v20 offset:10240
v_mfma_f32_16x16x32_bf16 v[132:135], v[64:67], a[20:23], v[132:135]
buffer_load_dwordx4 a[0:3], v10, s[24:27], s17 offen offset:0 sc1
s_waitcnt lgkmcnt(6)
v_mfma_f32_16x16x32_bf16 v[136:139], v[68:71], a[12:15], v[136:139]
ds_read_b64_tr_b16 v[84:85], v21 offset:9216
v_mfma_f32_16x16x32_bf16 v[140:143], v[68:71], a[16:19], v[140:143]
ds_read_b64_tr_b16 v[86:87], v21 offset:9472
v_mfma_f32_16x16x32_bf16 v[144:147], v[68:71], a[20:23], v[144:147]
buffer_load_dwordx4 a[4:7], v11, s[24:27], s17 offen offset:0 sc1
s_waitcnt lgkmcnt(6)
v_mfma_f32_16x16x32_bf16 v[148:151], v[72:75], a[12:15], v[148:151]
ds_read_b64_tr_b16 v[64:65], v13 offset:18432
v_mfma_f32_16x16x32_bf16 v[152:155], v[72:75], a[16:19], v[152:155]
ds_read_b64_tr_b16 v[66:67], v13 offset:19456
v_mfma_f32_16x16x32_bf16 v[156:159], v[72:75], a[20:23], v[156:159]
buffer_load_dwordx4 a[8:11], v12, s[24:27], s17 offen offset:0 sc1
s_waitcnt lgkmcnt(6)
v_mfma_f32_16x16x32_bf16 v[160:163], v[76:79], a[12:15], v[160:163]
ds_read_b64_tr_b16 v[68:69], v14 offset:18432
v_mfma_f32_16x16x32_bf16 v[164:167], v[76:79], a[16:19], v[164:167]
ds_read_b64_tr_b16 v[70:71], v14 offset:19456
v_mfma_f32_16x16x32_bf16 v[168:171], v[76:79], a[20:23], v[168:171]
s_waitcnt lgkmcnt(6)
v_mfma_f32_16x16x32_bf16 v[172:175], v[80:83], a[12:15], v[172:175]
ds_read_b64_tr_b16 v[72:73], v15 offset:18432
v_mfma_f32_16x16x32_bf16 v[176:179], v[80:83], a[16:19], v[176:179]
ds_read_b64_tr_b16 v[74:75], v15 offset:19456
v_mfma_f32_16x16x32_bf16 v[180:183], v[80:83], a[20:23], v[180:183]
s_waitcnt lgkmcnt(6)
v_mfma_f32_16x16x32_bf16 v[184:187], v[84:87], a[12:15], v[184:187]
ds_read_b64_tr_b16 v[76:77], v16 offset:18432
v_mfma_f32_16x16x32_bf16 v[188:191], v[84:87], a[16:19], v[188:191]
ds_read_b64_tr_b16 v[78:79], v16 offset:19456
v_mfma_f32_16x16x32_bf16 v[192:195], v[84:87], a[20:23], v[192:195]
s_waitcnt vmcnt(27) lgkmcnt(6)
v_mfma_f32_16x16x32_bf16 v[88:91], v[64:67], a[24:27], v[88:91]
ds_read_b64_tr_b16 v[80:81], v17 offset:18432
v_mfma_f32_16x16x32_bf16 v[92:95], v[64:67], a[28:31], v[92:95]
ds_read_b64_tr_b16 v[82:83], v17 offset:19456
v_mfma_f32_16x16x32_bf16 v[96:99], v[64:67], a[32:35], v[96:99]
s_waitcnt lgkmcnt(6)
v_mfma_f32_16x16x32_bf16 v[100:103], v[68:71], a[24:27], v[100:103]
ds_read_b64_tr_b16 v[84:85], v18 offset:18432
v_mfma_f32_16x16x32_bf16 v[104:107], v[68:71], a[28:31], v[104:107]
ds_read_b64_tr_b16 v[86:87], v18 offset:19456
v_mfma_f32_16x16x32_bf16 v[108:111], v[68:71], a[32:35], v[108:111]
buffer_load_dwordx4 a[12:15], v10, s[24:27], s17 offen offset:2048 sc1
s_waitcnt lgkmcnt(6)
v_mfma_f32_16x16x32_bf16 v[112:115], v[72:75], a[24:27], v[112:115]
ds_read_b64_tr_b16 v[64:65], v19 offset:18432
v_mfma_f32_16x16x32_bf16 v[116:119], v[72:75], a[28:31], v[116:119]
ds_read_b64_tr_b16 v[66:67], v19 offset:19456
v_mfma_f32_16x16x32_bf16 v[120:123], v[72:75], a[32:35], v[120:123]
buffer_load_dwordx4 a[16:19], v11, s[24:27], s17 offen offset:2048 sc1
s_waitcnt lgkmcnt(6)
v_mfma_f32_16x16x32_bf16 v[124:127], v[76:79], a[24:27], v[124:127]
ds_read_b64_tr_b16 v[68:69], v20 offset:18432
v_mfma_f32_16x16x32_bf16 v[128:131], v[76:79], a[28:31], v[128:131]
ds_read_b64_tr_b16 v[70:71], v20 offset:19456
v_mfma_f32_16x16x32_bf16 v[132:135], v[76:79], a[32:35], v[132:135]
buffer_load_dwordx4 a[20:23], v12, s[24:27], s17 offen offset:2048 sc1
s_waitcnt lgkmcnt(6)
v_mfma_f32_16x16x32_bf16 v[136:139], v[80:83], a[24:27], v[136:139]
ds_read_b64_tr_b16 v[72:73], v21 offset:18432
v_mfma_f32_16x16x32_bf16 v[140:143], v[80:83], a[28:31], v[140:143]
ds_read_b64_tr_b16 v[74:75], v21 offset:18688
v_mfma_f32_16x16x32_bf16 v[144:147], v[80:83], a[32:35], v[144:147]
s_waitcnt lgkmcnt(6)
v_mfma_f32_16x16x32_bf16 v[148:151], v[84:87], a[24:27], v[148:151]
ds_read_b64_tr_b16 v[76:77], v13 offset:27648
v_mfma_f32_16x16x32_bf16 v[152:155], v[84:87], a[28:31], v[152:155]
ds_read_b64_tr_b16 v[78:79], v13 offset:28672
v_mfma_f32_16x16x32_bf16 v[156:159], v[84:87], a[32:35], v[156:159]
s_waitcnt lgkmcnt(6)
v_mfma_f32_16x16x32_bf16 v[160:163], v[64:67], a[24:27], v[160:163]
ds_read_b64_tr_b16 v[80:81], v14 offset:27648
v_mfma_f32_16x16x32_bf16 v[164:167], v[64:67], a[28:31], v[164:167]
ds_read_b64_tr_b16 v[82:83], v14 offset:28672
v_mfma_f32_16x16x32_bf16 v[168:171], v[64:67], a[32:35], v[168:171]
s_waitcnt lgkmcnt(6)
v_mfma_f32_16x16x32_bf16 v[172:175], v[68:71], a[24:27], v[172:175]
ds_read_b64_tr_b16 v[84:85], v15 offset:27648
v_mfma_f32_16x16x32_bf16 v[176:179], v[68:71], a[28:31], v[176:179]
ds_read_b64_tr_b16 v[86:87], v15 offset:28672
v_mfma_f32_16x16x32_bf16 v[180:183], v[68:71], a[32:35], v[180:183]
s_waitcnt lgkmcnt(6)
v_mfma_f32_16x16x32_bf16 v[184:187], v[72:75], a[24:27], v[184:187]
ds_read_b64_tr_b16 v[64:65], v16 offset:27648
v_mfma_f32_16x16x32_bf16 v[188:191], v[72:75], a[28:31], v[188:191]
ds_read_b64_tr_b16 v[66:67], v16 offset:28672
v_mfma_f32_16x16x32_bf16 v[192:195], v[72:75], a[32:35], v[192:195]
s_waitcnt vmcnt(27) lgkmcnt(6)
v_mfma_f32_16x16x32_bf16 v[88:91], v[76:79], a[36:39], v[88:91]
ds_read_b64_tr_b16 v[68:69], v17 offset:27648
v_mfma_f32_16x16x32_bf16 v[92:95], v[76:79], a[40:43], v[92:95]
ds_read_b64_tr_b16 v[70:71], v17 offset:28672
v_mfma_f32_16x16x32_bf16 v[96:99], v[76:79], a[44:47], v[96:99]
s_waitcnt lgkmcnt(6)
v_mfma_f32_16x16x32_bf16 v[100:103], v[80:83], a[36:39], v[100:103]
ds_read_b64_tr_b16 v[72:73], v18 offset:27648
v_mfma_f32_16x16x32_bf16 v[104:107], v[80:83], a[40:43], v[104:107]
ds_read_b64_tr_b16 v[74:75], v18 offset:28672
v_mfma_f32_16x16x32_bf16 v[108:111], v[80:83], a[44:47], v[108:111]
s_add_u32 s17, s17, 4096
s_add_u32 s94, s94, 8192
s_and_b32 s94, s94, 0xffff
s_waitcnt lgkmcnt(6)
v_mfma_f32_16x16x32_bf16 v[112:115], v[84:87], a[36:39], v[112:115]
ds_read_b64_tr_b16 v[76:77], v19 offset:27648
v_mfma_f32_16x16x32_bf16 v[116:119], v[84:87], a[40:43], v[116:119]
ds_read_b64_tr_b16 v[78:79], v19 offset:28672
v_mfma_f32_16x16x32_bf16 v[120:123], v[84:87], a[44:47], v[120:123]
buffer_load_dwordx4 a[24:27], v10, s[24:27], s17 offen offset:0 sc1
s_waitcnt lgkmcnt(6)
v_mfma_f32_16x16x32_bf16 v[124:127], v[64:67], a[36:39], v[124:127]
ds_read_b64_tr_b16 v[80:81], v20 offset:27648
v_mfma_f32_16x16x32_bf16 v[128:131], v[64:67], a[40:43], v[128:131]
ds_read_b64_tr_b16 v[82:83], v20 offset:28672
v_mfma_f32_16x16x32_bf16 v[132:135], v[64:67], a[44:47], v[132:135]
buffer_load_dwordx4 a[28:31], v11, s[24:27], s17 offen offset:0 sc1
s_waitcnt lgkmcnt(6)
v_mfma_f32_16x16x32_bf16 v[136:139], v[68:71], a[36:39], v[136:139]
ds_read_b64_tr_b16 v[84:85], v21 offset:27648
v_mfma_f32_16x16x32_bf16 v[140:143], v[68:71], a[40:43], v[140:143]
ds_read_b64_tr_b16 v[86:87], v21 offset:27904
v_mfma_f32_16x16x32_bf16 v[144:147], v[68:71], a[44:47], v[144:147]
buffer_load_dwordx4 a[32:35], v12, s[24:27], s17 offen offset:0 sc1
s_waitcnt lgkmcnt(6)
v_mfma_f32_16x16x32_bf16 v[148:151], v[72:75], a[36:39], v[148:151]
s_barrier
v_add_u32 v13, 0x9000, v13
v_add_u32 v14, 0x9000, v14
v_add_u32 v15, 0x9000, v15
v_add_u32 v16, 0x9000, v16
v_add_u32 v17, 0x9000, v17
v_add_u32 v18, 0x9000, v18
v_add_u32 v19, 0x9000, v19
v_add_u32 v20, 0x9000, v20
v_add_u32 v21, 0x9000, v21
ds_read_b64_tr_b16 v[64:65], v13 offset:0
v_mfma_f32_16x16x32_bf16 v[152:155], v[72:75], a[40:43], v[152:155]
ds_read_b64_tr_b16 v[66:67], v13 offset:1024
v_mfma_f32_16x16x32_bf16 v[156:159], v[72:75], a[44:47], v[156:159]
s_add_u32 m0, s89, 36864
s_mov_b32 s16, s90
s_waitcnt lgkmcnt(6)
v_mfma_f32_16x16x32_bf16 v[160:163], v[76:79], a[36:39], v[160:163]
ds_read_b64_tr_b16 v[68:69], v14 offset:0
v_mfma_f32_16x16x32_bf16 v[164:167], v[76:79], a[40:43], v[164:167]
ds_read_b64_tr_b16 v[70:71], v14 offset:1024
v_mfma_f32_16x16x32_bf16 v[168:171], v[76:79], a[44:47], v[168:171]
buffer_load_dwordx4 v22, s[56:59], s16 offen offset:0 lds
s_waitcnt lgkmcnt(6)
v_mfma_f32_16x16x32_bf16 v[172:175], v[80:83], a[36:39], v[172:175]
ds_read_b64_tr_b16 v[72:73], v15 offset:0
v_mfma_f32_16x16x32_bf16 v[176:179], v[80:83], a[40:43], v[176:179]
ds_read_b64_tr_b16 v[74:75], v15 offset:1024
v_mfma_f32_16x16x32_bf16 v[180:183], v[80:83], a[44:47], v[180:183]
buffer_load_dwordx4 v23, s[56:59], s16 offen offset:1024 lds
s_waitcnt lgkmcnt(6)
v_mfma_f32_16x16x32_bf16 v[184:187], v[84:87], a[36:39], v[184:187]
ds_read_b64_tr_b16 v[76:77], v16 offset:0
v_mfma_f32_16x16x32_bf16 v[188:191], v[84:87], a[40:43], v[188:191]
ds_read_b64_tr_b16 v[78:79], v16 offset:1024
v_mfma_f32_16x16x32_bf16 v[192:195], v[84:87], a[44:47], v[192:195]
buffer_load_dwordx4 v24, s[56:59], s16 offen offset:2048 lds
s_waitcnt vmcnt(30) lgkmcnt(6)
v_mfma_f32_16x16x32_bf16 v[88:91], v[64:67], a[48:51], v[88:91]
ds_read_b64_tr_b16 v[80:81], v17 offset:0
v_mfma_f32_16x16x32_bf16 v[92:95], v[64:67], a[52:55], v[92:95]
ds_read_b64_tr_b16 v[82:83], v17 offset:1024
v_mfma_f32_16x16x32_bf16 v[96:99], v[64:67], a[56:59], v[96:99]
buffer_load_dwordx4 v25, s[56:59], s16 offen offset:3072 lds
s_waitcnt lgkmcnt(6)
v_mfma_f32_16x16x32_bf16 v[100:103], v[68:71], a[48:51], v[100:103]
ds_read_b64_tr_b16 v[84:85], v18 offset:0
v_mfma_f32_16x16x32_bf16 v[104:107], v[68:71], a[52:55], v[104:107]
ds_read_b64_tr_b16 v[86:87], v18 offset:1024
v_mfma_f32_16x16x32_bf16 v[108:111], v[68:71], a[56:59], v[108:111]
s_add_u32 m0, s89, 40960
s_nop 0
s_waitcnt lgkmcnt(6)
v_mfma_f32_16x16x32_bf16 v[112:115], v[72:75], a[48:51], v[112:115]
ds_read_b64_tr_b16 v[64:65], v19 offset:0
v_mfma_f32_16x16x32_bf16 v[116:119], v[72:75], a[52:55], v[116:119]
ds_read_b64_tr_b16 v[66:67], v19 offset:1024
v_mfma_f32_16x16x32_bf16 v[120:123], v[72:75], a[56:59], v[120:123]
buffer_load_dwordx4 v26, s[56:59], s16 offen offset:0 lds
s_waitcnt lgkmcnt(6)
v_mfma_f32_16x16x32_bf16 v[124:127], v[76:79], a[48:51], v[124:127]
ds_read_b64_tr_b16 v[68:69], v20 offset:0
v_mfma_f32_16x16x32_bf16 v[128:131], v[76:79], a[52:55], v[128:131]
ds_read_b64_tr_b16 v[70:71], v20 offset:1024
v_mfma_f32_16x16x32_bf16 v[132:135], v[76:79], a[56:59], v[132:135]
buffer_load_dwordx4 v27, s[56:59], s16 offen offset:1024 lds
s_waitcnt lgkmcnt(6)
v_mfma_f32_16x16x32_bf16 v[136:139], v[80:83], a[48:51], v[136:139]
ds_read_b64_tr_b16 v[72:73], v21 offset:0
v_mfma_f32_16x16x32_bf16 v[140:143], v[80:83], a[52:55], v[140:143]
ds_read_b64_tr_b16 v[74:75], v21 offset:256
v_mfma_f32_16x16x32_bf16 v[144:147], v[80:83], a[56:59], v[144:147]
buffer_load_dwordx4 v28, s[56:59], s16 offen offset:2048 lds
s_waitcnt lgkmcnt(6)
v_mfma_f32_16x16x32_bf16 v[148:151], v[84:87], a[48:51], v[148:151]
ds_read_b64_tr_b16 v[76:77], v13 offset:9216
v_mfma_f32_16x16x32_bf16 v[152:155], v[84:87], a[52:55], v[152:155]
ds_read_b64_tr_b16 v[78:79], v13 offset:10240
v_mfma_f32_16x16x32_bf16 v[156:159], v[84:87], a[56:59], v[156:159]
buffer_load_dwordx4 v29, s[56:59], s16 offen offset:3072 lds
s_waitcnt lgkmcnt(6)
v_mfma_f32_16x16x32_bf16 v[160:163], v[64:67], a[48:51], v[160:163]
ds_read_b64_tr_b16 v[80:81], v14 offset:9216
v_mfma_f32_16x16x32_bf16 v[164:167], v[64:67], a[52:55], v[164:167]
ds_read_b64_tr_b16 v[82:83], v14 offset:10240
v_mfma_f32_16x16x32_bf16 v[168:171], v[64:67], a[56:59], v[168:171]
s_add_u32 m0, s89, 45056
s_waitcnt lgkmcnt(6)
v_mfma_f32_16x16x32_bf16 v[172:175], v[68:71], a[48:51], v[172:175]
ds_read_b64_tr_b16 v[84:85], v15 offset:9216
v_mfma_f32_16x16x32_bf16 v[176:179], v[68:71], a[52:55], v[176:179]
ds_read_b64_tr_b16 v[86:87], v15 offset:10240
v_mfma_f32_16x16x32_bf16 v[180:183], v[68:71], a[56:59], v[180:183]
s_add_u32 s90, s90, 147456
buffer_load_dwordx4 v30, s[56:59], s16 offen lds
s_cmp_eq_u32 s90, s91
s_cselect_b32 s90, s92, s90
s_waitcnt lgkmcnt(6)
v_mfma_f32_16x16x32_bf16 v[184:187], v[72:75], a[48:51], v[184:187]
ds_read_b64_tr_b16 v[64:65], v16 offset:9216
v_mfma_f32_16x16x32_bf16 v[188:191], v[72:75], a[52:55], v[188:191]
ds_read_b64_tr_b16 v[66:67], v16 offset:10240
v_mfma_f32_16x16x32_bf16 v[192:195], v[72:75], a[56:59], v[192:195]
buffer_load_dwordx4 a[36:39], v10, s[24:27], s17 offen offset:2048 sc1
s_waitcnt vmcnt(34) lgkmcnt(6)
v_mfma_f32_16x16x32_bf16 v[88:91], v[76:79], a[60:63], v[88:91]
ds_read_b64_tr_b16 v[68:69], v17 offset:9216
v_mfma_f32_16x16x32_bf16 v[92:95], v[76:79], a[64:67], v[92:95]
ds_read_b64_tr_b16 v[70:71], v17 offset:10240
v_mfma_f32_16x16x32_bf16 v[96:99], v[76:79], a[68:71], v[96:99]
buffer_load_dwordx4 a[40:43], v11, s[24:27], s17 offen offset:2048 sc1
s_waitcnt lgkmcnt(6)
v_mfma_f32_16x16x32_bf16 v[100:103], v[80:83], a[60:63], v[100:103]
ds_read_b64_tr_b16 v[72:73], v18 offset:9216
v_mfma_f32_16x16x32_bf16 v[104:107], v[80:83], a[64:67], v[104:107]
ds_read_b64_tr_b16 v[74:75], v18 offset:10240
v_mfma_f32_16x16x32_bf16 v[108:111], v[80:83], a[68:71], v[108:111]
buffer_load_dwordx4 a[44:47], v12, s[24:27], s17 offen offset:2048 sc1
s_waitcnt lgkmcnt(6)
v_mfma_f32_16x16x32_bf16 v[112:115], v[84:87], a[60:63], v[112:115]
ds_read_b64_tr_b16 v[76:77], v19 offset:9216
v_mfma_f32_16x16x32_bf16 v[116:119], v[84:87], a[64:67], v[116:119]
ds_read_b64_tr_b16 v[78:79], v19 offset:10240
v_mfma_f32_16x16x32_bf16 v[120:123], v[84:87], a[68:71], v[120:123]
s_add_u32 s17, s93, s94
s_waitcnt lgkmcnt(6)
v_mfma_f32_16x16x32_bf16 v[124:127], v[64:67], a[60:63], v[124:127]
ds_read_b64_tr_b16 v[80:81], v20 offset:9216
v_mfma_f32_16x16x32_bf16 v[128:131], v[64:67], a[64:67], v[128:131]
ds_read_b64_tr_b16 v[82:83], v20 offset:10240
v_mfma_f32_16x16x32_bf16 v[132:135], v[64:67], a[68:71], v[132:135]
buffer_load_dwordx4 a[48:51], v10, s[24:27], s17 offen offset:0 sc1
s_waitcnt lgkmcnt(6)
v_mfma_f32_16x16x32_bf16 v[136:139], v[68:71], a[60:63], v[136:139]
ds_read_b64_tr_b16 v[84:85], v21 offset:9216
v_mfma_f32_16x16x32_bf16 v[140:143], v[68:71], a[64:67], v[140:143]
ds_read_b64_tr_b16 v[86:87], v21 offset:9472
v_mfma_f32_16x16x32_bf16 v[144:147], v[68:71], a[68:71], v[144:147]
buffer_load_dwordx4 a[52:55], v11, s[24:27], s17 offen offset:0 sc1
s_waitcnt lgkmcnt(6)
v_mfma_f32_16x16x32_bf16 v[148:151], v[72:75], a[60:63], v[148:151]
ds_read_b64_tr_b16 v[64:65], v13 offset:18432
v_mfma_f32_16x16x32_bf16 v[152:155], v[72:75], a[64:67], v[152:155]
ds_read_b64_tr_b16 v[66:67], v13 offset:19456
v_mfma_f32_16x16x32_bf16 v[156:159], v[72:75], a[68:71], v[156:159]
buffer_load_dwordx4 a[56:59], v12, s[24:27], s17 offen offset:0 sc1
s_waitcnt lgkmcnt(6)
v_mfma_f32_16x16x32_bf16 v[160:163], v[76:79], a[60:63], v[160:163]
ds_read_b64_tr_b16 v[68:69], v14 offset:18432
v_mfma_f32_16x16x32_bf16 v[164:167], v[76:79], a[64:67], v[164:167]
ds_read_b64_tr_b16 v[70:71], v14 offset:19456
v_mfma_f32_16x16x32_bf16 v[168:171], v[76:79], a[68:71], v[168:171]
s_waitcnt lgkmcnt(6)
v_mfma_f32_16x16x32_bf16 v[172:175], v[80:83], a[60:63], v[172:175]
ds_read_b64_tr_b16 v[72:73], v15 offset:18432
v_mfma_f32_16x16x32_bf16 v[176:179], v[80:83], a[64:67], v[176:179]
ds_read_b64_tr_b16 v[74:75], v15 offset:19456
v_mfma_f32_16x16x32_bf16 v[180:183], v[80:83], a[68:71], v[180:183]
s_waitcnt lgkmcnt(6)
v_mfma_f32_16x16x32_bf16 v[184:187], v[84:87], a[60:63], v[184:187]
ds_read_b64_tr_b16 v[76:77], v16 offset:18432
v_mfma_f32_16x16x32_bf16 v[188:191], v[84:87], a[64:67], v[188:191]
ds_read_b64_tr_b16 v[78:79], v16 offset:19456
v_mfma_f32_16x16x32_bf16 v[192:195], v[84:87], a[68:71], v[192:195]
s_waitcnt vmcnt(36) lgkmcnt(6)
v_mfma_f32_16x16x32_bf16 v[88:91], v[64:67], a[72:75], v[88:91]
ds_read_b64_tr_b16 v[80:81], v17 offset:18432
v_mfma_f32_16x16x32_bf16 v[92:95], v[64:67], a[76:79], v[92:95]
ds_read_b64_tr_b16 v[82:83], v17 offset:19456
v_mfma_f32_16x16x32_bf16 v[96:99], v[64:67], a[80:83], v[96:99]
s_waitcnt lgkmcnt(6)
v_mfma_f32_16x16x32_bf16 v[100:103], v[68:71], a[72:75], v[100:103]
ds_read_b64_tr_b16 v[84:85], v18 offset:18432
v_mfma_f32_16x16x32_bf16 v[104:107], v[68:71], a[76:79], v[104:107]
ds_read_b64_tr_b16 v[86:87], v18 offset:19456
v_mfma_f32_16x16x32_bf16 v[108:111], v[68:71], a[80:83], v[108:111]
buffer_load_dwordx4 a[60:63], v10, s[24:27], s17 offen offset:2048 sc1
s_waitcnt lgkmcnt(6)
v_mfma_f32_16x16x32_bf16 v[112:115], v[72:75], a[72:75], v[112:115]
ds_read_b64_tr_b16 v[64:65], v19 offset:18432
v_mfma_f32_16x16x32_bf16 v[116:119], v[72:75], a[76:79], v[116:119]
ds_read_b64_tr_b16 v[66:67], v19 offset:19456
v_mfma_f32_16x16x32_bf16 v[120:123], v[72:75], a[80:83], v[120:123]
buffer_load_dwordx4 a[64:67], v11, s[24:27], s17 offen offset:2048 sc1
s_waitcnt lgkmcnt(6)
v_mfma_f32_16x16x32_bf16 v[124:127], v[76:79], a[72:75], v[124:127]
ds_read_b64_tr_b16 v[68:69], v20 offset:18432
v_mfma_f32_16x16x32_bf16 v[128:131], v[76:79], a[76:79], v[128:131]
ds_read_b64_tr_b16 v[70:71], v20 offset:19456
v_mfma_f32_16x16x32_bf16 v[132:135], v[76:79], a[80:83], v[132:135]
buffer_load_dwordx4 a[68:71], v12, s[24:27], s17 offen offset:2048 sc1
s_waitcnt lgkmcnt(6)
v_mfma_f32_16x16x32_bf16 v[136:139], v[80:83], a[72:75], v[136:139]
ds_read_b64_tr_b16 v[72:73], v21 offset:18432
v_mfma_f32_16x16x32_bf16 v[140:143], v[80:83], a[76:79], v[140:143]
ds_read_b64_tr_b16 v[74:75], v21 offset:18688
v_mfma_f32_16x16x32_bf16 v[144:147], v[80:83], a[80:83], v[144:147]
s_waitcnt lgkmcnt(6)
v_mfma_f32_16x16x32_bf16 v[148:151], v[84:87], a[72:75], v[148:151]
ds_read_b64_tr_b16 v[76:77], v13 offset:27648
v_mfma_f32_16x16x32_bf16 v[152:155], v[84:87], a[76:79], v[152:155]
ds_read_b64_tr_b16 v[78:79], v13 offset:28672
v_mfma_f32_16x16x32_bf16 v[156:159], v[84:87], a[80:83], v[156:159]
s_waitcnt lgkmcnt(6)
v_mfma_f32_16x16x32_bf16 v[160:163], v[64:67], a[72:75], v[160:163]
ds_read_b64_tr_b16 v[80:81], v14 offset:27648
v_mfma_f32_16x16x32_bf16 v[164:167], v[64:67], a[76:79], v[164:167]
ds_read_b64_tr_b16 v[82:83], v14 offset:28672
v_mfma_f32_16x16x32_bf16 v[168:171], v[64:67], a[80:83], v[168:171]
s_waitcnt lgkmcnt(6)
v_mfma_f32_16x16x32_bf16 v[172:175], v[68:71], a[72:75], v[172:175]
ds_read_b64_tr_b16 v[84:85], v15 offset:27648
v_mfma_f32_16x16x32_bf16 v[176:179], v[68:71], a[76:79], v[176:179]
ds_read_b64_tr_b16 v[86:87], v15 offset:28672
v_mfma_f32_16x16x32_bf16 v[180:183], v[68:71], a[80:83], v[180:183]
s_waitcnt lgkmcnt(6)
v_mfma_f32_16x16x32_bf16 v[184:187], v[72:75], a[72:75], v[184:187]
ds_read_b64_tr_b16 v[64:65], v16 offset:27648
v_mfma_f32_16x16x32_bf16 v[188:191], v[72:75], a[76:79], v[188:191]
ds_read_b64_tr_b16 v[66:67], v16 offset:28672
v_mfma_f32_16x16x32_bf16 v[192:195], v[72:75], a[80:83], v[192:195]
s_waitcnt vmcnt(27) lgkmcnt(6)
v_mfma_f32_16x16x32_bf16 v[88:91], v[76:79], a[84:87], v[88:91]
ds_read_b64_tr_b16 v[68:69], v17 offset:27648
v_mfma_f32_16x16x32_bf16 v[92:95], v[76:79], a[88:91], v[92:95]
ds_read_b64_tr_b16 v[70:71], v17 offset:28672
v_mfma_f32_16x16x32_bf16 v[96:99], v[76:79], a[92:95], v[96:99]
s_waitcnt lgkmcnt(6)
v_mfma_f32_16x16x32_bf16 v[100:103], v[80:83], a[84:87], v[100:103]
ds_read_b64_tr_b16 v[72:73], v18 offset:27648
v_mfma_f32_16x16x32_bf16 v[104:107], v[80:83], a[88:91], v[104:107]
ds_read_b64_tr_b16 v[74:75], v18 offset:28672
v_mfma_f32_16x16x32_bf16 v[108:111], v[80:83], a[92:95], v[108:111]
s_add_u32 s17, s17, 4096
s_add_u32 s94, s94, 8192
s_and_b32 s94, s94, 0xffff
s_waitcnt lgkmcnt(6)
v_mfma_f32_16x16x32_bf16 v[112:115], v[84:87], a[84:87], v[112:115]
ds_read_b64_tr_b16 v[76:77], v19 offset:27648
v_mfma_f32_16x16x32_bf16 v[116:119], v[84:87], a[88:91], v[116:119]
ds_read_b64_tr_b16 v[78:79], v19 offset:28672
v_mfma_f32_16x16x32_bf16 v[120:123], v[84:87], a[92:95], v[120:123]
buffer_load_dwordx4 a[72:75], v10, s[24:27], s17 offen offset:0 sc1
s_waitcnt lgkmcnt(6)
v_mfma_f32_16x16x32_bf16 v[124:127], v[64:67], a[84:87], v[124:127]
ds_read_b64_tr_b16 v[80:81], v20 offset:27648
v_mfma_f32_16x16x32_bf16 v[128:131], v[64:67], a[88:91], v[128:131]
ds_read_b64_tr_b16 v[82:83], v20 offset:28672
v_mfma_f32_16x16x32_bf16 v[132:135], v[64:67], a[92:95], v[132:135]
buffer_load_dwordx4 a[76:79], v11, s[24:27], s17 offen offset:0 sc1
s_waitcnt lgkmcnt(6)
v_mfma_f32_16x16x32_bf16 v[136:139], v[68:71], a[84:87], v[136:139]
ds_read_b64_tr_b16 v[84:85], v21 offset:27648
v_mfma_f32_16x16x32_bf16 v[140:143], v[68:71], a[88:91], v[140:143]
ds_read_b64_tr_b16 v[86:87], v21 offset:27904
v_mfma_f32_16x16x32_bf16 v[144:147], v[68:71], a[92:95], v[144:147]
buffer_load_dwordx4 a[80:83], v12, s[24:27], s17 offen offset:0 sc1
s_waitcnt lgkmcnt(6)
v_mfma_f32_16x16x32_bf16 v[148:151], v[72:75], a[84:87], v[148:151]
s_barrier
v_add_u32 v13, 0xfffe5000, v13
v_add_u32 v14, 0xfffe5000, v14
v_add_u32 v15, 0xfffe5000, v15
v_add_u32 v16, 0xfffe5000, v16
v_add_u32 v17, 0xfffe5000, v17
v_add_u32 v18, 0xfffe5000, v18
v_add_u32 v19, 0xfffe5000, v19
v_add_u32 v20, 0xfffe5000, v20
v_add_u32 v21, 0xfffe5000, v21
ds_read_b64_tr_b16 v[64:65], v13 offset:0
v_mfma_f32_16x16x32_bf16 v[152:155], v[72:75], a[88:91], v[152:155]
ds_read_b64_tr_b16 v[66:67], v13 offset:1024
v_mfma_f32_16x16x32_bf16 v[156:159], v[72:75], a[92:95], v[156:159]
s_add_u32 m0, s89, 73728
s_mov_b32 s16, s90
s_waitcnt lgkmcnt(6)
v_mfma_f32_16x16x32_bf16 v[160:163], v[76:79], a[84:87], v[160:163]
ds_read_b64_tr_b16 v[68:69], v14 offset:0
v_mfma_f32_16x16x32_bf16 v[164:167], v[76:79], a[88:91], v[164:167]
ds_read_b64_tr_b16 v[70:71], v14 offset:1024
v_mfma_f32_16x16x32_bf16 v[168:171], v[76:79], a[92:95], v[168:171]
buffer_load_dwordx4 v22, s[56:59], s16 offen offset:0 lds
s_waitcnt lgkmcnt(6)
v_mfma_f32_16x16x32_bf16 v[172:175], v[80:83], a[84:87], v[172:175]
ds_read_b64_tr_b16 v[72:73], v15 offset:0
v_mfma_f32_16x16x32_bf16 v[176:179], v[80:83], a[88:91], v[176:179]
ds_read_b64_tr_b16 v[74:75], v15 offset:1024
v_mfma_f32_16x16x32_bf16 v[180:183], v[80:83], a[92:95], v[180:183]
buffer_load_dwordx4 v23, s[56:59], s16 offen offset:1024 lds
s_waitcnt lgkmcnt(6)
v_mfma_f32_16x16x32_bf16 v[184:187], v[84:87], a[84:87], v[184:187]
ds_read_b64_tr_b16 v[76:77], v16 offset:0
v_mfma_f32_16x16x32_bf16 v[188:191], v[84:87], a[88:91], v[188:191]
ds_read_b64_tr_b16 v[78:79], v16 offset:1024
v_mfma_f32_16x16x32_bf16 v[192:195], v[84:87], a[92:95], v[192:195]
buffer_load_dwordx4 v24, s[56:59], s16 offen offset:2048 lds
s_waitcnt vmcnt(30) lgkmcnt(6)
v_mfma_f32_16x16x32_bf16 v[88:91], v[64:67], a[0:3], v[88:91]
ds_read_b64_tr_b16 v[80:81], v17 offset:0
v_mfma_f32_16x16x32_bf16 v[92:95], v[64:67], a[4:7], v[92:95]
ds_read_b64_tr_b16 v[82:83], v17 offset:1024
v_mfma_f32_16x16x32_bf16 v[96:99], v[64:67], a[8:11], v[96:99]
buffer_load_dwordx4 v25, s[56:59], s16 offen offset:3072 lds
s_waitcnt lgkmcnt(6)
v_mfma_f32_16x16x32_bf16 v[100:103], v[68:71], a[0:3], v[100:103]
ds_read_b64_tr_b16 v[84:85], v18 offset:0
v_mfma_f32_16x16x32_bf16 v[104:107], v[68:71], a[4:7], v[104:107]
ds_read_b64_tr_b16 v[86:87], v18 offset:1024
v_mfma_f32_16x16x32_bf16 v[108:111], v[68:71], a[8:11], v[108:111]
s_add_u32 m0, s89, 77824
s_nop 0
s_waitcnt lgkmcnt(6)
v_mfma_f32_16x16x32_bf16 v[112:115], v[72:75], a[0:3], v[112:115]
ds_read_b64_tr_b16 v[64:65], v19 offset:0
v_mfma_f32_16x16x32_bf16 v[116:119], v[72:75], a[4:7], v[116:119]
ds_read_b64_tr_b16 v[66:67], v19 offset:1024
v_mfma_f32_16x16x32_bf16 v[120:123], v[72:75], a[8:11], v[120:123]
buffer_load_dwordx4 v26, s[56:59], s16 offen offset:0 lds
s_waitcnt lgkmcnt(6)
v_mfma_f32_16x16x32_bf16 v[124:127], v[76:79], a[0:3], v[124:127]
ds_read_b64_tr_b16 v[68:69], v20 offset:0
v_mfma_f32_16x16x32_bf16 v[128:131], v[76:79], a[4:7], v[128:131]
ds_read_b64_tr_b16 v[70:71], v20 offset:1024
v_mfma_f32_16x16x32_bf16 v[132:135], v[76:79], a[8:11], v[132:135]
buffer_load_dwordx4 v27, s[56:59], s16 offen offset:1024 lds
s_waitcnt lgkmcnt(6)
v_mfma_f32_16x16x32_bf16 v[136:139], v[80:83], a[0:3], v[136:139]
ds_read_b64_tr_b16 v[72:73], v21 offset:0
v_mfma_f32_16x16x32_bf16 v[140:143], v[80:83], a[4:7], v[140:143]
ds_read_b64_tr_b16 v[74:75], v21 offset:256
v_mfma_f32_16x16x32_bf16 v[144:147], v[80:83], a[8:11], v[144:147]
buffer_load_dwordx4 v28, s[56:59], s16 offen offset:2048 lds
s_waitcnt lgkmcnt(6)
v_mfma_f32_16x16x32_bf16 v[148:151], v[84:87], a[0:3], v[148:151]
ds_read_b64_tr_b16 v[76:77], v13 offset:9216
v_mfma_f32_16x16x32_bf16 v[152:155], v[84:87], a[4:7], v[152:155]
ds_read_b64_tr_b16 v[78:79], v13 offset:10240
v_mfma_f32_16x16x32_bf16 v[156:159], v[84:87], a[8:11], v[156:159]
buffer_load_dwordx4 v29, s[56:59], s16 offen offset:3072 lds
s_waitcnt lgkmcnt(6)
v_mfma_f32_16x16x32_bf16 v[160:163], v[64:67], a[0:3], v[160:163]
ds_read_b64_tr_b16 v[80:81], v14 offset:9216
v_mfma_f32_16x16x32_bf16 v[164:167], v[64:67], a[4:7], v[164:167]
ds_read_b64_tr_b16 v[82:83], v14 offset:10240
v_mfma_f32_16x16x32_bf16 v[168:171], v[64:67], a[8:11], v[168:171]
s_add_u32 m0, s89, 81920
s_waitcnt lgkmcnt(6)
v_mfma_f32_16x16x32_bf16 v[172:175], v[68:71], a[0:3], v[172:175]
ds_read_b64_tr_b16 v[84:85], v15 offset:9216
v_mfma_f32_16x16x32_bf16 v[176:179], v[68:71], a[4:7], v[176:179]
ds_read_b64_tr_b16 v[86:87], v15 offset:10240
v_mfma_f32_16x16x32_bf16 v[180:183], v[68:71], a[8:11], v[180:183]
s_add_u32 s90, s90, 147456
buffer_load_dwordx4 v30, s[56:59], s16 offen lds
s_cmp_eq_u32 s90, s91
s_cselect_b32 s90, s92, s90
s_waitcnt lgkmcnt(6)
v_mfma_f32_16x16x32_bf16 v[184:187], v[72:75], a[0:3], v[184:187]
ds_read_b64_tr_b16 v[64:65], v16 offset:9216
v_mfma_f32_16x16x32_bf16 v[188:191], v[72:75], a[4:7], v[188:191]
ds_read_b64_tr_b16 v[66:67], v16 offset:10240
v_mfma_f32_16x16x32_bf16 v[192:195], v[72:75], a[8:11], v[192:195]
buffer_load_dwordx4 a[84:87], v10, s[24:27], s17 offen offset:2048 sc1
s_waitcnt vmcnt(34) lgkmcnt(6)
v_mfma_f32_16x16x32_bf16 v[88:91], v[76:79], a[12:15], v[88:91]
ds_read_b64_tr_b16 v[68:69], v17 offset:9216
v_mfma_f32_16x16x32_bf16 v[92:95], v[76:79], a[16:19], v[92:95]
ds_read_b64_tr_b16 v[70:71], v17 offset:10240
v_mfma_f32_16x16x32_bf16 v[96:99], v[76:79], a[20:23], v[96:99]
buffer_load_dwordx4 a[88:91], v11, s[24:27], s17 offen offset:2048 sc1
s_waitcnt lgkmcnt(6)
v_mfma_f32_16x16x32_bf16 v[100:103], v[80:83], a[12:15], v[100:103]
ds_read_b64_tr_b16 v[72:73], v18 offset:9216
v_mfma_f32_16x16x32_bf16 v[104:107], v[80:83], a[16:19], v[104:107]
ds_read_b64_tr_b16 v[74:75], v18 offset:10240
v_mfma_f32_16x16x32_bf16 v[108:111], v[80:83], a[20:23], v[108:111]
buffer_load_dwordx4 a[92:95], v12, s[24:27], s17 offen offset:2048 sc1
s_waitcnt lgkmcnt(6)
v_mfma_f32_16x16x32_bf16 v[112:115], v[84:87], a[12:15], v[112:115]
ds_read_b64_tr_b16 v[76:77], v19 offset:9216
v_mfma_f32_16x16x32_bf16 v[116:119], v[84:87], a[16:19], v[116:119]
ds_read_b64_tr_b16 v[78:79], v19 offset:10240
v_mfma_f32_16x16x32_bf16 v[120:123], v[84:87], a[20:23], v[120:123]
s_add_u32 s17, s93, s94
s_waitcnt lgkmcnt(6)
v_mfma_f32_16x16x32_bf16 v[124:127], v[64:67], a[12:15], v[124:127]
ds_read_b64_tr_b16 v[80:81], v20 offset:9216
v_mfma_f32_16x16x32_bf16 v[128:131], v[64:67], a[16:19], v[128:131]
ds_read_b64_tr_b16 v[82:83], v20 offset:10240
v_mfma_f32_16x16x32_bf16 v[132:135], v[64:67], a[20:23], v[132:135]
buffer_load_dwordx4 a[0:3], v10, s[24:27], s17 offen offset:0 sc1
s_waitcnt lgkmcnt(6)
v_mfma_f32_16x16x32_bf16 v[136:139], v[68:71], a[12:15], v[136:139]
ds_read_b64_tr_b16 v[84:85], v21 offset:9216
v_mfma_f32_16x16x32_bf16 v[140:143], v[68:71], a[16:19], v[140:143]
ds_read_b64_tr_b16 v[86:87], v21 offset:9472
v_mfma_f32_16x16x32_bf16 v[144:147], v[68:71], a[20:23], v[144:147]
buffer_load_dwordx4 a[4:7], v11, s[24:27], s17 offen offset:0 sc1
s_waitcnt lgkmcnt(6)
v_mfma_f32_16x16x32_bf16 v[148:151], v[72:75], a[12:15], v[148:151]
ds_read_b64_tr_b16 v[64:65], v13 offset:18432
v_mfma_f32_16x16x32_bf16 v[152:155], v[72:75], a[16:19], v[152:155]
ds_read_b64_tr_b16 v[66:67], v13 offset:19456
v_mfma_f32_16x16x32_bf16 v[156:159], v[72:75], a[20:23], v[156:159]
buffer_load_dwordx4 a[8:11], v12, s[24:27], s17 offen offset:0 sc1
s_waitcnt lgkmcnt(6)
v_mfma_f32_16x16x32_bf16 v[160:163], v[76:79], a[12:15], v[160:163]
ds_read_b64_tr_b16 v[68:69], v14 offset:18432
v_mfma_f32_16x16x32_bf16 v[164:167], v[76:79], a[16:19], v[164:167]
ds_read_b64_tr_b16 v[70:71], v14 offset:19456
v_mfma_f32_16x16x32_bf16 v[168:171], v[76:79], a[20:23], v[168:171]
s_waitcnt lgkmcnt(6)
v_mfma_f32_16x16x32_bf16 v[172:175], v[80:83], a[12:15], v[172:175]
ds_read_b64_tr_b16 v[72:73], v15 offset:18432
v_mfma_f32_16x16x32_bf16 v[176:179], v[80:83], a[16:19], v[176:179]
ds_read_b64_tr_b16 v[74:75], v15 offset:19456
v_mfma_f32_16x16x32_bf16 v[180:183], v[80:83], a[20:23], v[180:183]
s_waitcnt lgkmcnt(6)
v_mfma_f32_16x16x32_bf16 v[184:187], v[84:87], a[12:15], v[184:187]
ds_read_b64_tr_b16 v[76:77], v16 offset:18432
v_mfma_f32_16x16x32_bf16 v[188:191], v[84:87], a[16:19], v[188:191]
ds_read_b64_tr_b16 v[78:79], v16 offset:19456
v_mfma_f32_16x16x32_bf16 v[192:195], v[84:87], a[20:23], v[192:195]
s_waitcnt vmcnt(36) lgkmcnt(6)
v_mfma_f32_16x16x32_bf16 v[88:91], v[64:67], a[24:27], v[88:91]
ds_read_b64_tr_b16 v[80:81], v17 offset:18432
v_mfma_f32_16x16x32_bf16 v[92:95], v[64:67], a[28:31], v[92:95]
ds_read_b64_tr_b16 v[82:83], v17 offset:19456
v_mfma_f32_16x16x32_bf16 v[96:99], v[64:67], a[32:35], v[96:99]
s_waitcnt lgkmcnt(6)
v_mfma_f32_16x16x32_bf16 v[100:103], v[68:71], a[24:27], v[100:103]
ds_read_b64_tr_b16 v[84:85], v18 offset:18432
v_mfma_f32_16x16x32_bf16 v[104:107], v[68:71], a[28:31], v[104:107]
ds_read_b64_tr_b16 v[86:87], v18 offset:19456
v_mfma_f32_16x16x32_bf16 v[108:111], v[68:71], a[32:35], v[108:111]
buffer_load_dwordx4 a[12:15], v10, s[24:27], s17 offen offset:2048 sc1
s_waitcnt lgkmcnt(6)
v_mfma_f32_16x16x32_bf16 v[112:115], v[72:75], a[24:27], v[112:115]
ds_read_b64_tr_b16 v[64:65], v19 offset:18432
v_mfma_f32_16x16x32_bf16 v[116:119], v[72:75], a[28:31], v[116:119]
ds_read_b64_tr_b16 v[66:67], v19 offset:19456
v_mfma_f32_16x16x32_bf16 v[120:123], v[72:75], a[32:35], v[120:123]
buffer_load_dwordx4 a[16:19], v11, s[24:27], s17 offen offset:2048 sc1
s_waitcnt lgkmcnt(6)
v_mfma_f32_16x16x32_bf16 v[124:127], v[76:79], a[24:27], v[124:127]
ds_read_b64_tr_b16 v[68:69], v20 offset:18432
v_mfma_f32_16x16x32_bf16 v[128:131], v[76:79], a[28:31], v[128:131]
ds_read_b64_tr_b16 v[70:71], v20 offset:19456
v_mfma_f32_16x16x32_bf16 v[132:135], v[76:79], a[32:35], v[132:135]
buffer_load_dwordx4 a[20:23], v12, s[24:27], s17 offen offset:2048 sc1
s_waitcnt lgkmcnt(6)
v_mfma_f32_16x16x32_bf16 v[136:139], v[80:83], a[24:27], v[136:139]
ds_read_b64_tr_b16 v[72:73], v21 offset:18432
v_mfma_f32_16x16x32_bf16 v[140:143], v[80:83], a[28:31], v[140:143]
ds_read_b64_tr_b16 v[74:75], v21 offset:18688
v_mfma_f32_16x16x32_bf16 v[144:147], v[80:83], a[32:35], v[144:147]
s_waitcnt lgkmcnt(6)
v_mfma_f32_16x16x32_bf16 v[148:151], v[84:87], a[24:27], v[148:151]
ds_read_b64_tr_b16 v[76:77], v13 offset:27648
v_mfma_f32_16x16x32_bf16 v[152:155], v[84:87], a[28:31], v[152:155]
ds_read_b64_tr_b16 v[78:79], v13 offset:28672
v_mfma_f32_16x16x32_bf16 v[156:159], v[84:87], a[32:35], v[156:159]
s_waitcnt lgkmcnt(6)
v_mfma_f32_16x16x32_bf16 v[160:163], v[64:67], a[24:27], v[160:163]
ds_read_b64_tr_b16 v[80:81], v14 offset:27648
v_mfma_f32_16x16x32_bf16 v[164:167], v[64:67], a[28:31], v[164:167]
ds_read_b64_tr_b16 v[82:83], v14 offset:28672
v_mfma_f32_16x16x32_bf16 v[168:171], v[64:67], a[32:35], v[168:171]
s_waitcnt lgkmcnt(6)
v_mfma_f32_16x16x32_bf16 v[172:175], v[68:71], a[24:27], v[172:175]
ds_read_b64_tr_b16 v[84:85], v15 offset:27648
v_mfma_f32_16x16x32_bf16 v[176:179], v[68:71], a[28:31], v[176:179]
ds_read_b64_tr_b16 v[86:87], v15 offset:28672
v_mfma_f32_16x16x32_bf16 v[180:183], v[68:71], a[32:35], v[180:183]
s_waitcnt lgkmcnt(6)
v_mfma_f32_16x16x32_bf16 v[184:187], v[72:75], a[24:27], v[184:187]
ds_read_b64_tr_b16 v[64:65], v16 offset:27648
v_mfma_f32_16x16x32_bf16 v[188:191], v[72:75], a[28:31], v[188:191]
ds_read_b64_tr_b16 v[66:67], v16 offset:28672
v_mfma_f32_16x16x32_bf16 v[192:195], v[72:75], a[32:35], v[192:195]
s_waitcnt vmcnt(27) lgkmcnt(6)
v_mfma_f32_16x16x32_bf16 v[88:91], v[76:79], a[36:39], v[88:91]
ds_read_b64_tr_b16 v[68:69], v17 offset:27648
v_mfma_f32_16x16x32_bf16 v[92:95], v[76:79], a[40:43], v[92:95]
ds_read_b64_tr_b16 v[70:71], v17 offset:28672
v_mfma_f32_16x16x32_bf16 v[96:99], v[76:79], a[44:47], v[96:99]
s_waitcnt lgkmcnt(6)
v_mfma_f32_16x16x32_bf16 v[100:103], v[80:83], a[36:39], v[100:103]
ds_read_b64_tr_b16 v[72:73], v18 offset:27648
v_mfma_f32_16x16x32_bf16 v[104:107], v[80:83], a[40:43], v[104:107]
ds_read_b64_tr_b16 v[74:75], v18 offset:28672
v_mfma_f32_16x16x32_bf16 v[108:111], v[80:83], a[44:47], v[108:111]
s_add_u32 s17, s17, 4096
s_add_u32 s94, s94, 8192
s_and_b32 s94, s94, 0xffff
s_waitcnt lgkmcnt(6)
v_mfma_f32_16x16x32_bf16 v[112:115], v[84:87], a[36:39], v[112:115]
ds_read_b64_tr_b16 v[76:77], v19 offset:27648
v_mfma_f32_16x16x32_bf16 v[116:119], v[84:87], a[40:43], v[116:119]
ds_read_b64_tr_b16 v[78:79], v19 offset:28672
v_mfma_f32_16x16x32_bf16 v[120:123], v[84:87], a[44:47], v[120:123]
buffer_load_dwordx4 a[24:27], v10, s[24:27], s17 offen offset:0 sc1
s_waitcnt lgkmcnt(6)
v_mfma_f32_16x16x32_bf16 v[124:127], v[64:67], a[36:39], v[124:127]
ds_read_b64_tr_b16 v[80:81], v20 offset:27648
v_mfma_f32_16x16x32_bf16 v[128:131], v[64:67], a[40:43], v[128:131]
ds_read_b64_tr_b16 v[82:83], v20 offset:28672
v_mfma_f32_16x16x32_bf16 v[132:135], v[64:67], a[44:47], v[132:135]
buffer_load_dwordx4 a[28:31], v11, s[24:27], s17 offen offset:0 sc1
s_waitcnt lgkmcnt(6)
v_mfma_f32_16x16x32_bf16 v[136:139], v[68:71], a[36:39], v[136:139]
ds_read_b64_tr_b16 v[84:85], v21 offset:27648
v_mfma_f32_16x16x32_bf16 v[140:143], v[68:71], a[40:43], v[140:143]
ds_read_b64_tr_b16 v[86:87], v21 offset:27904
v_mfma_f32_16x16x32_bf16 v[144:147], v[68:71], a[44:47], v[144:147]
buffer_load_dwordx4 a[32:35], v12, s[24:27], s17 offen offset:0 sc1
s_waitcnt lgkmcnt(6)
v_mfma_f32_16x16x32_bf16 v[148:151], v[72:75], a[36:39], v[148:151]
s_barrier
v_add_u32 v13, 0x9000, v13
v_add_u32 v14, 0x9000, v14
v_add_u32 v15, 0x9000, v15
v_add_u32 v16, 0x9000, v16
v_add_u32 v17, 0x9000, v17
v_add_u32 v18, 0x9000, v18
v_add_u32 v19, 0x9000, v19
v_add_u32 v20, 0x9000, v20
v_add_u32 v21, 0x9000, v21
ds_read_b64_tr_b16 v[64:65], v13 offset:0
v_mfma_f32_16x16x32_bf16 v[152:155], v[72:75], a[40:43], v[152:155]
ds_read_b64_tr_b16 v[66:67], v13 offset:1024
v_mfma_f32_16x16x32_bf16 v[156:159], v[72:75], a[44:47], v[156:159]
s_add_u32 m0, s89, 110592
s_mov_b32 s16, s90
s_waitcnt lgkmcnt(6)
v_mfma_f32_16x16x32_bf16 v[160:163], v[76:79], a[36:39], v[160:163]
ds_read_b64_tr_b16 v[68:69], v14 offset:0
v_mfma_f32_16x16x32_bf16 v[164:167], v[76:79], a[40:43], v[164:167]
ds_read_b64_tr_b16 v[70:71], v14 offset:1024
v_mfma_f32_16x16x32_bf16 v[168:171], v[76:79], a[44:47], v[168:171]
buffer_load_dwordx4 v22, s[56:59], s16 offen offset:0 lds
s_waitcnt lgkmcnt(6)
v_mfma_f32_16x16x32_bf16 v[172:175], v[80:83], a[36:39], v[172:175]
ds_read_b64_tr_b16 v[72:73], v15 offset:0
v_mfma_f32_16x16x32_bf16 v[176:179], v[80:83], a[40:43], v[176:179]
ds_read_b64_tr_b16 v[74:75], v15 offset:1024
v_mfma_f32_16x16x32_bf16 v[180:183], v[80:83], a[44:47], v[180:183]
buffer_load_dwordx4 v23, s[56:59], s16 offen offset:1024 lds
s_waitcnt lgkmcnt(6)
v_mfma_f32_16x16x32_bf16 v[184:187], v[84:87], a[36:39], v[184:187]
ds_read_b64_tr_b16 v[76:77], v16 offset:0
v_mfma_f32_16x16x32_bf16 v[188:191], v[84:87], a[40:43], v[188:191]
ds_read_b64_tr_b16 v[78:79], v16 offset:1024
v_mfma_f32_16x16x32_bf16 v[192:195], v[84:87], a[44:47], v[192:195]
buffer_load_dwordx4 v24, s[56:59], s16 offen offset:2048 lds
s_waitcnt vmcnt(30) lgkmcnt(6)
v_mfma_f32_16x16x32_bf16 v[88:91], v[64:67], a[48:51], v[88:91]
ds_read_b64_tr_b16 v[80:81], v17 offset:0
v_mfma_f32_16x16x32_bf16 v[92:95], v[64:67], a[52:55], v[92:95]
ds_read_b64_tr_b16 v[82:83], v17 offset:1024
v_mfma_f32_16x16x32_bf16 v[96:99], v[64:67], a[56:59], v[96:99]
buffer_load_dwordx4 v25, s[56:59], s16 offen offset:3072 lds
s_waitcnt lgkmcnt(6)
v_mfma_f32_16x16x32_bf16 v[100:103], v[68:71], a[48:51], v[100:103]
ds_read_b64_tr_b16 v[84:85], v18 offset:0
v_mfma_f32_16x16x32_bf16 v[104:107], v[68:71], a[52:55], v[104:107]
ds_read_b64_tr_b16 v[86:87], v18 offset:1024
v_mfma_f32_16x16x32_bf16 v[108:111], v[68:71], a[56:59], v[108:111]
s_add_u32 m0, s89, 114688
s_nop 0
s_waitcnt lgkmcnt(6)
v_mfma_f32_16x16x32_bf16 v[112:115], v[72:75], a[48:51], v[112:115]
ds_read_b64_tr_b16 v[64:65], v19 offset:0
v_mfma_f32_16x16x32_bf16 v[116:119], v[72:75], a[52:55], v[116:119]
ds_read_b64_tr_b16 v[66:67], v19 offset:1024
v_mfma_f32_16x16x32_bf16 v[120:123], v[72:75], a[56:59], v[120:123]
buffer_load_dwordx4 v26, s[56:59], s16 offen offset:0 lds
s_waitcnt lgkmcnt(6)
v_mfma_f32_16x16x32_bf16 v[124:127], v[76:79], a[48:51], v[124:127]
ds_read_b64_tr_b16 v[68:69], v20 offset:0
v_mfma_f32_16x16x32_bf16 v[128:131], v[76:79], a[52:55], v[128:131]
ds_read_b64_tr_b16 v[70:71], v20 offset:1024
v_mfma_f32_16x16x32_bf16 v[132:135], v[76:79], a[56:59], v[132:135]
buffer_load_dwordx4 v27, s[56:59], s16 offen offset:1024 lds
s_waitcnt lgkmcnt(6)
v_mfma_f32_16x16x32_bf16 v[136:139], v[80:83], a[48:51], v[136:139]
ds_read_b64_tr_b16 v[72:73], v21 offset:0
v_mfma_f32_16x16x32_bf16 v[140:143], v[80:83], a[52:55], v[140:143]
ds_read_b64_tr_b16 v[74:75], v21 offset:256
v_mfma_f32_16x16x32_bf16 v[144:147], v[80:83], a[56:59], v[144:147]
buffer_load_dwordx4 v28, s[56:59], s16 offen offset:2048 lds
s_waitcnt lgkmcnt(6)
v_mfma_f32_16x16x32_bf16 v[148:151], v[84:87], a[48:51], v[148:151]
ds_read_b64_tr_b16 v[76:77], v13 offset:9216
v_mfma_f32_16x16x32_bf16 v[152:155], v[84:87], a[52:55], v[152:155]
ds_read_b64_tr_b16 v[78:79], v13 offset:10240
v_mfma_f32_16x16x32_bf16 v[156:159], v[84:87], a[56:59], v[156:159]
buffer_load_dwordx4 v29, s[56:59], s16 offen offset:3072 lds
s_waitcnt lgkmcnt(6)
v_mfma_f32_16x16x32_bf16 v[160:163], v[64:67], a[48:51], v[160:163]
ds_read_b64_tr_b16 v[80:81], v14 offset:9216
v_mfma_f32_16x16x32_bf16 v[164:167], v[64:67], a[52:55], v[164:167]
ds_read_b64_tr_b16 v[82:83], v14 offset:10240
v_mfma_f32_16x16x32_bf16 v[168:171], v[64:67], a[56:59], v[168:171]
s_add_u32 m0, s89, 118784
s_waitcnt lgkmcnt(6)
v_mfma_f32_16x16x32_bf16 v[172:175], v[68:71], a[48:51], v[172:175]
ds_read_b64_tr_b16 v[84:85], v15 offset:9216
v_mfma_f32_16x16x32_bf16 v[176:179], v[68:71], a[52:55], v[176:179]
ds_read_b64_tr_b16 v[86:87], v15 offset:10240
v_mfma_f32_16x16x32_bf16 v[180:183], v[68:71], a[56:59], v[180:183]
s_add_u32 s90, s90, 147456
buffer_load_dwordx4 v30, s[56:59], s16 offen lds
s_cmp_eq_u32 s90, s91
s_cselect_b32 s90, s92, s90
s_waitcnt lgkmcnt(6)
v_mfma_f32_16x16x32_bf16 v[184:187], v[72:75], a[48:51], v[184:187]
ds_read_b64_tr_b16 v[64:65], v16 offset:9216
v_mfma_f32_16x16x32_bf16 v[188:191], v[72:75], a[52:55], v[188:191]
ds_read_b64_tr_b16 v[66:67], v16 offset:10240
v_mfma_f32_16x16x32_bf16 v[192:195], v[72:75], a[56:59], v[192:195]
buffer_load_dwordx4 a[36:39], v10, s[24:27], s17 offen offset:2048 sc1
s_waitcnt vmcnt(34) lgkmcnt(6)
v_mfma_f32_16x16x32_bf16 v[88:91], v[76:79], a[60:63], v[88:91]
ds_read_b64_tr_b16 v[68:69], v17 offset:9216
v_mfma_f32_16x16x32_bf16 v[92:95], v[76:79], a[64:67], v[92:95]
ds_read_b64_tr_b16 v[70:71], v17 offset:10240
v_mfma_f32_16x16x32_bf16 v[96:99], v[76:79], a[68:71], v[96:99]
buffer_load_dwordx4 a[40:43], v11, s[24:27], s17 offen offset:2048 sc1
s_waitcnt lgkmcnt(6)
v_mfma_f32_16x16x32_bf16 v[100:103], v[80:83], a[60:63], v[100:103]
ds_read_b64_tr_b16 v[72:73], v18 offset:9216
v_mfma_f32_16x16x32_bf16 v[104:107], v[80:83], a[64:67], v[104:107]
ds_read_b64_tr_b16 v[74:75], v18 offset:10240
v_mfma_f32_16x16x32_bf16 v[108:111], v[80:83], a[68:71], v[108:111]
buffer_load_dwordx4 a[44:47], v12, s[24:27], s17 offen offset:2048 sc1
s_waitcnt lgkmcnt(6)
v_mfma_f32_16x16x32_bf16 v[112:115], v[84:87], a[60:63], v[112:115]
ds_read_b64_tr_b16 v[76:77], v19 offset:9216
v_mfma_f32_16x16x32_bf16 v[116:119], v[84:87], a[64:67], v[116:119]
ds_read_b64_tr_b16 v[78:79], v19 offset:10240
v_mfma_f32_16x16x32_bf16 v[120:123], v[84:87], a[68:71], v[120:123]
s_add_u32 s17, s93, s94
s_waitcnt lgkmcnt(6)
v_mfma_f32_16x16x32_bf16 v[124:127], v[64:67], a[60:63], v[124:127]
ds_read_b64_tr_b16 v[80:81], v20 offset:9216
v_mfma_f32_16x16x32_bf16 v[128:131], v[64:67], a[64:67], v[128:131]
ds_read_b64_tr_b16 v[82:83], v20 offset:10240
v_mfma_f32_16x16x32_bf16 v[132:135], v[64:67], a[68:71], v[132:135]
buffer_load_dwordx4 a[48:51], v10, s[24:27], s17 offen offset:0 sc1
s_waitcnt lgkmcnt(6)
v_mfma_f32_16x16x32_bf16 v[136:139], v[68:71], a[60:63], v[136:139]
ds_read_b64_tr_b16 v[84:85], v21 offset:9216
v_mfma_f32_16x16x32_bf16 v[140:143], v[68:71], a[64:67], v[140:143]
ds_read_b64_tr_b16 v[86:87], v21 offset:9472
v_mfma_f32_16x16x32_bf16 v[144:147], v[68:71], a[68:71], v[144:147]
buffer_load_dwordx4 a[52:55], v11, s[24:27], s17 offen offset:0 sc1
s_waitcnt lgkmcnt(6)
v_mfma_f32_16x16x32_bf16 v[148:151], v[72:75], a[60:63], v[148:151]
ds_read_b64_tr_b16 v[64:65], v13 offset:18432
v_mfma_f32_16x16x32_bf16 v[152:155], v[72:75], a[64:67], v[152:155]
ds_read_b64_tr_b16 v[66:67], v13 offset:19456
v_mfma_f32_16x16x32_bf16 v[156:159], v[72:75], a[68:71], v[156:159]
buffer_load_dwordx4 a[56:59], v12, s[24:27], s17 offen offset:0 sc1
s_waitcnt lgkmcnt(6)
v_mfma_f32_16x16x32_bf16 v[160:163], v[76:79], a[60:63], v[160:163]
ds_read_b64_tr_b16 v[68:69], v14 offset:18432
v_mfma_f32_16x16x32_bf16 v[164:167], v[76:79], a[64:67], v[164:167]
ds_read_b64_tr_b16 v[70:71], v14 offset:19456
v_mfma_f32_16x16x32_bf16 v[168:171], v[76:79], a[68:71], v[168:171]
s_waitcnt lgkmcnt(6)
v_mfma_f32_16x16x32_bf16 v[172:175], v[80:83], a[60:63], v[172:175]
ds_read_b64_tr_b16 v[72:73], v15 offset:18432
v_mfma_f32_16x16x32_bf16 v[176:179], v[80:83], a[64:67], v[176:179]
ds_read_b64_tr_b16 v[74:75], v15 offset:19456
v_mfma_f32_16x16x32_bf16 v[180:183], v[80:83], a[68:71], v[180:183]
s_waitcnt lgkmcnt(6)
v_mfma_f32_16x16x32_bf16 v[184:187], v[84:87], a[60:63], v[184:187]
ds_read_b64_tr_b16 v[76:77], v16 offset:18432
v_mfma_f32_16x16x32_bf16 v[188:191], v[84:87], a[64:67], v[188:191]
ds_read_b64_tr_b16 v[78:79], v16 offset:19456
v_mfma_f32_16x16x32_bf16 v[192:195], v[84:87], a[68:71], v[192:195]
s_waitcnt vmcnt(36) lgkmcnt(6)
v_mfma_f32_16x16x32_bf16 v[88:91], v[64:67], a[72:75], v[88:91]
ds_read_b64_tr_b16 v[80:81], v17 offset:18432
v_mfma_f32_16x16x32_bf16 v[92:95], v[64:67], a[76:79], v[92:95]
ds_read_b64_tr_b16 v[82:83], v17 offset:19456
v_mfma_f32_16x16x32_bf16 v[96:99], v[64:67], a[80:83], v[96:99]
s_waitcnt lgkmcnt(6)
v_mfma_f32_16x16x32_bf16 v[100:103], v[68:71], a[72:75], v[100:103]
ds_read_b64_tr_b16 v[84:85], v18 offset:18432
v_mfma_f32_16x16x32_bf16 v[104:107], v[68:71], a[76:79], v[104:107]
ds_read_b64_tr_b16 v[86:87], v18 offset:19456
v_mfma_f32_16x16x32_bf16 v[108:111], v[68:71], a[80:83], v[108:111]
buffer_load_dwordx4 a[60:63], v10, s[24:27], s17 offen offset:2048 sc1
s_waitcnt lgkmcnt(6)
v_mfma_f32_16x16x32_bf16 v[112:115], v[72:75], a[72:75], v[112:115]
ds_read_b64_tr_b16 v[64:65], v19 offset:18432
v_mfma_f32_16x16x32_bf16 v[116:119], v[72:75], a[76:79], v[116:119]
ds_read_b64_tr_b16 v[66:67], v19 offset:19456
v_mfma_f32_16x16x32_bf16 v[120:123], v[72:75], a[80:83], v[120:123]
buffer_load_dwordx4 a[64:67], v11, s[24:27], s17 offen offset:2048 sc1
s_waitcnt lgkmcnt(6)
v_mfma_f32_16x16x32_bf16 v[124:127], v[76:79], a[72:75], v[124:127]
ds_read_b64_tr_b16 v[68:69], v20 offset:18432
v_mfma_f32_16x16x32_bf16 v[128:131], v[76:79], a[76:79], v[128:131]
ds_read_b64_tr_b16 v[70:71], v20 offset:19456
v_mfma_f32_16x16x32_bf16 v[132:135], v[76:79], a[80:83], v[132:135]
buffer_load_dwordx4 a[68:71], v12, s[24:27], s17 offen offset:2048 sc1
s_waitcnt lgkmcnt(6)
v_mfma_f32_16x16x32_bf16 v[136:139], v[80:83], a[72:75], v[136:139]
ds_read_b64_tr_b16 v[72:73], v21 offset:18432
v_mfma_f32_16x16x32_bf16 v[140:143], v[80:83], a[76:79], v[140:143]
ds_read_b64_tr_b16 v[74:75], v21 offset:18688
v_mfma_f32_16x16x32_bf16 v[144:147], v[80:83], a[80:83], v[144:147]
s_waitcnt lgkmcnt(6)
v_mfma_f32_16x16x32_bf16 v[148:151], v[84:87], a[72:75], v[148:151]
ds_read_b64_tr_b16 v[76:77], v13 offset:27648
v_mfma_f32_16x16x32_bf16 v[152:155], v[84:87], a[76:79], v[152:155]
ds_read_b64_tr_b16 v[78:79], v13 offset:28672
v_mfma_f32_16x16x32_bf16 v[156:159], v[84:87], a[80:83], v[156:159]
s_waitcnt lgkmcnt(6)
v_mfma_f32_16x16x32_bf16 v[160:163], v[64:67], a[72:75], v[160:163]
ds_read_b64_tr_b16 v[80:81], v14 offset:27648
v_mfma_f32_16x16x32_bf16 v[164:167], v[64:67], a[76:79], v[164:167]
ds_read_b64_tr_b16 v[82:83], v14 offset:28672
v_mfma_f32_16x16x32_bf16 v[168:171], v[64:67], a[80:83], v[168:171]
s_waitcnt lgkmcnt(6)
v_mfma_f32_16x16x32_bf16 v[172:175], v[68:71], a[72:75], v[172:175]
ds_read_b64_tr_b16 v[84:85], v15 offset:27648
v_mfma_f32_16x16x32_bf16 v[176:179], v[68:71], a[76:79], v[176:179]
ds_read_b64_tr_b16 v[86:87], v15 offset:28672
v_mfma_f32_16x16x32_bf16 v[180:183], v[68:71], a[80:83], v[180:183]
s_waitcnt lgkmcnt(6)
v_mfma_f32_16x16x32_bf16 v[184:187], v[72:75], a[72:75], v[184:187]
ds_read_b64_tr_b16 v[64:65], v16 offset:27648
v_mfma_f32_16x16x32_bf16 v[188:191], v[72:75], a[76:79], v[188:191]
ds_read_b64_tr_b16 v[66:67], v16 offset:28672
v_mfma_f32_16x16x32_bf16 v[192:195], v[72:75], a[80:83], v[192:195]
s_waitcnt vmcnt(27) lgkmcnt(6)
v_mfma_f32_16x16x32_bf16 v[88:91], v[76:79], a[84:87], v[88:91]
ds_read_b64_tr_b16 v[68:69], v17 offset:27648
v_mfma_f32_16x16x32_bf16 v[92:95], v[76:79], a[88:91], v[92:95]
ds_read_b64_tr_b16 v[70:71], v17 offset:28672
v_mfma_f32_16x16x32_bf16 v[96:99], v[76:79], a[92:95], v[96:99]
s_waitcnt lgkmcnt(6)
v_mfma_f32_16x16x32_bf16 v[100:103], v[80:83], a[84:87], v[100:103]
ds_read_b64_tr_b16 v[72:73], v18 offset:27648
v_mfma_f32_16x16x32_bf16 v[104:107], v[80:83], a[88:91], v[104:107]
ds_read_b64_tr_b16 v[74:75], v18 offset:28672
v_mfma_f32_16x16x32_bf16 v[108:111], v[80:83], a[92:95], v[108:111]
s_add_u32 s17, s17, 4096
s_add_u32 s94, s94, 8192
s_and_b32 s94, s94, 0xffff
s_waitcnt lgkmcnt(6)
v_mfma_f32_16x16x32_bf16 v[112:115], v[84:87], a[84:87], v[112:115]
ds_read_b64_tr_b16 v[76:77], v19 offset:27648
v_mfma_f32_16x16x32_bf16 v[116:119], v[84:87], a[88:91], v[116:119]
ds_read_b64_tr_b16 v[78:79], v19 offset:28672
v_mfma_f32_16x16x32_bf16 v[120:123], v[84:87], a[92:95], v[120:123]
buffer_load_dwordx4 a[72:75], v10, s[24:27], s17 offen offset:0 sc1
s_waitcnt lgkmcnt(6)
v_mfma_f32_16x16x32_bf16 v[124:127], v[64:67], a[84:87], v[124:127]
ds_read_b64_tr_b16 v[80:81], v20 offset:27648
v_mfma_f32_16x16x32_bf16 v[128:131], v[64:67], a[88:91], v[128:131]
ds_read_b64_tr_b16 v[82:83], v20 offset:28672
v_mfma_f32_16x16x32_bf16 v[132:135], v[64:67], a[92:95], v[132:135]
buffer_load_dwordx4 a[76:79], v11, s[24:27], s17 offen offset:0 sc1
s_waitcnt lgkmcnt(6)
v_mfma_f32_16x16x32_bf16 v[136:139], v[68:71], a[84:87], v[136:139]
ds_read_b64_tr_b16 v[84:85], v21 offset:27648
v_mfma_f32_16x16x32_bf16 v[140:143], v[68:71], a[88:91], v[140:143]
ds_read_b64_tr_b16 v[86:87], v21 offset:27904
v_mfma_f32_16x16x32_bf16 v[144:147], v[68:71], a[92:95], v[144:147]
buffer_load_dwordx4 a[80:83], v12, s[24:27], s17 offen offset:0 sc1
s_waitcnt lgkmcnt(6)
v_mfma_f32_16x16x32_bf16 v[148:151], v[72:75], a[84:87], v[148:151]
s_barrier
v_add_u32 v13, 0x9000, v13
v_add_u32 v14, 0x9000, v14
v_add_u32 v15, 0x9000, v15
v_add_u32 v16, 0x9000, v16
v_add_u32 v17, 0x9000, v17
v_add_u32 v18, 0x9000, v18
v_add_u32 v19, 0x9000, v19
v_add_u32 v20, 0x9000, v20
v_add_u32 v21, 0x9000, v21
ds_read_b64_tr_b16 v[64:65], v13 offset:0
v_mfma_f32_16x16x32_bf16 v[152:155], v[72:75], a[88:91], v[152:155]
ds_read_b64_tr_b16 v[66:67], v13 offset:1024
v_mfma_f32_16x16x32_bf16 v[156:159], v[72:75], a[92:95], v[156:159]
s_waitcnt lgkmcnt(6)
v_mfma_f32_16x16x32_bf16 v[160:163], v[76:79], a[84:87], v[160:163]
ds_read_b64_tr_b16 v[68:69], v14 offset:0
v_mfma_f32_16x16x32_bf16 v[164:167], v[76:79], a[88:91], v[164:167]
ds_read_b64_tr_b16 v[70:71], v14 offset:1024
v_mfma_f32_16x16x32_bf16 v[168:171], v[76:79], a[92:95], v[168:171]
s_waitcnt lgkmcnt(6)
v_mfma_f32_16x16x32_bf16 v[172:175], v[80:83], a[84:87], v[172:175]
ds_read_b64_tr_b16 v[72:73], v15 offset:0
v_mfma_f32_16x16x32_bf16 v[176:179], v[80:83], a[88:91], v[176:179]
ds_read_b64_tr_b16 v[74:75], v15 offset:1024
v_mfma_f32_16x16x32_bf16 v[180:183], v[80:83], a[92:95], v[180:183]
s_waitcnt lgkmcnt(6)
v_mfma_f32_16x16x32_bf16 v[184:187], v[84:87], a[84:87], v[184:187]
ds_read_b64_tr_b16 v[76:77], v16 offset:0
v_mfma_f32_16x16x32_bf16 v[188:191], v[84:87], a[88:91], v[188:191]
ds_read_b64_tr_b16 v[78:79], v16 offset:1024
v_mfma_f32_16x16x32_bf16 v[192:195], v[84:87], a[92:95], v[192:195]
s_waitcnt vmcnt(27) lgkmcnt(6)
v_mfma_f32_16x16x32_bf16 v[88:91], v[64:67], a[0:3], v[88:91]
ds_read_b64_tr_b16 v[80:81], v17 offset:0
v_mfma_f32_16x16x32_bf16 v[92:95], v[64:67], a[4:7], v[92:95]
ds_read_b64_tr_b16 v[82:83], v17 offset:1024
v_mfma_f32_16x16x32_bf16 v[96:99], v[64:67], a[8:11], v[96:99]
s_waitcnt lgkmcnt(6)
v_mfma_f32_16x16x32_bf16 v[100:103], v[68:71], a[0:3], v[100:103]
ds_read_b64_tr_b16 v[84:85], v18 offset:0
v_mfma_f32_16x16x32_bf16 v[104:107], v[68:71], a[4:7], v[104:107]
ds_read_b64_tr_b16 v[86:87], v18 offset:1024
v_mfma_f32_16x16x32_bf16 v[108:111], v[68:71], a[8:11], v[108:111]
buffer_load_dwordx4 a[84:87], v10, s[24:27], s17 offen offset:2048 sc1
s_waitcnt lgkmcnt(6)
v_mfma_f32_16x16x32_bf16 v[112:115], v[72:75], a[0:3], v[112:115]
ds_read_b64_tr_b16 v[64:65], v19 offset:0
v_mfma_f32_16x16x32_bf16 v[116:119], v[72:75], a[4:7], v[116:119]
ds_read_b64_tr_b16 v[66:67], v19 offset:1024
v_mfma_f32_16x16x32_bf16 v[120:123], v[72:75], a[8:11], v[120:123]
buffer_load_dwordx4 a[88:91], v11, s[24:27], s17 offen offset:2048 sc1
s_waitcnt lgkmcnt(6)
v_mfma_f32_16x16x32_bf16 v[124:127], v[76:79], a[0:3], v[124:127]
ds_read_b64_tr_b16 v[68:69], v20 offset:0
v_mfma_f32_16x16x32_bf16 v[128:131], v[76:79], a[4:7], v[128:131]
ds_read_b64_tr_b16 v[70:71], v20 offset:1024
v_mfma_f32_16x16x32_bf16 v[132:135], v[76:79], a[8:11], v[132:135]
buffer_load_dwordx4 a[92:95], v12, s[24:27], s17 offen offset:2048 sc1
s_waitcnt lgkmcnt(6)
v_mfma_f32_16x16x32_bf16 v[136:139], v[80:83], a[0:3], v[136:139]
ds_read_b64_tr_b16 v[72:73], v21 offset:0
v_mfma_f32_16x16x32_bf16 v[140:143], v[80:83], a[4:7], v[140:143]
ds_read_b64_tr_b16 v[74:75], v21 offset:256
v_mfma_f32_16x16x32_bf16 v[144:147], v[80:83], a[8:11], v[144:147]
s_waitcnt lgkmcnt(6)
v_mfma_f32_16x16x32_bf16 v[148:151], v[84:87], a[0:3], v[148:151]
ds_read_b64_tr_b16 v[76:77], v13 offset:9216
v_mfma_f32_16x16x32_bf16 v[152:155], v[84:87], a[4:7], v[152:155]
ds_read_b64_tr_b16 v[78:79], v13 offset:10240
v_mfma_f32_16x16x32_bf16 v[156:159], v[84:87], a[8:11], v[156:159]
s_waitcnt lgkmcnt(6)
v_mfma_f32_16x16x32_bf16 v[160:163], v[64:67], a[0:3], v[160:163]
ds_read_b64_tr_b16 v[80:81], v14 offset:9216
v_mfma_f32_16x16x32_bf16 v[164:167], v[64:67], a[4:7], v[164:167]
ds_read_b64_tr_b16 v[82:83], v14 offset:10240
v_mfma_f32_16x16x32_bf16 v[168:171], v[64:67], a[8:11], v[168:171]
s_waitcnt lgkmcnt(6)
v_mfma_f32_16x16x32_bf16 v[172:175], v[68:71], a[0:3], v[172:175]
ds_read_b64_tr_b16 v[84:85], v15 offset:9216
v_mfma_f32_16x16x32_bf16 v[176:179], v[68:71], a[4:7], v[176:179]
ds_read_b64_tr_b16 v[86:87], v15 offset:10240
v_mfma_f32_16x16x32_bf16 v[180:183], v[68:71], a[8:11], v[180:183]
s_waitcnt lgkmcnt(6)
v_mfma_f32_16x16x32_bf16 v[184:187], v[72:75], a[0:3], v[184:187]
ds_read_b64_tr_b16 v[64:65], v16 offset:9216
v_mfma_f32_16x16x32_bf16 v[188:191], v[72:75], a[4:7], v[188:191]
ds_read_b64_tr_b16 v[66:67], v16 offset:10240
v_mfma_f32_16x16x32_bf16 v[192:195], v[72:75], a[8:11], v[192:195]
s_waitcnt vmcnt(27) lgkmcnt(6)
v_mfma_f32_16x16x32_bf16 v[88:91], v[76:79], a[12:15], v[88:91]
ds_read_b64_tr_b16 v[68:69], v17 offset:9216
v_mfma_f32_16x16x32_bf16 v[92:95], v[76:79], a[16:19], v[92:95]
ds_read_b64_tr_b16 v[70:71], v17 offset:10240
v_mfma_f32_16x16x32_bf16 v[96:99], v[76:79], a[20:23], v[96:99]
s_waitcnt lgkmcnt(6)
v_mfma_f32_16x16x32_bf16 v[100:103], v[80:83], a[12:15], v[100:103]
ds_read_b64_tr_b16 v[72:73], v18 offset:9216
v_mfma_f32_16x16x32_bf16 v[104:107], v[80:83], a[16:19], v[104:107]
ds_read_b64_tr_b16 v[74:75], v18 offset:10240
v_mfma_f32_16x16x32_bf16 v[108:111], v[80:83], a[20:23], v[108:111]
s_waitcnt lgkmcnt(6)
v_mfma_f32_16x16x32_bf16 v[112:115], v[84:87], a[12:15], v[112:115]
ds_read_b64_tr_b16 v[76:77], v19 offset:9216
v_mfma_f32_16x16x32_bf16 v[116:119], v[84:87], a[16:19], v[116:119]
ds_read_b64_tr_b16 v[78:79], v19 offset:10240
v_mfma_f32_16x16x32_bf16 v[120:123], v[84:87], a[20:23], v[120:123]
s_waitcnt lgkmcnt(6)
v_mfma_f32_16x16x32_bf16 v[124:127], v[64:67], a[12:15], v[124:127]
ds_read_b64_tr_b16 v[80:81], v20 offset:9216
v_mfma_f32_16x16x32_bf16 v[128:131], v[64:67], a[16:19], v[128:131]
ds_read_b64_tr_b16 v[82:83], v20 offset:10240
v_mfma_f32_16x16x32_bf16 v[132:135], v[64:67], a[20:23], v[132:135]
s_waitcnt lgkmcnt(6)
v_mfma_f32_16x16x32_bf16 v[136:139], v[68:71], a[12:15], v[136:139]
ds_read_b64_tr_b16 v[84:85], v21 offset:9216
v_mfma_f32_16x16x32_bf16 v[140:143], v[68:71], a[16:19], v[140:143]
ds_read_b64_tr_b16 v[86:87], v21 offset:9472
v_mfma_f32_16x16x32_bf16 v[144:147], v[68:71], a[20:23], v[144:147]
s_waitcnt lgkmcnt(6)
v_mfma_f32_16x16x32_bf16 v[148:151], v[72:75], a[12:15], v[148:151]
ds_read_b64_tr_b16 v[64:65], v13 offset:18432
v_mfma_f32_16x16x32_bf16 v[152:155], v[72:75], a[16:19], v[152:155]
ds_read_b64_tr_b16 v[66:67], v13 offset:19456
v_mfma_f32_16x16x32_bf16 v[156:159], v[72:75], a[20:23], v[156:159]
s_waitcnt lgkmcnt(6)
v_mfma_f32_16x16x32_bf16 v[160:163], v[76:79], a[12:15], v[160:163]
ds_read_b64_tr_b16 v[68:69], v14 offset:18432
v_mfma_f32_16x16x32_bf16 v[164:167], v[76:79], a[16:19], v[164:167]
ds_read_b64_tr_b16 v[70:71], v14 offset:19456
v_mfma_f32_16x16x32_bf16 v[168:171], v[76:79], a[20:23], v[168:171]
s_waitcnt lgkmcnt(6)
v_mfma_f32_16x16x32_bf16 v[172:175], v[80:83], a[12:15], v[172:175]
ds_read_b64_tr_b16 v[72:73], v15 offset:18432
v_mfma_f32_16x16x32_bf16 v[176:179], v[80:83], a[16:19], v[176:179]
ds_read_b64_tr_b16 v[74:75], v15 offset:19456
v_mfma_f32_16x16x32_bf16 v[180:183], v[80:83], a[20:23], v[180:183]
s_waitcnt lgkmcnt(6)
v_mfma_f32_16x16x32_bf16 v[184:187], v[84:87], a[12:15], v[184:187]
ds_read_b64_tr_b16 v[76:77], v16 offset:18432
v_mfma_f32_16x16x32_bf16 v[188:191], v[84:87], a[16:19], v[188:191]
ds_read_b64_tr_b16 v[78:79], v16 offset:19456
v_mfma_f32_16x16x32_bf16 v[192:195], v[84:87], a[20:23], v[192:195]
s_waitcnt vmcnt(24) lgkmcnt(6)
v_mfma_f32_16x16x32_bf16 v[88:91], v[64:67], a[24:27], v[88:91]
ds_read_b64_tr_b16 v[80:81], v17 offset:18432
v_mfma_f32_16x16x32_bf16 v[92:95], v[64:67], a[28:31], v[92:95]
ds_read_b64_tr_b16 v[82:83], v17 offset:19456
v_mfma_f32_16x16x32_bf16 v[96:99], v[64:67], a[32:35], v[96:99]
s_waitcnt lgkmcnt(6)
v_mfma_f32_16x16x32_bf16 v[100:103], v[68:71], a[24:27], v[100:103]
ds_read_b64_tr_b16 v[84:85], v18 offset:18432
v_mfma_f32_16x16x32_bf16 v[104:107], v[68:71], a[28:31], v[104:107]
ds_read_b64_tr_b16 v[86:87], v18 offset:19456
v_mfma_f32_16x16x32_bf16 v[108:111], v[68:71], a[32:35], v[108:111]
s_waitcnt lgkmcnt(6)
v_mfma_f32_16x16x32_bf16 v[112:115], v[72:75], a[24:27], v[112:115]
ds_read_b64_tr_b16 v[64:65], v19 offset:18432
v_mfma_f32_16x16x32_bf16 v[116:119], v[72:75], a[28:31], v[116:119]
ds_read_b64_tr_b16 v[66:67], v19 offset:19456
v_mfma_f32_16x16x32_bf16 v[120:123], v[72:75], a[32:35], v[120:123]
s_waitcnt lgkmcnt(6)
v_mfma_f32_16x16x32_bf16 v[124:127], v[76:79], a[24:27], v[124:127]
ds_read_b64_tr_b16 v[68:69], v20 offset:18432
v_mfma_f32_16x16x32_bf16 v[128:131], v[76:79], a[28:31], v[128:131]
ds_read_b64_tr_b16 v[70:71], v20 offset:19456
v_mfma_f32_16x16x32_bf16 v[132:135], v[76:79], a[32:35], v[132:135]
s_waitcnt lgkmcnt(6)
v_mfma_f32_16x16x32_bf16 v[136:139], v[80:83], a[24:27], v[136:139]
ds_read_b64_tr_b16 v[72:73], v21 offset:18432
v_mfma_f32_16x16x32_bf16 v[140:143], v[80:83], a[28:31], v[140:143]
ds_read_b64_tr_b16 v[74:75], v21 offset:18688
v_mfma_f32_16x16x32_bf16 v[144:147], v[80:83], a[32:35], v[144:147]
s_waitcnt lgkmcnt(6)
v_mfma_f32_16x16x32_bf16 v[148:151], v[84:87], a[24:27], v[148:151]
ds_read_b64_tr_b16 v[76:77], v13 offset:27648
v_mfma_f32_16x16x32_bf16 v[152:155], v[84:87], a[28:31], v[152:155]
ds_read_b64_tr_b16 v[78:79], v13 offset:28672
v_mfma_f32_16x16x32_bf16 v[156:159], v[84:87], a[32:35], v[156:159]
s_waitcnt lgkmcnt(6)
v_mfma_f32_16x16x32_bf16 v[160:163], v[64:67], a[24:27], v[160:163]
ds_read_b64_tr_b16 v[80:81], v14 offset:27648
v_mfma_f32_16x16x32_bf16 v[164:167], v[64:67], a[28:31], v[164:167]
ds_read_b64_tr_b16 v[82:83], v14 offset:28672
v_mfma_f32_16x16x32_bf16 v[168:171], v[64:67], a[32:35], v[168:171]
s_waitcnt lgkmcnt(6)
v_mfma_f32_16x16x32_bf16 v[172:175], v[68:71], a[24:27], v[172:175]
ds_read_b64_tr_b16 v[84:85], v15 offset:27648
v_mfma_f32_16x16x32_bf16 v[176:179], v[68:71], a[28:31], v[176:179]
ds_read_b64_tr_b16 v[86:87], v15 offset:28672
v_mfma_f32_16x16x32_bf16 v[180:183], v[68:71], a[32:35], v[180:183]
s_waitcnt lgkmcnt(6)
v_mfma_f32_16x16x32_bf16 v[184:187], v[72:75], a[24:27], v[184:187]
ds_read_b64_tr_b16 v[64:65], v16 offset:27648
v_mfma_f32_16x16x32_bf16 v[188:191], v[72:75], a[28:31], v[188:191]
ds_read_b64_tr_b16 v[66:67], v16 offset:28672
v_mfma_f32_16x16x32_bf16 v[192:195], v[72:75], a[32:35], v[192:195]
s_waitcnt vmcnt(12) lgkmcnt(6)
v_mfma_f32_16x16x32_bf16 v[88:91], v[76:79], a[36:39], v[88:91]
ds_read_b64_tr_b16 v[68:69], v17 offset:27648
v_mfma_f32_16x16x32_bf16 v[92:95], v[76:79], a[40:43], v[92:95]
ds_read_b64_tr_b16 v[70:71], v17 offset:28672
v_mfma_f32_16x16x32_bf16 v[96:99], v[76:79], a[44:47], v[96:99]
s_waitcnt lgkmcnt(6)
v_mfma_f32_16x16x32_bf16 v[100:103], v[80:83], a[36:39], v[100:103]
ds_read_b64_tr_b16 v[72:73], v18 offset:27648
v_mfma_f32_16x16x32_bf16 v[104:107], v[80:83], a[40:43], v[104:107]
ds_read_b64_tr_b16 v[74:75], v18 offset:28672
v_mfma_f32_16x16x32_bf16 v[108:111], v[80:83], a[44:47], v[108:111]
s_waitcnt lgkmcnt(6)
v_mfma_f32_16x16x32_bf16 v[112:115], v[84:87], a[36:39], v[112:115]
ds_read_b64_tr_b16 v[76:77], v19 offset:27648
v_mfma_f32_16x16x32_bf16 v[116:119], v[84:87], a[40:43], v[116:119]
ds_read_b64_tr_b16 v[78:79], v19 offset:28672
v_mfma_f32_16x16x32_bf16 v[120:123], v[84:87], a[44:47], v[120:123]
s_waitcnt lgkmcnt(6)
v_mfma_f32_16x16x32_bf16 v[124:127], v[64:67], a[36:39], v[124:127]
ds_read_b64_tr_b16 v[80:81], v20 offset:27648
v_mfma_f32_16x16x32_bf16 v[128:131], v[64:67], a[40:43], v[128:131]
ds_read_b64_tr_b16 v[82:83], v20 offset:28672
v_mfma_f32_16x16x32_bf16 v[132:135], v[64:67], a[44:47], v[132:135]
s_waitcnt lgkmcnt(6)
v_mfma_f32_16x16x32_bf16 v[136:139], v[68:71], a[36:39], v[136:139]
ds_read_b64_tr_b16 v[84:85], v21 offset:27648
v_mfma_f32_16x16x32_bf16 v[140:143], v[68:71], a[40:43], v[140:143]
ds_read_b64_tr_b16 v[86:87], v21 offset:27904
v_mfma_f32_16x16x32_bf16 v[144:147], v[68:71], a[44:47], v[144:147]
s_waitcnt lgkmcnt(6)
v_mfma_f32_16x16x32_bf16 v[148:151], v[72:75], a[36:39], v[148:151]
s_barrier
v_add_u32 v13, 0x9000, v13
v_add_u32 v14, 0x9000, v14
v_add_u32 v15, 0x9000, v15
v_add_u32 v16, 0x9000, v16
v_add_u32 v17, 0x9000, v17
v_add_u32 v18, 0x9000, v18
v_add_u32 v19, 0x9000, v19
v_add_u32 v20, 0x9000, v20
v_add_u32 v21, 0x9000, v21
ds_read_b64_tr_b16 v[64:65], v13 offset:0
v_mfma_f32_16x16x32_bf16 v[152:155], v[72:75], a[40:43], v[152:155]
ds_read_b64_tr_b16 v[66:67], v13 offset:1024
v_mfma_f32_16x16x32_bf16 v[156:159], v[72:75], a[44:47], v[156:159]
s_waitcnt lgkmcnt(6)
v_mfma_f32_16x16x32_bf16 v[160:163], v[76:79], a[36:39], v[160:163]
ds_read_b64_tr_b16 v[68:69], v14 offset:0
v_mfma_f32_16x16x32_bf16 v[164:167], v[76:79], a[40:43], v[164:167]
ds_read_b64_tr_b16 v[70:71], v14 offset:1024
v_mfma_f32_16x16x32_bf16 v[168:171], v[76:79], a[44:47], v[168:171]
s_waitcnt lgkmcnt(6)
v_mfma_f32_16x16x32_bf16 v[172:175], v[80:83], a[36:39], v[172:175]
ds_read_b64_tr_b16 v[72:73], v15 offset:0
v_mfma_f32_16x16x32_bf16 v[176:179], v[80:83], a[40:43], v[176:179]
ds_read_b64_tr_b16 v[74:75], v15 offset:1024
v_mfma_f32_16x16x32_bf16 v[180:183], v[80:83], a[44:47], v[180:183]
s_waitcnt lgkmcnt(6)
v_mfma_f32_16x16x32_bf16 v[184:187], v[84:87], a[36:39], v[184:187]
ds_read_b64_tr_b16 v[76:77], v16 offset:0
v_mfma_f32_16x16x32_bf16 v[188:191], v[84:87], a[40:43], v[188:191]
ds_read_b64_tr_b16 v[78:79], v16 offset:1024
v_mfma_f32_16x16x32_bf16 v[192:195], v[84:87], a[44:47], v[192:195]
s_waitcnt vmcnt(9) lgkmcnt(6)
v_mfma_f32_16x16x32_bf16 v[88:91], v[64:67], a[48:51], v[88:91]
ds_read_b64_tr_b16 v[80:81], v17 offset:0
v_mfma_f32_16x16x32_bf16 v[92:95], v[64:67], a[52:55], v[92:95]
ds_read_b64_tr_b16 v[82:83], v17 offset:1024
v_mfma_f32_16x16x32_bf16 v[96:99], v[64:67], a[56:59], v[96:99]
s_waitcnt lgkmcnt(6)
v_mfma_f32_16x16x32_bf16 v[100:103], v[68:71], a[48:51], v[100:103]
ds_read_b64_tr_b16 v[84:85], v18 offset:0
v_mfma_f32_16x16x32_bf16 v[104:107], v[68:71], a[52:55], v[104:107]
ds_read_b64_tr_b16 v[86:87], v18 offset:1024
v_mfma_f32_16x16x32_bf16 v[108:111], v[68:71], a[56:59], v[108:111]
s_waitcnt lgkmcnt(6)
v_mfma_f32_16x16x32_bf16 v[112:115], v[72:75], a[48:51], v[112:115]
ds_read_b64_tr_b16 v[64:65], v19 offset:0
v_mfma_f32_16x16x32_bf16 v[116:119], v[72:75], a[52:55], v[116:119]
ds_read_b64_tr_b16 v[66:67], v19 offset:1024
v_mfma_f32_16x16x32_bf16 v[120:123], v[72:75], a[56:59], v[120:123]
s_waitcnt lgkmcnt(6)
v_mfma_f32_16x16x32_bf16 v[124:127], v[76:79], a[48:51], v[124:127]
ds_read_b64_tr_b16 v[68:69], v20 offset:0
v_mfma_f32_16x16x32_bf16 v[128:131], v[76:79], a[52:55], v[128:131]
ds_read_b64_tr_b16 v[70:71], v20 offset:1024
v_mfma_f32_16x16x32_bf16 v[132:135], v[76:79], a[56:59], v[132:135]
s_waitcnt lgkmcnt(6)
v_mfma_f32_16x16x32_bf16 v[136:139], v[80:83], a[48:51], v[136:139]
ds_read_b64_tr_b16 v[72:73], v21 offset:0
v_mfma_f32_16x16x32_bf16 v[140:143], v[80:83], a[52:55], v[140:143]
ds_read_b64_tr_b16 v[74:75], v21 offset:256
v_mfma_f32_16x16x32_bf16 v[144:147], v[80:83], a[56:59], v[144:147]
s_waitcnt lgkmcnt(6)
v_mfma_f32_16x16x32_bf16 v[148:151], v[84:87], a[48:51], v[148:151]
ds_read_b64_tr_b16 v[76:77], v13 offset:9216
v_mfma_f32_16x16x32_bf16 v[152:155], v[84:87], a[52:55], v[152:155]
ds_read_b64_tr_b16 v[78:79], v13 offset:10240
v_mfma_f32_16x16x32_bf16 v[156:159], v[84:87], a[56:59], v[156:159]
s_waitcnt lgkmcnt(6)
v_mfma_f32_16x16x32_bf16 v[160:163], v[64:67], a[48:51], v[160:163]
ds_read_b64_tr_b16 v[80:81], v14 offset:9216
v_mfma_f32_16x16x32_bf16 v[164:167], v[64:67], a[52:55], v[164:167]
ds_read_b64_tr_b16 v[82:83], v14 offset:10240
v_mfma_f32_16x16x32_bf16 v[168:171], v[64:67], a[56:59], v[168:171]
s_waitcnt lgkmcnt(6)
v_mfma_f32_16x16x32_bf16 v[172:175], v[68:71], a[48:51], v[172:175]
ds_read_b64_tr_b16 v[84:85], v15 offset:9216
v_mfma_f32_16x16x32_bf16 v[176:179], v[68:71], a[52:55], v[176:179]
ds_read_b64_tr_b16 v[86:87], v15 offset:10240
v_mfma_f32_16x16x32_bf16 v[180:183], v[68:71], a[56:59], v[180:183]
s_waitcnt lgkmcnt(6)
v_mfma_f32_16x16x32_bf16 v[184:187], v[72:75], a[48:51], v[184:187]
ds_read_b64_tr_b16 v[64:65], v16 offset:9216
v_mfma_f32_16x16x32_bf16 v[188:191], v[72:75], a[52:55], v[188:191]
ds_read_b64_tr_b16 v[66:67], v16 offset:10240
v_mfma_f32_16x16x32_bf16 v[192:195], v[72:75], a[56:59], v[192:195]
s_waitcnt vmcnt(6) lgkmcnt(6)
v_mfma_f32_16x16x32_bf16 v[88:91], v[76:79], a[60:63], v[88:91]
ds_read_b64_tr_b16 v[68:69], v17 offset:9216
v_mfma_f32_16x16x32_bf16 v[92:95], v[76:79], a[64:67], v[92:95]
ds_read_b64_tr_b16 v[70:71], v17 offset:10240
v_mfma_f32_16x16x32_bf16 v[96:99], v[76:79], a[68:71], v[96:99]
s_waitcnt lgkmcnt(6)
v_mfma_f32_16x16x32_bf16 v[100:103], v[80:83], a[60:63], v[100:103]
ds_read_b64_tr_b16 v[72:73], v18 offset:9216
v_mfma_f32_16x16x32_bf16 v[104:107], v[80:83], a[64:67], v[104:107]
ds_read_b64_tr_b16 v[74:75], v18 offset:10240
v_mfma_f32_16x16x32_bf16 v[108:111], v[80:83], a[68:71], v[108:111]
s_waitcnt lgkmcnt(6)
v_mfma_f32_16x16x32_bf16 v[112:115], v[84:87], a[60:63], v[112:115]
ds_read_b64_tr_b16 v[76:77], v19 offset:9216
v_mfma_f32_16x16x32_bf16 v[116:119], v[84:87], a[64:67], v[116:119]
ds_read_b64_tr_b16 v[78:79], v19 offset:10240
v_mfma_f32_16x16x32_bf16 v[120:123], v[84:87], a[68:71], v[120:123]
s_waitcnt lgkmcnt(6)
v_mfma_f32_16x16x32_bf16 v[124:127], v[64:67], a[60:63], v[124:127]
ds_read_b64_tr_b16 v[80:81], v20 offset:9216
v_mfma_f32_16x16x32_bf16 v[128:131], v[64:67], a[64:67], v[128:131]
ds_read_b64_tr_b16 v[82:83], v20 offset:10240
v_mfma_f32_16x16x32_bf16 v[132:135], v[64:67], a[68:71], v[132:135]
s_waitcnt lgkmcnt(6)
v_mfma_f32_16x16x32_bf16 v[136:139], v[68:71], a[60:63], v[136:139]
ds_read_b64_tr_b16 v[84:85], v21 offset:9216
v_mfma_f32_16x16x32_bf16 v[140:143], v[68:71], a[64:67], v[140:143]
ds_read_b64_tr_b16 v[86:87], v21 offset:9472
v_mfma_f32_16x16x32_bf16 v[144:147], v[68:71], a[68:71], v[144:147]
s_waitcnt lgkmcnt(6)
v_mfma_f32_16x16x32_bf16 v[148:151], v[72:75], a[60:63], v[148:151]
ds_read_b64_tr_b16 v[64:65], v13 offset:18432
v_mfma_f32_16x16x32_bf16 v[152:155], v[72:75], a[64:67], v[152:155]
ds_read_b64_tr_b16 v[66:67], v13 offset:19456
v_mfma_f32_16x16x32_bf16 v[156:159], v[72:75], a[68:71], v[156:159]
s_waitcnt lgkmcnt(6)
v_mfma_f32_16x16x32_bf16 v[160:163], v[76:79], a[60:63], v[160:163]
ds_read_b64_tr_b16 v[68:69], v14 offset:18432
v_mfma_f32_16x16x32_bf16 v[164:167], v[76:79], a[64:67], v[164:167]
ds_read_b64_tr_b16 v[70:71], v14 offset:19456
v_mfma_f32_16x16x32_bf16 v[168:171], v[76:79], a[68:71], v[168:171]
s_waitcnt lgkmcnt(6)
v_mfma_f32_16x16x32_bf16 v[172:175], v[80:83], a[60:63], v[172:175]
ds_read_b64_tr_b16 v[72:73], v15 offset:18432
v_mfma_f32_16x16x32_bf16 v[176:179], v[80:83], a[64:67], v[176:179]
ds_read_b64_tr_b16 v[74:75], v15 offset:19456
v_mfma_f32_16x16x32_bf16 v[180:183], v[80:83], a[68:71], v[180:183]
s_waitcnt lgkmcnt(6)
v_mfma_f32_16x16x32_bf16 v[184:187], v[84:87], a[60:63], v[184:187]
ds_read_b64_tr_b16 v[76:77], v16 offset:18432
v_mfma_f32_16x16x32_bf16 v[188:191], v[84:87], a[64:67], v[188:191]
ds_read_b64_tr_b16 v[78:79], v16 offset:19456
v_mfma_f32_16x16x32_bf16 v[192:195], v[84:87], a[68:71], v[192:195]
s_waitcnt vmcnt(3) lgkmcnt(6)
v_mfma_f32_16x16x32_bf16 v[88:91], v[64:67], a[72:75], v[88:91]
ds_read_b64_tr_b16 v[80:81], v17 offset:18432
v_mfma_f32_16x16x32_bf16 v[92:95], v[64:67], a[76:79], v[92:95]
ds_read_b64_tr_b16 v[82:83], v17 offset:19456
v_mfma_f32_16x16x32_bf16 v[96:99], v[64:67], a[80:83], v[96:99]
s_waitcnt lgkmcnt(6)
v_mfma_f32_16x16x32_bf16 v[100:103], v[68:71], a[72:75], v[100:103]
ds_read_b64_tr_b16 v[84:85], v18 offset:18432
v_mfma_f32_16x16x32_bf16 v[104:107], v[68:71], a[76:79], v[104:107]
ds_read_b64_tr_b16 v[86:87], v18 offset:19456
v_mfma_f32_16x16x32_bf16 v[108:111], v[68:71], a[80:83], v[108:111]
s_waitcnt lgkmcnt(6)
v_mfma_f32_16x16x32_bf16 v[112:115], v[72:75], a[72:75], v[112:115]
ds_read_b64_tr_b16 v[64:65], v19 offset:18432
v_mfma_f32_16x16x32_bf16 v[116:119], v[72:75], a[76:79], v[116:119]
ds_read_b64_tr_b16 v[66:67], v19 offset:19456
v_mfma_f32_16x16x32_bf16 v[120:123], v[72:75], a[80:83], v[120:123]
s_waitcnt lgkmcnt(6)
v_mfma_f32_16x16x32_bf16 v[124:127], v[76:79], a[72:75], v[124:127]
ds_read_b64_tr_b16 v[68:69], v20 offset:18432
v_mfma_f32_16x16x32_bf16 v[128:131], v[76:79], a[76:79], v[128:131]
ds_read_b64_tr_b16 v[70:71], v20 offset:19456
v_mfma_f32_16x16x32_bf16 v[132:135], v[76:79], a[80:83], v[132:135]
s_waitcnt lgkmcnt(6)
v_mfma_f32_16x16x32_bf16 v[136:139], v[80:83], a[72:75], v[136:139]
ds_read_b64_tr_b16 v[72:73], v21 offset:18432
v_mfma_f32_16x16x32_bf16 v[140:143], v[80:83], a[76:79], v[140:143]
ds_read_b64_tr_b16 v[74:75], v21 offset:18688
v_mfma_f32_16x16x32_bf16 v[144:147], v[80:83], a[80:83], v[144:147]
s_waitcnt lgkmcnt(6)
v_mfma_f32_16x16x32_bf16 v[148:151], v[84:87], a[72:75], v[148:151]
ds_read_b64_tr_b16 v[76:77], v13 offset:27648
v_mfma_f32_16x16x32_bf16 v[152:155], v[84:87], a[76:79], v[152:155]
ds_read_b64_tr_b16 v[78:79], v13 offset:28672
v_mfma_f32_16x16x32_bf16 v[156:159], v[84:87], a[80:83], v[156:159]
s_waitcnt lgkmcnt(6)
v_mfma_f32_16x16x32_bf16 v[160:163], v[64:67], a[72:75], v[160:163]
ds_read_b64_tr_b16 v[80:81], v14 offset:27648
v_mfma_f32_16x16x32_bf16 v[164:167], v[64:67], a[76:79], v[164:167]
ds_read_b64_tr_b16 v[82:83], v14 offset:28672
v_mfma_f32_16x16x32_bf16 v[168:171], v[64:67], a[80:83], v[168:171]
s_waitcnt lgkmcnt(6)
v_mfma_f32_16x16x32_bf16 v[172:175], v[68:71], a[72:75], v[172:175]
ds_read_b64_tr_b16 v[84:85], v15 offset:27648
v_mfma_f32_16x16x32_bf16 v[176:179], v[68:71], a[76:79], v[176:179]
ds_read_b64_tr_b16 v[86:87], v15 offset:28672
v_mfma_f32_16x16x32_bf16 v[180:183], v[68:71], a[80:83], v[180:183]
s_waitcnt lgkmcnt(6)
v_mfma_f32_16x16x32_bf16 v[184:187], v[72:75], a[72:75], v[184:187]
ds_read_b64_tr_b16 v[64:65], v16 offset:27648
v_mfma_f32_16x16x32_bf16 v[188:191], v[72:75], a[76:79], v[188:191]
ds_read_b64_tr_b16 v[66:67], v16 offset:28672
v_mfma_f32_16x16x32_bf16 v[192:195], v[72:75], a[80:83], v[192:195]
s_waitcnt vmcnt(0) lgkmcnt(6)
v_mfma_f32_16x16x32_bf16 v[88:91], v[76:79], a[84:87], v[88:91]
ds_read_b64_tr_b16 v[68:69], v17 offset:27648
v_mfma_f32_16x16x32_bf16 v[92:95], v[76:79], a[88:91], v[92:95]
ds_read_b64_tr_b16 v[70:71], v17 offset:28672
v_mfma_f32_16x16x32_bf16 v[96:99], v[76:79], a[92:95], v[96:99]
s_waitcnt lgkmcnt(6)
v_mfma_f32_16x16x32_bf16 v[100:103], v[80:83], a[84:87], v[100:103]
ds_read_b64_tr_b16 v[72:73], v18 offset:27648
v_mfma_f32_16x16x32_bf16 v[104:107], v[80:83], a[88:91], v[104:107]
ds_read_b64_tr_b16 v[74:75], v18 offset:28672
v_mfma_f32_16x16x32_bf16 v[108:111], v[80:83], a[92:95], v[108:111]
s_waitcnt lgkmcnt(6)
v_mfma_f32_16x16x32_bf16 v[112:115], v[84:87], a[84:87], v[112:115]
ds_read_b64_tr_b16 v[76:77], v19 offset:27648
v_mfma_f32_16x16x32_bf16 v[116:119], v[84:87], a[88:91], v[116:119]
ds_read_b64_tr_b16 v[78:79], v19 offset:28672
v_mfma_f32_16x16x32_bf16 v[120:123], v[84:87], a[92:95], v[120:123]
s_waitcnt lgkmcnt(6)
v_mfma_f32_16x16x32_bf16 v[124:127], v[64:67], a[84:87], v[124:127]
ds_read_b64_tr_b16 v[80:81], v20 offset:27648
v_mfma_f32_16x16x32_bf16 v[128:131], v[64:67], a[88:91], v[128:131]
ds_read_b64_tr_b16 v[82:83], v20 offset:28672
v_mfma_f32_16x16x32_bf16 v[132:135], v[64:67], a[92:95], v[132:135]
s_waitcnt lgkmcnt(6)
v_mfma_f32_16x16x32_bf16 v[136:139], v[68:71], a[84:87], v[136:139]
ds_read_b64_tr_b16 v[84:85], v21 offset:27648
v_mfma_f32_16x16x32_bf16 v[140:143], v[68:71], a[88:91], v[140:143]
ds_read_b64_tr_b16 v[86:87], v21 offset:27904
v_mfma_f32_16x16x32_bf16 v[144:147], v[68:71], a[92:95], v[144:147]
s_waitcnt lgkmcnt(6)
v_mfma_f32_16x16x32_bf16 v[148:151], v[72:75], a[84:87], v[148:151]
v_mfma_f32_16x16x32_bf16 v[152:155], v[72:75], a[88:91], v[152:155]
v_mfma_f32_16x16x32_bf16 v[156:159], v[72:75], a[92:95], v[156:159]
s_waitcnt lgkmcnt(4)
v_mfma_f32_16x16x32_bf16 v[160:163], v[76:79], a[84:87], v[160:163]
v_mfma_f32_16x16x32_bf16 v[164:167], v[76:79], a[88:91], v[164:167]
v_mfma_f32_16x16x32_bf16 v[168:171], v[76:79], a[92:95], v[168:171]
s_waitcnt lgkmcnt(2)
v_mfma_f32_16x16x32_bf16 v[172:175], v[80:83], a[84:87], v[172:175]
v_mfma_f32_16x16x32_bf16 v[176:179], v[80:83], a[88:91], v[176:179]
v_mfma_f32_16x16x32_bf16 v[180:183], v[80:83], a[92:95], v[180:183]
s_waitcnt lgkmcnt(0)
v_mfma_f32_16x16x32_bf16 v[184:187], v[84:87], a[84:87], v[184:187]
v_mfma_f32_16x16x32_bf16 v[188:191], v[84:87], a[88:91], v[188:191]
v_mfma_f32_16x16x32_bf16 v[192:195], v[84:87], a[92:95], v[192:195]
s_nop 7
v_cvt_pk_bf16_f32 v196, v88, v89
v_cvt_pk_bf16_f32 v197, v90, v91
v_cvt_pk_bf16_f32 v198, v100, v101
v_cvt_pk_bf16_f32 v199, v102, v103
v_cvt_pk_bf16_f32 v200, v112, v113
v_cvt_pk_bf16_f32 v201, v114, v115
v_cvt_pk_bf16_f32 v202, v124, v125
v_cvt_pk_bf16_f32 v203, v126, v127
v_cvt_pk_bf16_f32 v204, v136, v137
v_cvt_pk_bf16_f32 v205, v138, v139
v_cvt_pk_bf16_f32 v206, v148, v149
v_cvt_pk_bf16_f32 v207, v150, v151
v_cvt_pk_bf16_f32 v208, v160, v161
v_cvt_pk_bf16_f32 v209, v162, v163
v_cvt_pk_bf16_f32 v210, v172, v173
v_cvt_pk_bf16_f32 v211, v174, v175
v_cvt_pk_bf16_f32 v244, v184, v185
v_cvt_pk_bf16_f32 v245, v186, v187
s_nop 1
v_permlane16_swap_b32 v196, v198
v_permlane16_swap_b32 v197, v199
v_permlane16_swap_b32 v200, v202
v_permlane16_swap_b32 v201, v203
v_permlane16_swap_b32 v204, v206
v_permlane16_swap_b32 v205, v207
v_permlane16_swap_b32 v208, v210
v_permlane16_swap_b32 v209, v211
s_add_u32 s16, s95, 0
buffer_store_dwordx4 v[196:199], v43, s[24:27], s16 offen offset:0 sc1
buffer_store_dwordx4 v[200:203], v43, s[24:27], s16 offen offset:1024 sc1
buffer_store_dwordx4 v[204:207], v43, s[24:27], s16 offen offset:2048 sc1
buffer_store_dwordx4 v[208:211], v43, s[24:27], s16 offen offset:3072 sc1
v_cvt_pk_bf16_f32 v212, v92, v93
v_cvt_pk_bf16_f32 v213, v94, v95
v_cvt_pk_bf16_f32 v214, v104, v105
v_cvt_pk_bf16_f32 v215, v106, v107
v_cvt_pk_bf16_f32 v216, v116, v117
v_cvt_pk_bf16_f32 v217, v118, v119
v_cvt_pk_bf16_f32 v218, v128, v129
v_cvt_pk_bf16_f32 v219, v130, v131
v_cvt_pk_bf16_f32 v220, v140, v141
v_cvt_pk_bf16_f32 v221, v142, v143
v_cvt_pk_bf16_f32 v222, v152, v153
v_cvt_pk_bf16_f32 v223, v154, v155
v_cvt_pk_bf16_f32 v224, v164, v165
v_cvt_pk_bf16_f32 v225, v166, v167
v_cvt_pk_bf16_f32 v226, v176, v177
v_cvt_pk_bf16_f32 v227, v178, v179
v_cvt_pk_bf16_f32 v246, v188, v189
v_cvt_pk_bf16_f32 v247, v190, v191
s_nop 1
v_permlane16_swap_b32 v212, v214
v_permlane16_swap_b32 v213, v215
v_permlane16_swap_b32 v216, v218
v_permlane16_swap_b32 v217, v219
v_permlane16_swap_b32 v220, v222
v_permlane16_swap_b32 v221, v223
v_permlane16_swap_b32 v224, v226
v_permlane16_swap_b32 v225, v227
s_add_u32 s16, s95, 4096
buffer_store_dwordx4 v[212:215], v43, s[24:27], s16 offen offset:0 sc1
buffer_store_dwordx4 v[216:219], v43, s[24:27], s16 offen offset:1024 sc1
buffer_store_dwordx4 v[220:223], v43, s[24:27], s16 offen offset:2048 sc1
buffer_store_dwordx4 v[224:227], v43, s[24:27], s16 offen offset:3072 sc1
v_cvt_pk_bf16_f32 v228, v96, v97
v_cvt_pk_bf16_f32 v229, v98, v99
v_cvt_pk_bf16_f32 v230, v108, v109
v_cvt_pk_bf16_f32 v231, v110, v111
v_cvt_pk_bf16_f32 v232, v120, v121
v_cvt_pk_bf16_f32 v233, v122, v123
v_cvt_pk_bf16_f32 v234, v132, v133
v_cvt_pk_bf16_f32 v235, v134, v135
v_cvt_pk_bf16_f32 v236, v144, v145
v_cvt_pk_bf16_f32 v237, v146, v147
v_cvt_pk_bf16_f32 v238, v156, v157
v_cvt_pk_bf16_f32 v239, v158, v159
v_cvt_pk_bf16_f32 v240, v168, v169
v_cvt_pk_bf16_f32 v241, v170, v171
v_cvt_pk_bf16_f32 v242, v180, v181
v_cvt_pk_bf16_f32 v243, v182, v183
v_cvt_pk_bf16_f32 v248, v192, v193
v_cvt_pk_bf16_f32 v249, v194, v195
s_nop 1
v_permlane16_swap_b32 v228, v230
v_permlane16_swap_b32 v229, v231
v_permlane16_swap_b32 v232, v234
v_permlane16_swap_b32 v233, v235
v_permlane16_swap_b32 v236, v238
v_permlane16_swap_b32 v237, v239
v_permlane16_swap_b32 v240, v242
v_permlane16_swap_b32 v241, v243
s_add_u32 s16, s95, 8192
buffer_store_dwordx4 v[228:231], v43, s[24:27], s16 offen offset:0 sc1
buffer_store_dwordx4 v[232:235], v43, s[24:27], s16 offen offset:1024 sc1
buffer_store_dwordx4 v[236:239], v43, s[24:27], s16 offen offset:2048 sc1
buffer_store_dwordx4 v[240:243], v43, s[24:27], s16 offen offset:3072 sc1
s_add_u32 s16, s95, 12288
buffer_store_dwordx2 v[244:245], v44, s[24:27], s16 offen offset:0 sc1
buffer_store_dwordx2 v[246:247], v44, s[24:27], s16 offen offset:512 sc1
buffer_store_dwordx2 v[248:249], v44, s[24:27], s16 offen offset:1024 sc1
s_waitcnt vmcnt(0)
s_barrier
s_cmp_lg_u32 s35, 0
s_cbranch_scc1 L_sig_skip_B
v_mov_b32 v31, 0x10000
s_lshl_b32 s3, s87, 2
v_mov_b32 v32, s3
s_mov_b64 exec, 1
buffer_atomic_add v31, v32, s[76:79], 0 offen sc1
s_mov_b64 exec, -1
L_sig_skip_B:
s_lshl_b32 s4, s38, 5
s_add_u32 s4, s4, s39
s_lshl_b32 s4, s4, 2
s_add_u32 s4, s4, s84
s_mul_i32 s4, s4, 55296
s_mul_i32 s5, s85, 13824
s_add_u32 s4, s4, s5
s_add_u32 s4, s4, 33554432
s_lshl_b32 s5, s35, 10
s_add_u32 s8, s4, s5
s_lshl_b32 s5, s35, 9
s_add_u32 s9, s4, s5
s_add_u32 s9, s9, 12288
s_mul_i32 s5, s39, 192
s_mul_i32 s4, s85, 48
s_add_u32 s5, s5, s4
s_mul_i32 s5, s5, 2304
s_mul_i32 s4, s38, 1152
s_add_u32 s5, s5, s4
s_mul_i32 s4, s84, 288
s_add_u32 s10, s5, s4
v_lshlrev_b32 v2, 4, v0
v_lshlrev_b32 v3, 3, v0
v_and_b32 v4, 15, v0
v_mul_u32_u24 v4, 2304, v4
v_lshrrev_b32 v5, 4, v0
v_and_b32 v6, 1, v5
v_lshlrev_b32 v6, 5, v6
v_lshrrev_b32 v7, 1, v5
v_lshlrev_b32 v7, 4, v7
v_add3_u32 v6, v4, v6, v7
v_lshlrev_b32 v7, 3, v5
v_add_u32 v7, v4, v7
v_mov_b32 v8, 0xffff0000
s_cmp_lg_u32 s35, 0
s_cbranch_scc1 L_poll_done_B
s_lshl_b32 s3, s87, 2
v_mov_b32 v32, s3
s_mov_b32 s6, 65536
L_poll_B:
buffer_load_dword v31, v32, s[76:79], 0 offen sc1
s_waitcnt vmcnt(0)
v_readfirstlane_b32 s3, v31
s_nop 3
s_lshr_b32 s3, s3, 16
s_and_b32 s3, s3, 0xffff
s_cmp_ge_u32 s3, 4
s_cbranch_scc1 L_poll_done_B
s_sub_u32 s6, s6, 1
s_cmp_lg_u32 s6, 0
s_cbranch_scc1 L_poll_B
L_poll_done_B:
s_barrier
s_min_u32 s5, s35, 2
s_lshl_b32 s5, s5, 9
s_lshl_b32 s4, s35, 9
s_sub_u32 s9, s9, s4
s_add_u32 s9, s9, s5
s_add_u32 s11, s8, 0
buffer_load_dwordx4 v[96:99], v2, s[24:27], s11 offen sc1
s_add_u32 s11, s8, 1769472
buffer_load_dwordx4 v[100:103], v2, s[24:27], s11 offen sc1
s_add_u32 s11, s8, 3538944
buffer_load_dwordx4 v[104:107], v2, s[24:27], s11 offen sc1
s_add_u32 s11, s8, 5308416
buffer_load_dwordx4 v[108:111], v2, s[24:27], s11 offen sc1
s_add_u32 s11, s8, 4096
buffer_load_dwordx4 v[112:115], v2, s[24:27], s11 offen sc1
s_add_u32 s11, s8, 1773568
buffer_load_dwordx4 v[116:119], v2, s[24:27], s11 offen sc1
s_add_u32 s11, s8, 3543040
buffer_load_dwordx4 v[120:123], v2, s[24:27], s11 offen sc1
s_add_u32 s11, s8, 5312512
buffer_load_dwordx4 v[124:127], v2, s[24:27], s11 offen sc1
s_add_u32 s11, s8, 8192
buffer_load_dwordx4 v[128:131], v2, s[24:27], s11 offen sc1
s_add_u32 s11, s8, 1777664
buffer_load_dwordx4 v[132:135], v2, s[24:27], s11 offen sc1
s_add_u32 s11, s8, 3547136
buffer_load_dwordx4 v[136:139], v2, s[24:27], s11 offen sc1
s_add_u32 s11, s8, 5316608
buffer_load_dwordx4 v[140:143], v2, s[24:27], s11 offen sc1
s_add_u32 s11, s9, 0
buffer_load_dwordx2 v[144:145], v3, s[24:27], s11 offen sc1
s_add_u32 s11, s9, 1769472
buffer_load_dwordx2 v[146:147], v3, s[24:27], s11 offen sc1
s_add_u32 s11, s9, 3538944
buffer_load_dwordx2 v[148:149], v3, s[24:27], s11 offen sc1
s_add_u32 s11, s9, 5308416
buffer_load_dwordx2 v[150:151], v3, s[24:27], s11 offen sc1
s_waitcnt vmcnt(12)
v_lshlrev_b32 v10, 16, v96
v_and_b32 v11, v8, v96
v_lshlrev_b32 v12, 16, v100
v_add_f32 v10, v10, v12
v_and_b32 v12, v8, v100
v_add_f32 v11, v11, v12
v_lshlrev_b32 v12, 16, v104
v_add_f32 v10, v10, v12
v_and_b32 v12, v8, v104
v_add_f32 v11, v11, v12
v_lshlrev_b32 v12, 16, v108
v_add_f32 v10, v10, v12
v_and_b32 v12, v8, v108
v_add_f32 v11, v11, v12
v_cvt_pk_bf16_f32 v160, v10, v11
v_lshlrev_b32 v10, 16, v97
v_and_b32 v11, v8, v97
v_lshlrev_b32 v12, 16, v101
v_add_f32 v10, v10, v12
v_and_b32 v12, v8, v101
v_add_f32 v11, v11, v12
v_lshlrev_b32 v12, 16, v105
v_add_f32 v10, v10, v12
v_and_b32 v12, v8, v105
v_add_f32 v11, v11, v12
v_lshlrev_b32 v12, 16, v109
v_add_f32 v10, v10, v12
v_and_b32 v12, v8, v109
v_add_f32 v11, v11, v12
v_cvt_pk_bf16_f32 v161, v10, v11
v_lshlrev_b32 v10, 16, v98
v_and_b32 v11, v8, v98
v_lshlrev_b32 v12, 16, v102
v_add_f32 v10, v10, v12
v_and_b32 v12, v8, v102
v_add_f32 v11, v11, v12
v_lshlrev_b32 v12, 16, v106
v_add_f32 v10, v10, v12
v_and_b32 v12, v8, v106
v_add_f32 v11, v11, v12
v_lshlrev_b32 v12, 16, v110
v_add_f32 v10, v10, v12
v_and_b32 v12, v8, v110
v_add_f32 v11, v11, v12
v_cvt_pk_bf16_f32 v162, v10, v11
v_lshlrev_b32 v10, 16, v99
v_and_b32 v11, v8, v99
v_lshlrev_b32 v12, 16, v103
v_add_f32 v10, v10, v12
v_and_b32 v12, v8, v103
v_add_f32 v11, v11, v12
v_lshlrev_b32 v12, 16, v107
v_add_f32 v10, v10, v12
v_and_b32 v12, v8, v107
v_add_f32 v11, v11, v12
v_lshlrev_b32 v12, 16, v111
v_add_f32 v10, v10, v12
v_and_b32 v12, v8, v111
v_add_f32 v11, v11, v12
v_cvt_pk_bf16_f32 v163, v10, v11
s_lshl_b32 s5, s35, 6
s_add_u32 s11, s10, s5
s_add_u32 s11, s11, 0
buffer_store_dwordx4 v[160:163], v6, s[80:83], s11 offen
s_waitcnt vmcnt(9)
v_lshlrev_b32 v10, 16, v112
v_and_b32 v11, v8, v112
v_lshlrev_b32 v12, 16, v116
v_add_f32 v10, v10, v12
v_and_b32 v12, v8, v116
v_add_f32 v11, v11, v12
v_lshlrev_b32 v12, 16, v120
v_add_f32 v10, v10, v12
v_and_b32 v12, v8, v120
v_add_f32 v11, v11, v12
v_lshlrev_b32 v12, 16, v124
v_add_f32 v10, v10, v12
v_and_b32 v12, v8, v124
v_add_f32 v11, v11, v12
v_cvt_pk_bf16_f32 v164, v10, v11
v_lshlrev_b32 v10, 16, v113
v_and_b32 v11, v8, v113
v_lshlrev_b32 v12, 16, v117
v_add_f32 v10, v10, v12
v_and_b32 v12, v8, v117
v_add_f32 v11, v11, v12
v_lshlrev_b32 v12, 16, v121
v_add_f32 v10, v10, v12
v_and_b32 v12, v8, v121
v_add_f32 v11, v11, v12
v_lshlrev_b32 v12, 16, v125
v_add_f32 v10, v10, v12
v_and_b32 v12, v8, v125
v_add_f32 v11, v11, v12
v_cvt_pk_bf16_f32 v165, v10, v11
v_lshlrev_b32 v10, 16, v114
v_and_b32 v11, v8, v114
v_lshlrev_b32 v12, 16, v118
v_add_f32 v10, v10, v12
v_and_b32 v12, v8, v118
v_add_f32 v11, v11, v12
v_lshlrev_b32 v12, 16, v122
v_add_f32 v10, v10, v12
v_and_b32 v12, v8, v122
v_add_f32 v11, v11, v12
v_lshlrev_b32 v12, 16, v126
v_add_f32 v10, v10, v12
v_and_b32 v12, v8, v126
v_add_f32 v11, v11, v12
v_cvt_pk_bf16_f32 v166, v10, v11
v_lshlrev_b32 v10, 16, v115
v_and_b32 v11, v8, v115
v_lshlrev_b32 v12, 16, v119
v_add_f32 v10, v10, v12
v_and_b32 v12, v8, v119
v_add_f32 v11, v11, v12
v_lshlrev_b32 v12, 16, v123
v_add_f32 v10, v10, v12
v_and_b32 v12, v8, v123
v_add_f32 v11, v11, v12
v_lshlrev_b32 v12, 16, v127
v_add_f32 v10, v10, v12
v_and_b32 v12, v8, v127
v_add_f32 v11, v11, v12
v_cvt_pk_bf16_f32 v167, v10, v11
s_lshl_b32 s5, s35, 6
s_add_u32 s11, s10, s5
s_add_u32 s11, s11, 36864
buffer_store_dwordx4 v[164:167], v6, s[80:83], s11 offen
s_waitcnt vmcnt(6)
v_lshlrev_b32 v10, 16, v128
v_and_b32 v11, v8, v128
v_lshlrev_b32 v12, 16, v132
v_add_f32 v10, v10, v12
v_and_b32 v12, v8, v132
v_add_f32 v11, v11, v12
v_lshlrev_b32 v12, 16, v136
v_add_f32 v10, v10, v12
v_and_b32 v12, v8, v136
v_add_f32 v11, v11, v12
v_lshlrev_b32 v12, 16, v140
v_add_f32 v10, v10, v12
v_and_b32 v12, v8, v140
v_add_f32 v11, v11, v12
v_cvt_pk_bf16_f32 v168, v10, v11
v_lshlrev_b32 v10, 16, v129
v_and_b32 v11, v8, v129
v_lshlrev_b32 v12, 16, v133
v_add_f32 v10, v10, v12
v_and_b32 v12, v8, v133
v_add_f32 v11, v11, v12
v_lshlrev_b32 v12, 16, v137
v_add_f32 v10, v10, v12
v_and_b32 v12, v8, v137
v_add_f32 v11, v11, v12
v_lshlrev_b32 v12, 16, v141
v_add_f32 v10, v10, v12
v_and_b32 v12, v8, v141
v_add_f32 v11, v11, v12
v_cvt_pk_bf16_f32 v169, v10, v11
v_lshlrev_b32 v10, 16, v130
v_and_b32 v11, v8, v130
v_lshlrev_b32 v12, 16, v134
v_add_f32 v10, v10, v12
v_and_b32 v12, v8, v134
v_add_f32 v11, v11, v12
v_lshlrev_b32 v12, 16, v138
v_add_f32 v10, v10, v12
v_and_b32 v12, v8, v138
v_add_f32 v11, v11, v12
v_lshlrev_b32 v12, 16, v142
v_add_f32 v10, v10, v12
v_and_b32 v12, v8, v142
v_add_f32 v11, v11, v12
v_cvt_pk_bf16_f32 v170, v10, v11
v_lshlrev_b32 v10, 16, v131
v_and_b32 v11, v8, v131
v_lshlrev_b32 v12, 16, v135
v_add_f32 v10, v10, v12
v_and_b32 v12, v8, v135
v_add_f32 v11, v11, v12
v_lshlrev_b32 v12, 16, v139
v_add_f32 v10, v10, v12
v_and_b32 v12, v8, v139
v_add_f32 v11, v11, v12
v_lshlrev_b32 v12, 16, v143
v_add_f32 v10, v10, v12
v_and_b32 v12, v8, v143
v_add_f32 v11, v11, v12
v_cvt_pk_bf16_f32 v171, v10, v11
s_lshl_b32 s5, s35, 6
s_add_u32 s11, s10, s5
s_add_u32 s11, s11, 73728
buffer_store_dwordx4 v[168:171], v6, s[80:83], s11 offen
s_waitcnt vmcnt(3)
s_cmp_eq_u32 s35, 3
s_cbranch_scc1 L_red_skip8b
v_lshlrev_b32 v10, 16, v144
v_and_b32 v11, v8, v144
v_lshlrev_b32 v12, 16, v146
v_add_f32 v10, v10, v12
v_and_b32 v12, v8, v146
v_add_f32 v11, v11, v12
v_lshlrev_b32 v12, 16, v148
v_add_f32 v10, v10, v12
v_and_b32 v12, v8, v148
v_add_f32 v11, v11, v12
v_lshlrev_b32 v12, 16, v150
v_add_f32 v10, v10, v12
v_and_b32 v12, v8, v150
v_add_f32 v11, v11, v12
v_cvt_pk_bf16_f32 v172, v10, v11
v_lshlrev_b32 v10, 16, v145
v_and_b32 v11, v8, v145
v_lshlrev_b32 v12, 16, v147
v_add_f32 v10, v10, v12
v_and_b32 v12, v8, v147
v_add_f32 v11, v11, v12
v_lshlrev_b32 v12, 16, v149
v_add_f32 v10, v10, v12
v_and_b32 v12, v8, v149
v_add_f32 v11, v11, v12
v_lshlrev_b32 v12, 16, v151
v_add_f32 v10, v10, v12
v_and_b32 v12, v8, v151
v_add_f32 v11, v11, v12
v_cvt_pk_bf16_f32 v173, v10, v11
s_mul_i32 s5, s35, 36864
s_add_u32 s11, s10, s5
s_add_u32 s11, s11, 256
buffer_store_dwordx2 v[172:173], v7, s[80:83], s11 offen
L_red_skip8b:
s_waitcnt vmcnt(0)
L_end:
s_endpgm
L_fallback:
s_mov_b32 s31, 1
s_waitcnt vmcnt(0)
s_barrier
v_mov_b32 v49, 0xff800000
v_mov_b32 v50, 0xff800000
v_mov_b32 v51, 0xff800000
s_mov_b32 s54, s41
s_mov_b32 s6, 16
L_maxpass:
s_add_u32 m0, s28, 0
s_add_u32 s46, s29, s54
buffer_load_dwordx4 v13, s[8:11], s46 offen offset:0 nt lds
buffer_load_dwordx4 v14, s[8:11], s46 offen offset:1024 nt lds
buffer_load_dwordx4 v15, s[8:11], s46 offen offset:2048 nt lds
buffer_load_dwordx4 v16, s[8:11], s46 offen offset:3072 nt lds
s_add_u32 s54, s54, 8192
s_and_b32 s54, s54, 0x1ffff
s_waitcnt vmcnt(0)
s_barrier
ds_read_b128 a[192:195], v1 offset:0
ds_read_b128 a[196:199], v2 offset:0
ds_read_b128 a[200:203], v3 offset:0
ds_read_b128 a[204:207], v4 offset:0
ds_read_b128 a[208:211], v5 offset:0
ds_read_b128 a[212:215], v6 offset:0
ds_read_b128 a[216:219], v7 offset:0
ds_read_b128 a[220:223], v8 offset:0
s_waitcnt lgkmcnt(0)
s_barrier
v_mfma_f32_32x32x16_bf16 v[64:79], a[192:195], v[160:163], 0
v_mfma_f32_32x32x16_bf16 v[64:79], a[196:199], v[164:167], v[64:79]
v_mfma_f32_32x32x16_bf16 v[64:79], a[200:203], v[168:171], v[64:79]
v_mfma_f32_32x32x16_bf16 v[64:79], a[204:207], v[172:175], v[64:79]
v_mfma_f32_32x32x16_bf16 v[64:79], a[208:211], v[176:179], v[64:79]
v_mfma_f32_32x32x16_bf16 v[64:79], a[212:215], v[180:183], v[64:79]
v_mfma_f32_32x32x16_bf16 v[64:79], a[216:219], v[184:187], v[64:79]
v_mfma_f32_32x32x16_bf16 v[64:79], a[220:223], v[188:191], v[64:79]
s_nop 7
s_nop 7
v_max3_f32 v49, v49, v64, v65
v_max3_f32 v49, v49, v66, v67
v_max3_f32 v49, v49, v68, v69
v_max3_f32 v49, v49, v70, v71
v_max3_f32 v49, v49, v72, v73
v_max3_f32 v49, v49, v74, v75
v_max3_f32 v49, v49, v76, v77
v_max3_f32 v49, v49, v78, v79
s_nop 1
v_mfma_f32_32x32x16_bf16 v[64:79], a[192:195], v[192:195], 0
v_mfma_f32_32x32x16_bf16 v[64:79], a[196:199], v[196:199], v[64:79]
v_mfma_f32_32x32x16_bf16 v[64:79], a[200:203], v[200:203], v[64:79]
v_mfma_f32_32x32x16_bf16 v[64:79], a[204:207], v[204:207], v[64:79]
v_mfma_f32_32x32x16_bf16 v[64:79], a[208:211], v[208:211], v[64:79]
v_mfma_f32_32x32x16_bf16 v[64:79], a[212:215], v[212:215], v[64:79]
v_mfma_f32_32x32x16_bf16 v[64:79], a[216:219], v[216:219], v[64:79]
v_mfma_f32_32x32x16_bf16 v[64:79], a[220:223], v[220:223], v[64:79]
s_nop 7
s_nop 7
v_max3_f32 v50, v50, v64, v65
v_max3_f32 v50, v50, v66, v67
v_max3_f32 v50, v50, v68, v69
v_max3_f32 v50, v50, v70, v71
v_max3_f32 v50, v50, v72, v73
v_max3_f32 v50, v50, v74, v75
v_max3_f32 v50, v50, v76, v77
v_max3_f32 v50, v50, v78, v79
s_nop 1
v_mfma_f32_32x32x16_bf16 v[64:79], a[192:195], v[224:227], 0
v_mfma_f32_32x32x16_bf16 v[64:79], a[196:199], v[228:231], v[64:79]
v_mfma_f32_32x32x16_bf16 v[64:79], a[200:203], v[232:235], v[64:79]
v_mfma_f32_32x32x16_bf16 v[64:79], a[204:207], v[236:239], v[64:79]
v_mfma_f32_32x32x16_bf16 v[64:79], a[208:211], v[240:243], v[64:79]
v_mfma_f32_32x32x16_bf16 v[64:79], a[212:215], v[244:247], v[64:79]
v_mfma_f32_32x32x16_bf16 v[64:79], a[216:219], v[248:251], v[64:79]
v_mfma_f32_32x32x16_bf16 v[64:79], a[220:223], v[252:255], v[64:79]
s_nop 7
s_nop 7
v_max3_f32 v51, v51, v64, v65
v_max3_f32 v51, v51, v66, v67
v_max3_f32 v51, v51, v68, v69
v_max3_f32 v51, v51, v70, v71
v_max3_f32 v51, v51, v72, v73
v_max3_f32 v51, v51, v74, v75
v_max3_f32 v51, v51, v76, v77
v_max3_f32 v51, v51, v78, v79
s_nop 1
s_sub_u32 s6, s6, 1
s_cmp_lg_u32 s6, 0
s_cbranch_scc1 L_maxpass
v_mov_b32 v47, v49
s_nop 1
v_permlane32_swap_b32 v47, v49
s_nop 1
v_max_f32 v49, v49, v47
v_mul_f32 v112, -1.0, v49
v_mov_b32 v113, v112
v_mov_b32 v114, v112
v_mov_b32 v115, v112
v_mov_b32 v116, v112
v_mov_b32 v117, v112
v_mov_b32 v118, v112
v_mov_b32 v119, v112
v_mov_b32 v120, v112
v_mov_b32 v121, v112
v_mov_b32 v122, v112
v_mov_b32 v123, v112
v_mov_b32 v124, v112
v_mov_b32 v125, v112
v_mov_b32 v126, v112
v_mov_b32 v127, v112
v_mov_b32 v18, 0
v_mov_b32 v47, v50
s_nop 1
v_permlane32_swap_b32 v47, v50
s_nop 1
v_max_f32 v50, v50, v47
v_mul_f32 v128, -1.0, v50
v_mov_b32 v129, v128
v_mov_b32 v130, v128
v_mov_b32 v131, v128
v_mov_b32 v132, v128
v_mov_b32 v133, v128
v_mov_b32 v134, v128
v_mov_b32 v135, v128
v_mov_b32 v136, v128
v_mov_b32 v137, v128
v_mov_b32 v138, v128
v_mov_b32 v139, v128
v_mov_b32 v140, v128
v_mov_b32 v141, v128
v_mov_b32 v142, v128
v_mov_b32 v143, v128
v_mov_b32 v19, 0
v_mov_b32 v47, v51
s_nop 1
v_permlane32_swap_b32 v47, v51
s_nop 1
v_max_f32 v51, v51, v47
v_mul_f32 v144, -1.0, v51
v_mov_b32 v145, v144
v_mov_b32 v146, v144
v_mov_b32 v147, v144
v_mov_b32 v148, v144
v_mov_b32 v149, v144
v_mov_b32 v150, v144
v_mov_b32 v151, v144
v_mov_b32 v152, v144
v_mov_b32 v153, v144
v_mov_b32 v154, v144
v_mov_b32 v155, v144
v_mov_b32 v156, v144
v_mov_b32 v157, v144
v_mov_b32 v158, v144
v_mov_b32 v159, v144
v_mov_b32 v20, 0
v_accvgpr_write_b32 a0, 0
v_accvgpr_write_b32 a1, 0
v_accvgpr_write_b32 a2, 0
v_accvgpr_write_b32 a3, 0
v_accvgpr_write_b32 a4, 0
v_accvgpr_write_b32 a5, 0
v_accvgpr_write_b32 a6, 0
v_accvgpr_write_b32 a7, 0
v_accvgpr_write_b32 a8, 0
v_accvgpr_write_b32 a9, 0
v_accvgpr_write_b32 a10, 0
v_accvgpr_write_b32 a11, 0
v_accvgpr_write_b32 a12, 0
v_accvgpr_write_b32 a13, 0
v_accvgpr_write_b32 a14, 0
v_accvgpr_write_b32 a15, 0
v_accvgpr_write_b32 a16, 0
v_accvgpr_write_b32 a17, 0
v_accvgpr_write_b32 a18, 0
v_accvgpr_write_b32 a19, 0
v_accvgpr_write_b32 a20, 0
v_accvgpr_write_b32 a21, 0
v_accvgpr_write_b32 a22, 0
v_accvgpr_write_b32 a23, 0
v_accvgpr_write_b32 a24, 0
v_accvgpr_write_b32 a25, 0
v_accvgpr_write_b32 a26, 0
v_accvgpr_write_b32 a27, 0
v_accvgpr_write_b32 a28, 0
v_accvgpr_write_b32 a29, 0
v_accvgpr_write_b32 a30, 0
v_accvgpr_write_b32 a31, 0
v_accvgpr_write_b32 a32, 0
v_accvgpr_write_b32 a33, 0
v_accvgpr_write_b32 a34, 0
v_accvgpr_write_b32 a35, 0
v_accvgpr_write_b32 a36, 0
v_accvgpr_write_b32 a37, 0
v_accvgpr_write_b32 a38, 0
v_accvgpr_write_b32 a39, 0
v_accvgpr_write_b32 a40, 0
v_accvgpr_write_b32 a41, 0
v_accvgpr_write_b32 a42, 0
v_accvgpr_write_b32 a43, 0
v_accvgpr_write_b32 a44, 0
v_accvgpr_write_b32 a45, 0
v_accvgpr_write_b32 a46, 0
v_accvgpr_write_b32 a47, 0
v_accvgpr_write_b32 a48, 0
v_accvgpr_write_b32 a49, 0
v_accvgpr_write_b32 a50, 0
v_accvgpr_write_b32 a51, 0
v_accvgpr_write_b32 a52, 0
v_accvgpr_write_b32 a53, 0
v_accvgpr_write_b32 a54, 0
v_accvgpr_write_b32 a55, 0
v_accvgpr_write_b32 a56, 0
v_accvgpr_write_b32 a57, 0
v_accvgpr_write_b32 a58, 0
v_accvgpr_write_b32 a59, 0
v_accvgpr_write_b32 a60, 0
v_accvgpr_write_b32 a61, 0
v_accvgpr_write_b32 a62, 0
v_accvgpr_write_b32 a63, 0
v_accvgpr_write_b32 a64, 0
v_accvgpr_write_b32 a65, 0
v_accvgpr_write_b32 a66, 0
v_accvgpr_write_b32 a67, 0
v_accvgpr_write_b32 a68, 0
v_accvgpr_write_b32 a69, 0
v_accvgpr_write_b32 a70, 0
v_accvgpr_write_b32 a71, 0
v_accvgpr_write_b32 a72, 0
v_accvgpr_write_b32 a73, 0
v_accvgpr_write_b32 a74, 0
v_accvgpr_write_b32 a75, 0
v_accvgpr_write_b32 a76, 0
v_accvgpr_write_b32 a77, 0
v_accvgpr_write_b32 a78, 0
v_accvgpr_write_b32 a79, 0
v_accvgpr_write_b32 a80, 0
v_accvgpr_write_b32 a81, 0
v_accvgpr_write_b32 a82, 0
v_accvgpr_write_b32 a83, 0
v_accvgpr_write_b32 a84, 0
v_accvgpr_write_b32 a85, 0
v_accvgpr_write_b32 a86, 0
v_accvgpr_write_b32 a87, 0
v_accvgpr_write_b32 a88, 0
v_accvgpr_write_b32 a89, 0
v_accvgpr_write_b32 a90, 0
v_accvgpr_write_b32 a91, 0
v_accvgpr_write_b32 a92, 0
v_accvgpr_write_b32 a93, 0
v_accvgpr_write_b32 a94, 0
v_accvgpr_write_b32 a95, 0
v_accvgpr_write_b32 a96, 0
v_accvgpr_write_b32 a97, 0
v_accvgpr_write_b32 a98, 0
v_accvgpr_write_b32 a99, 0
v_accvgpr_write_b32 a100, 0
v_accvgpr_write_b32 a101, 0
v_accvgpr_write_b32 a102, 0
v_accvgpr_write_b32 a103, 0
v_accvgpr_write_b32 a104, 0
v_accvgpr_write_b32 a105, 0
v_accvgpr_write_b32 a106, 0
v_accvgpr_write_b32 a107, 0
v_accvgpr_write_b32 a108, 0
v_accvgpr_write_b32 a109, 0
v_accvgpr_write_b32 a110, 0
v_accvgpr_write_b32 a111, 0
v_accvgpr_write_b32 a112, 0
v_accvgpr_write_b32 a113, 0
v_accvgpr_write_b32 a114, 0
v_accvgpr_write_b32 a115, 0
v_accvgpr_write_b32 a116, 0
v_accvgpr_write_b32 a117, 0
v_accvgpr_write_b32 a118, 0
v_accvgpr_write_b32 a119, 0
v_accvgpr_write_b32 a120, 0
v_accvgpr_write_b32 a121, 0
v_accvgpr_write_b32 a122, 0
v_accvgpr_write_b32 a123, 0
v_accvgpr_write_b32 a124, 0
v_accvgpr_write_b32 a125, 0
v_accvgpr_write_b32 a126, 0
v_accvgpr_write_b32 a127, 0
v_accvgpr_write_b32 a128, 0
v_accvgpr_write_b32 a129, 0
v_accvgpr_write_b32 a130, 0
v_accvgpr_write_b32 a131, 0
v_accvgpr_write_b32 a132, 0
v_accvgpr_write_b32 a133, 0
v_accvgpr_write_b32 a134, 0
v_accvgpr_write_b32 a135, 0
v_accvgpr_write_b32 a136, 0
v_accvgpr_write_b32 a137, 0
v_accvgpr_write_b32 a138, 0
v_accvgpr_write_b32 a139, 0
v_accvgpr_write_b32 a140, 0
v_accvgpr_write_b32 a141, 0
v_accvgpr_write_b32 a142, 0
v_accvgpr_write_b32 a143, 0
v_accvgpr_write_b32 a144, 0
v_accvgpr_write_b32 a145, 0
v_accvgpr_write_b32 a146, 0
v_accvgpr_write_b32 a147, 0
v_accvgpr_write_b32 a148, 0
v_accvgpr_write_b32 a149, 0
v_accvgpr_write_b32 a150, 0
v_accvgpr_write_b32 a151, 0
v_accvgpr_write_b32 a152, 0
v_accvgpr_write_b32 a153, 0
v_accvgpr_write_b32 a154, 0
v_accvgpr_write_b32 a155, 0
v_accvgpr_write_b32 a156, 0
v_accvgpr_write_b32 a157, 0
v_accvgpr_write_b32 a158, 0
v_accvgpr_write_b32 a159, 0
v_accvgpr_write_b32 a160, 0
v_accvgpr_write_b32 a161, 0
v_accvgpr_write_b32 a162, 0
v_accvgpr_write_b32 a163, 0
v_accvgpr_write_b32 a164, 0
v_accvgpr_write_b32 a165, 0
v_accvgpr_write_b32 a166, 0
v_accvgpr_write_b32 a167, 0
v_accvgpr_write_b32 a168, 0
v_accvgpr_write_b32 a169, 0
v_accvgpr_write_b32 a170, 0
v_accvgpr_write_b32 a171, 0
v_accvgpr_write_b32 a172, 0
v_accvgpr_write_b32 a173, 0
v_accvgpr_write_b32 a174, 0
v_accvgpr_write_b32 a175, 0
v_accvgpr_write_b32 a176, 0
v_accvgpr_write_b32 a177, 0
v_accvgpr_write_b32 a178, 0
v_accvgpr_write_b32 a179, 0
v_accvgpr_write_b32 a180, 0
v_accvgpr_write_b32 a181, 0
v_accvgpr_write_b32 a182, 0
v_accvgpr_write_b32 a183, 0
v_accvgpr_write_b32 a184, 0
v_accvgpr_write_b32 a185, 0
v_accvgpr_write_b32 a186, 0
v_accvgpr_write_b32 a187, 0
v_accvgpr_write_b32 a188, 0
v_accvgpr_write_b32 a189, 0
v_accvgpr_write_b32 a190, 0
v_accvgpr_write_b32 a191, 0
s_mov_b32 s54, s41
s_mov_b32 s55, s41
s_add_u32 m0, s28, 0
s_add_u32 s46, s29, s54
buffer_load_dwordx4 v13, s[8:11], s46 offen offset:0 nt lds
buffer_load_dwordx4 v14, s[8:11], s46 offen offset:1024 nt lds
buffer_load_dwordx4 v15, s[8:11], s46 offen offset:2048 nt lds
buffer_load_dwordx4 v16, s[8:11], s46 offen offset:3072 nt lds
s_add_u32 s54, s54, 8192
s_and_b32 s54, s54, 0x1ffff
s_add_u32 m0, s28, 32768
s_add_u32 s47, s29, s55
buffer_load_dwordx4 v17, s[12:15], s47 offen offset:0 nt lds
buffer_load_dwordx4 v17, s[12:15], s47 offen offset:1024 nt lds
buffer_load_dwordx4 v17, s[12:15], s47 offen offset:2048 nt lds
buffer_load_dwordx4 v17, s[12:15], s47 offen offset:3072 nt lds
s_add_u32 s55, s55, 8192
s_and_b32 s55, s55, 0x1ffff
s_add_u32 m0, s28, 8192
s_add_u32 s46, s29, s54
buffer_load_dwordx4 v13, s[8:11], s46 offen offset:0 nt lds
buffer_load_dwordx4 v14, s[8:11], s46 offen offset:1024 nt lds
buffer_load_dwordx4 v15, s[8:11], s46 offen offset:2048 nt lds
buffer_load_dwordx4 v16, s[8:11], s46 offen offset:3072 nt lds
s_add_u32 s54, s54, 8192
s_and_b32 s54, s54, 0x1ffff
s_add_u32 m0, s28, 40960
s_add_u32 s47, s29, s55
buffer_load_dwordx4 v17, s[12:15], s47 offen offset:0 nt lds
buffer_load_dwordx4 v17, s[12:15], s47 offen offset:1024 nt lds
buffer_load_dwordx4 v17, s[12:15], s47 offen offset:2048 nt lds
buffer_load_dwordx4 v17, s[12:15], s47 offen offset:3072 nt lds
s_add_u32 s55, s55, 8192
s_and_b32 s55, s55, 0x1ffff
s_add_u32 m0, s28, 16384
s_add_u32 s46, s29, s54
buffer_load_dwordx4 v13, s[8:11], s46 offen offset:0 nt lds
buffer_load_dwordx4 v14, s[8:11], s46 offen offset:1024 nt lds
buffer_load_dwordx4 v15, s[8:11], s46 offen offset:2048 nt lds
buffer_load_dwordx4 v16, s[8:11], s46 offen offset:3072 nt lds
s_add_u32 s54, s54, 8192
s_and_b32 s54, s54, 0x1ffff
s_add_u32 m0, s28, 49152
s_add_u32 s47, s29, s55
buffer_load_dwordx4 v17, s[12:15], s47 offen offset:0 nt lds
buffer_load_dwordx4 v17, s[12:15], s47 offen offset:1024 nt lds
buffer_load_dwordx4 v17, s[12:15], s47 offen offset:2048 nt lds
buffer_load_dwordx4 v17, s[12:15], s47 offen offset:3072 nt lds
s_add_u32 s55, s55, 8192
s_and_b32 s55, s55, 0x1ffff
s_add_u32 m0, s28, 24576
s_add_u32 s46, s29, s54
buffer_load_dwordx4 v13, s[8:11], s46 offen offset:0 nt lds
buffer_load_dwordx4 v14, s[8:11], s46 offen offset:1024 nt lds
buffer_load_dwordx4 v15, s[8:11], s46 offen offset:2048 nt lds
buffer_load_dwordx4 v16, s[8:11], s46 offen offset:3072 nt lds
s_add_u32 s54, s54, 8192
s_and_b32 s54, s54, 0x1ffff
s_waitcnt vmcnt(0)
s_barrier
ds_read_b128 a[192:195], v1 offset:0
ds_read_b128 a[196:199], v2 offset:0
ds_read_b128 a[200:203], v3 offset:0
ds_read_b128 a[204:207], v4 offset:0
ds_read_b128 a[208:211], v5 offset:0
ds_read_b128 a[212:215], v6 offset:0
ds_read_b128 a[216:219], v7 offset:0
ds_read_b128 a[220:223], v8 offset:0
s_waitcnt lgkmcnt(0)
s_nop 1
v_mfma_f32_32x32x16_bf16 v[64:79], a[192:195], v[160:163], v[112:127]
v_mfma_f32_32x32x16_bf16 v[64:79], a[196:199], v[164:167], v[64:79]
v_mfma_f32_32x32x16_bf16 v[64:79], a[200:203], v[168:171], v[64:79]
v_mfma_f32_32x32x16_bf16 v[64:79], a[204:207], v[172:175], v[64:79]
v_mfma_f32_32x32x16_bf16 v[64:79], a[208:211], v[176:179], v[64:79]
v_mfma_f32_32x32x16_bf16 v[64:79], a[212:215], v[180:183], v[64:79]
v_mfma_f32_32x32x16_bf16 v[64:79], a[216:219], v[184:187], v[64:79]
v_mfma_f32_32x32x16_bf16 v[64:79], a[220:223], v[188:191], v[64:79]
s_nop 7
s_nop 7
v_mfma_f32_32x32x16_bf16 v[80:95], a[192:195], v[192:195], v[128:143]
s_barrier
v_exp_f32 v64, v64
v_exp_f32 v65, v65
v_add_f32 v18, v18, v64
v_exp_f32 v66, v66
v_add_f32 v18, v18, v65
v_cvt_pk_bf16_f32 v96, v64, v65
v_mfma_f32_32x32x16_bf16 v[80:95], a[196:199], v[196:199], v[80:95]
ds_read_b64_tr_b16 a[224:225], v9 offset:0
ds_read_b64_tr_b16 a[226:227], v9 offset:2048
ds_read_b64_tr_b16 a[228:229], v10 offset:0
ds_read_b64_tr_b16 a[230:231], v10 offset:2048
s_add_u32 m0, s28, 0
s_add_u32 s46, s29, s54
v_exp_f32 v67, v67
v_add_f32 v18, v18, v66
v_exp_f32 v68, v68
v_mfma_f32_32x32x16_bf16 v[80:95], a[200:203], v[200:203], v[80:95]
ds_read_b64_tr_b16 a[232:233], v11 offset:0
ds_read_b64_tr_b16 a[234:235], v11 offset:2048
buffer_load_dwordx4 v13, s[8:11], s46 offen offset:0 nt lds
v_add_f32 v18, v18, v67
v_cvt_pk_bf16_f32 v97, v66, v67
v_exp_f32 v69, v69
v_add_f32 v18, v18, v68
v_exp_f32 v70, v70
v_mfma_f32_32x32x16_bf16 v[80:95], a[204:207], v[204:207], v[80:95]
ds_read_b64_tr_b16 a[236:237], v12 offset:0
ds_read_b64_tr_b16 a[238:239], v12 offset:2048
v_add_f32 v18, v18, v69
v_cvt_pk_bf16_f32 v98, v68, v69
v_exp_f32 v71, v71
v_add_f32 v18, v18, v70
v_exp_f32 v72, v72
v_add_f32 v18, v18, v71
v_mfma_f32_32x32x16_bf16 v[80:95], a[208:211], v[208:211], v[80:95]
ds_read_b64_tr_b16 a[240:241], v9 offset:4096
ds_read_b64_tr_b16 a[242:243], v9 offset:6144
v_cvt_pk_bf16_f32 v99, v70, v71
v_exp_f32 v73, v73
v_add_f32 v18, v18, v72
v_exp_f32 v74, v74
v_add_f32 v18, v18, v73
v_cvt_pk_bf16_f32 v100, v72, v73
v_mfma_f32_32x32x16_bf16 v[80:95], a[212:215], v[212:215], v[80:95]
ds_read_b64_tr_b16 a[244:245], v10 offset:4096
ds_read_b64_tr_b16 a[246:247], v10 offset:6144
v_exp_f32 v75, v75
v_add_f32 v18, v18, v74
v_exp_f32 v76, v76
v_add_f32 v18, v18, v75
v_cvt_pk_bf16_f32 v101, v74, v75
v_exp_f32 v77, v77
v_add_f32 v18, v18, v76
v_mfma_f32_32x32x16_bf16 v[80:95], a[216:219], v[216:219], v[80:95]
ds_read_b64_tr_b16 a[248:249], v11 offset:4096
ds_read_b64_tr_b16 a[250:251], v11 offset:6144
v_exp_f32 v78, v78
v_add_f32 v18, v18, v77
v_cvt_pk_bf16_f32 v102, v76, v77
v_exp_f32 v79, v79
v_add_f32 v18, v18, v78
v_add_f32 v18, v18, v79
v_mfma_f32_32x32x16_bf16 v[80:95], a[220:223], v[220:223], v[80:95]
ds_read_b64_tr_b16 a[252:253], v12 offset:4096
ds_read_b64_tr_b16 a[254:255], v12 offset:6144
s_add_u32 m0, s28, 0
s_nop 0
buffer_load_dwordx4 v14, s[8:11], s46 offen offset:1024 nt lds
s_add_u32 m0, s28, 0
s_nop 0
buffer_load_dwordx4 v15, s[8:11], s46 offen offset:2048 nt lds
v_cvt_pk_bf16_f32 v103, v78, v79
s_nop 3
v_mfma_f32_32x32x16_bf16 v[64:79], a[192:195], v[224:227], v[144:159]
ds_read_b128 a[192:195], v1 offset:8192
v_exp_f32 v80, v80
v_exp_f32 v81, v81
v_mfma_f32_32x32x16_bf16 v[64:79], a[196:199], v[228:231], v[64:79]
ds_read_b128 a[196:199], v2 offset:8192
v_add_f32 v19, v19, v80
v_exp_f32 v82, v82
v_mfma_f32_32x32x16_bf16 v[64:79], a[200:203], v[232:235], v[64:79]
ds_read_b128 a[200:203], v3 offset:8192
v_add_f32 v19, v19, v81
v_cvt_pk_bf16_f32 v104, v80, v81
v_exp_f32 v83, v83
v_mfma_f32_32x32x16_bf16 v[64:79], a[204:207], v[236:239], v[64:79]
ds_read_b128 a[204:207], v4 offset:8192
v_add_f32 v19, v19, v82
v_exp_f32 v84, v84
v_mfma_f32_32x32x16_bf16 v[64:79], a[208:211], v[240:243], v[64:79]
ds_read_b128 a[208:211], v5 offset:8192
v_add_f32 v19, v19, v83
v_cvt_pk_bf16_f32 v105, v82, v83
v_exp_f32 v85, v85
v_mfma_f32_32x32x16_bf16 v[64:79], a[212:215], v[244:247], v[64:79]
ds_read_b128 a[212:215], v6 offset:8192
s_add_u32 m0, s28, 0
v_add_f32 v19, v19, v84
v_exp_f32 v86, v86
v_mfma_f32_32x32x16_bf16 v[64:79], a[216:219], v[248:251], v[64:79]
ds_read_b128 a[216:219], v7 offset:8192
buffer_load_dwordx4 v16, s[8:11], s46 offen offset:3072 nt lds
s_add_u32 s54, s54, 8192
s_and_b32 s54, s54, 0x1ffff
v_mfma_f32_32x32x16_bf16 v[64:79], a[220:223], v[252:255], v[64:79]
ds_read_b128 a[220:223], v8 offset:8192
v_add_f32 v19, v19, v85
v_cvt_pk_bf16_f32 v106, v84, v85
s_waitcnt lgkmcnt(8)
v_mfma_f32_32x32x16_bf16 a[0:15], a[224:227], v[96:99], a[0:15]
v_exp_f32 v87, v87
v_add_f32 v19, v19, v86
v_exp_f32 v88, v88
v_mfma_f32_32x32x16_bf16 a[16:31], a[228:231], v[96:99], a[16:31]
v_add_f32 v19, v19, v87
v_cvt_pk_bf16_f32 v107, v86, v87
v_exp_f32 v89, v89
v_add_f32 v19, v19, v88
v_mfma_f32_32x32x16_bf16 a[32:47], a[232:235], v[96:99], a[32:47]
v_exp_f32 v90, v90
v_add_f32 v19, v19, v89
v_cvt_pk_bf16_f32 v108, v88, v89
v_mfma_f32_32x32x16_bf16 a[48:63], a[236:239], v[96:99], a[48:63]
s_add_u32 m0, s28, 57344
s_add_u32 s47, s29, s55
v_exp_f32 v91, v91
v_add_f32 v19, v19, v90
v_mfma_f32_32x32x16_bf16 a[0:15], a[240:243], v[100:103], a[0:15]
buffer_load_dwordx4 v17, s[12:15], s47 offen offset:0 nt lds
v_exp_f32 v92, v92
v_mfma_f32_32x32x16_bf16 a[16:31], a[244:247], v[100:103], a[16:31]
v_add_f32 v19, v19, v91
v_cvt_pk_bf16_f32 v109, v90, v91
v_exp_f32 v93, v93
v_add_f32 v19, v19, v92
v_mfma_f32_32x32x16_bf16 a[32:47], a[248:251], v[100:103], a[32:47]
v_exp_f32 v94, v94
v_add_f32 v19, v19, v93
v_cvt_pk_bf16_f32 v110, v92, v93
v_mfma_f32_32x32x16_bf16 a[48:63], a[252:255], v[100:103], a[48:63]
v_exp_f32 v95, v95
v_add_f32 v19, v19, v94
v_add_f32 v19, v19, v95
v_cvt_pk_bf16_f32 v111, v94, v95
s_waitcnt lgkmcnt(0)
v_mfma_f32_32x32x16_bf16 v[80:95], a[192:195], v[160:163], v[112:127]
v_exp_f32 v64, v64
v_exp_f32 v65, v65
v_mfma_f32_32x32x16_bf16 v[80:95], a[196:199], v[164:167], v[80:95]
v_add_f32 v20, v20, v64
v_exp_f32 v66, v66
v_add_f32 v20, v20, v65
v_mfma_f32_32x32x16_bf16 v[80:95], a[200:203], v[168:171], v[80:95]
s_add_u32 m0, s28, 57344
v_cvt_pk_bf16_f32 v96, v64, v65
v_exp_f32 v67, v67
v_mfma_f32_32x32x16_bf16 v[80:95], a[204:207], v[172:175], v[80:95]
buffer_load_dwordx4 v17, s[12:15], s47 offen offset:1024 nt lds
v_add_f32 v20, v20, v66
v_mfma_f32_32x32x16_bf16 v[80:95], a[208:211], v[176:179], v[80:95]
v_exp_f32 v68, v68
v_add_f32 v20, v20, v67
v_cvt_pk_bf16_f32 v97, v66, v67
v_mfma_f32_32x32x16_bf16 v[80:95], a[212:215], v[180:183], v[80:95]
v_exp_f32 v69, v69
v_add_f32 v20, v20, v68
v_exp_f32 v70, v70
v_mfma_f32_32x32x16_bf16 v[80:95], a[216:219], v[184:187], v[80:95]
v_add_f32 v20, v20, v69
v_cvt_pk_bf16_f32 v98, v68, v69
v_exp_f32 v71, v71
v_mfma_f32_32x32x16_bf16 v[80:95], a[220:223], v[188:191], v[80:95]
v_add_f32 v20, v20, v70
v_exp_f32 v72, v72
v_mfma_f32_32x32x16_bf16 a[64:79], a[224:227], v[104:107], a[64:79]
v_add_f32 v20, v20, v71
v_cvt_pk_bf16_f32 v99, v70, v71
v_exp_f32 v73, v73
v_mfma_f32_32x32x16_bf16 a[80:95], a[228:231], v[104:107], a[80:95]
s_add_u32 m0, s28, 57344
v_add_f32 v20, v20, v72
v_exp_f32 v74, v74
v_mfma_f32_32x32x16_bf16 a[96:111], a[232:235], v[104:107], a[96:111]
s_waitcnt vmcnt(5)
buffer_load_dwordx4 v17, s[12:15], s47 offen offset:2048 nt lds
v_add_f32 v20, v20, v73
v_cvt_pk_bf16_f32 v100, v72, v73
v_mfma_f32_32x32x16_bf16 a[112:127], a[236:239], v[104:107], a[112:127]
v_exp_f32 v75, v75
v_add_f32 v20, v20, v74
v_mfma_f32_32x32x16_bf16 a[64:79], a[240:243], v[108:111], a[64:79]
v_exp_f32 v76, v76
v_add_f32 v20, v20, v75
v_cvt_pk_bf16_f32 v101, v74, v75
v_mfma_f32_32x32x16_bf16 a[80:95], a[244:247], v[108:111], a[80:95]
v_exp_f32 v77, v77
v_add_f32 v20, v20, v76
v_exp_f32 v78, v78
v_mfma_f32_32x32x16_bf16 a[96:111], a[248:251], v[108:111], a[96:111]
v_add_f32 v20, v20, v77
v_cvt_pk_bf16_f32 v102, v76, v77
v_exp_f32 v79, v79
v_mfma_f32_32x32x16_bf16 a[112:127], a[252:255], v[108:111], a[112:127]
v_add_f32 v20, v20, v78
v_add_f32 v20, v20, v79
v_cvt_pk_bf16_f32 v103, v78, v79
s_branch L_slot3
L_code_end:
.section .rodata,"a"
.p2align 6
.amdhsa_kernel concat_heads__mha_block_cached__mha_block_cached__near_ridge_kernel
  .amdhsa_next_free_vgpr 512
  .amdhsa_next_free_sgpr 100
  .amdhsa_accum_offset 256
  .amdhsa_group_segment_fixed_size 0
  .amdhsa_kernarg_size 104
  .amdhsa_user_sgpr_count 2
  .amdhsa_user_sgpr_kernarg_segment_ptr 1
  .amdhsa_system_sgpr_workgroup_id_x 1
.end_amdhsa_kernel
```
